```python
import torch

def _softmax(x, axis=-1):
    return torch.softmax(x, dim=axis)
def _gelu(x):
    return torch.nn.functional.gelu(x, approximate="tanh")
def _silu(x):
    return torch.nn.functional.silu(x)
def _sigmoid(x):
    return torch.sigmoid(x)
def _layernorm(x, axis=-1, eps=1e-5):
    m = x.mean(dim=axis, keepdim=True)
    v = x.var(dim=axis, keepdim=True, unbiased=False)
    return (x - m) / torch.sqrt(v + eps)
def _scatter_add(tgt, idx, src, axis=0):
    return tgt.clone().index_add_(axis, idx, src)
def _segment_sum(src, seg, n):
    out = torch.zeros((n,) + src.shape[1:], dtype=src.dtype)
    return out.index_add_(0, seg, src)
def _pad(x, pw):
    flat = tuple(v for pair in reversed(pw) for v in pair)
    return torch.nn.functional.pad(x, flat)

kernel_name = 'interleave_layers__spectral_fnet__glu_gated_glu__prompt'

def setup_inputs():

    _w = (lambda a: (lambda t: t.to(torch.bfloat16) if t.is_floating_point() else t)(torch.as_tensor(a)))
    def _A_setup():
        B, S, D = 1, 2048, 512
        ns = torch.arange(S)[:, None] * torch.arange(S)[None, :]
        nd = torch.arange(D)[:, None] * torch.arange(D)[None, :]
        Ws_re = torch.cos(-2.0 * torch.pi * ns / S).to(float)
        Ws_im = torch.sin(-2.0 * torch.pi * ns / S).to(float)
        Wd_re = torch.cos(-2.0 * torch.pi * nd / D).to(float)
        Wd_im = torch.sin(-2.0 * torch.pi * nd / D).to(float)
        return {
            "x": _w((lambda *s: torch.randn(*s, dtype=torch.bfloat16) * 0.05)(B, S, D)),
            "dft_seq_re": _w(Ws_re),
            "dft_seq_im": _w(Ws_im),
            "dft_hid_re": _w(Wd_re),
            "dft_hid_im": _w(Wd_im),
        }
    _A_in = _A_setup()

    def _B_setup():
        B, S, D, F = 1, 2048, 512, 1792
        return {
            "x": _w((lambda *s: torch.randn(*s, dtype=torch.bfloat16) * 0.05)(B, S, D)),
            "w_gate": _w((lambda *s: torch.randn(*s, dtype=torch.bfloat16) * 1.6)(D, F)),
            "w_up": _w((lambda *s: torch.randn(*s, dtype=torch.bfloat16) * 0.8)(D, F)),
            "w_down": _w((lambda *s: torch.randn(*s, dtype=torch.bfloat16) * 0.8)(F, D)),
        }
    _B_in = _B_setup()

    return {
        "A_x": _A_in["x"],
        "A_dft_seq_re": _A_in["dft_seq_re"],
        "A_dft_seq_im": _A_in["dft_seq_im"],
        "A_dft_hid_re": _A_in["dft_hid_re"],
        "A_dft_hid_im": _A_in["dft_hid_im"],
        "B_x": _B_in["x"],
        "B_w_gate": _B_in["w_gate"],
        "B_w_up": _B_in["w_up"],
        "B_w_down": _B_in["w_down"],
    }

def reference(A_x, A_dft_seq_re, A_dft_seq_im, A_dft_hid_re, A_dft_hid_im, B_x, B_w_gate, B_w_up, B_w_down):
    def _A_ref(x, dft_seq_re, dft_seq_im, dft_hid_re, dft_hid_im):
        a = torch.einsum("bsd,ed->bse", x, dft_hid_re)
        b = torch.einsum("bsd,ed->bse", x, dft_hid_im)
        y = torch.einsum("ts,bse->bte", dft_seq_re, a) - torch.einsum("ts,bse->bte", dft_seq_im, b)
        return y

    def _B_ref(x, w_gate, w_up, w_down):
        g = torch.einsum("bsd,df->bsf", x, w_gate)
        u = torch.einsum("bsd,df->bsf", x, w_up)
        h = _sigmoid(g) * u
        return torch.einsum("bsf,fd->bsd", h, w_down)

    x = A_x
    x = x + _A_ref(_layernorm(x, axis=-1), A_dft_seq_re, A_dft_seq_im, A_dft_hid_re, A_dft_hid_im)
    x = x + _B_ref(_layernorm(x, axis=-1), B_w_gate, B_w_up, B_w_down)
    x = x + _A_ref(_layernorm(x, axis=-1), A_dft_seq_re, A_dft_seq_im, A_dft_hid_re, A_dft_hid_im)
    x = x + _B_ref(_layernorm(x, axis=-1), B_w_gate, B_w_up, B_w_down)
    return x
```

```asm
; @launch grid=(256,1,1) block=(256,1,1) lds=163840
.amdgcn_target "amdgcn-amd-amdhsa--gfx950"
.text
.globl interleave_layers__spectral_fnet__glu_gated_glu__prompt_kernel
.p2align 8
.type interleave_layers__spectral_fnet__glu_gated_glu__prompt_kernel,@function
interleave_layers__spectral_fnet__glu_gated_glu__prompt_kernel:
    s_load_dwordx2 s[12:13], s[0:1], 0
    s_load_dwordx2 s[16:17], s[0:1], 72
    s_load_dwordx4 s[52:55], s[0:1], 48
    s_load_dwordx2 s[56:57], s[0:1], 64
    s_load_dwordx2 s[4:5], s[0:1], 80
    s_memrealtime s[18:19]
    s_cmp_lt_u32 s2, 240
    s_cbranch_scc1 L_nopf_2
    s_getpc_b64 s[44:45]
L_pc_3:
    s_add_u32 s44, s44, interleave_layers__spectral_fnet__glu_gated_glu__prompt_kernel-L_pc_3
    s_addc_u32 s45, s45, -1
    v_lshlrev_b32 v65, 7, v0
    v_min_u32 v65, L_main_end-interleave_layers__spectral_fnet__glu_gated_glu__prompt_kernel, v65
    global_load_dword v255, v65, s[44:45]
    s_getpc_b64 s[44:45]
L_pc_4:
    s_add_u32 s44, s44, interleave_layers__spectral_fnet__glu_gated_glu__prompt_kernel-L_pc_4
    s_addc_u32 s45, s45, -1
    v_lshlrev_b32 v65, 7, v0
    v_add_u32 v65, 32768, v65
    v_min_u32 v65, L_main_end-interleave_layers__spectral_fnet__glu_gated_glu__prompt_kernel, v65
    global_load_dword v255, v65, s[44:45]
L_nopf_2:
    s_cmp_ge_u32 s2, 256
    s_cbranch_scc1 L_exit_1
    s_load_dwordx2 s[8:9], s[0:1], 88
    v_lshrrev_b32 v1, 6, v0
    s_nop 0
    v_readfirstlane_b32 s88, v1
    s_mov_b32 s10, 0x2000000
    s_mov_b32 s11, 0x20000
    s_and_b32 s27, s2, 7
    s_lshr_b32 s28, s2, 3
    s_and_b32 s23, s27, 1
    s_lshl_b32 s23, s23, 3
    s_and_b32 s29, s28, 7
    s_add_u32 s23, s23, s29
    s_lshr_b32 s20, s27, 1
    s_lshl_b32 s20, s20, 2
    s_lshr_b32 s29, s28, 3
    s_add_u32 s20, s20, s29
    s_lshr_b32 s21, s23, 3
    s_and_b32 s22, s23, 7
    s_mov_b32 s25, s20
    s_add_u32 s26, s20, 16
    s_lshl_b32 s24, s21, 4
    s_add_u32 s24, s24, s20
    s_lshl_b32 s20, s24, 1
    s_lshr_b32 s21, s22, 2
    s_add_u32 s20, s20, s21
    s_and_b32 s21, s22, 3
    v_and_b32 v1, 63, v0
    v_lshrrev_b32 v2, 3, v1
    v_and_b32 v3, 7, v1
    s_lshl_b32 s22, s88, 3
    v_add_u32 v4, s22, v2
    s_and_b32 s33, s20, 1
    s_lshl_b32 s33, s33, 5
    s_lshr_b32 s34, s20, 1
    s_add_u32 s33, s33, s34
    s_add_u32 s33, s33, 2032
    v_lshlrev_b32 v130, 4, v1
    v_lshlrev_b32 v5, 6, v4
    v_add_u32 v5, s33, v5
    v_and_b32 v5, 2047, v5
    v_lshlrev_b32 v5, 10, v5
    v_lshl_add_u32 v5, v3, 4, v5
    s_waitcnt lgkmcnt(0)
    s_mov_b32 s14, 0x200000
    s_mov_b32 s15, 0x20000
    buffer_load_dwordx4 v[16:19], v5, s[12:15], 0 offen offset:0
    buffer_load_dwordx4 v[20:23], v5, s[12:15], 0 offen offset:128
    buffer_load_dwordx4 v[24:27], v5, s[12:15], 0 offen offset:256
    buffer_load_dwordx4 v[28:31], v5, s[12:15], 0 offen offset:384
    buffer_load_dwordx4 v[32:35], v5, s[12:15], 0 offen offset:512
    buffer_load_dwordx4 v[36:39], v5, s[12:15], 0 offen offset:640
    buffer_load_dwordx4 v[40:43], v5, s[12:15], 0 offen offset:768
    buffer_load_dwordx4 v[44:47], v5, s[12:15], 0 offen offset:896
    s_cmp_lt_u32 s88, 2
    s_cselect_b32 s52, s52, s54
    s_cselect_b32 s53, s53, s55
    s_cmp_lt_u32 s2, 224
    s_cselect_b32 s54, 0x1c0000, 0
    s_mov_b32 s55, 0x20000
    s_mov_b32 s58, s54
    s_mov_b32 s59, 0x20000
    v_lshrrev_b32 v160, 3, v1
    v_mul_u32_u24 v160, 3584, v160
    v_and_b32 v161, 7, v1
    v_lshl_add_u32 v160, v161, 4, v160
    s_and_b32 s3, s2, 7
    s_lshl_b32 s3, s3, 1
    s_and_b32 s6, s88, 1
    s_add_u32 s3, s3, s6
    s_mul_i32 s3, s3, 114688
    s_lshr_b32 s6, s2, 3
    s_lshl_b32 s6, s6, 7
    s_add_u32 s3, s3, s6
    s_lshl_b32 s6, s88, 12
    s_add_u32 m0, s6, 16384
    s_add_u32 s89, s3, 0
    buffer_load_dwordx4 v160, s[52:55], s89 offen lds
    s_add_u32 m0, s6, 17408
    s_add_u32 s89, s3, 28672
    buffer_load_dwordx4 v160, s[52:55], s89 offen lds
    s_add_u32 m0, s6, 18432
    s_add_u32 s89, s3, 57344
    buffer_load_dwordx4 v160, s[52:55], s89 offen lds
    s_add_u32 m0, s6, 19456
    s_add_u32 s89, s3, 86016
    buffer_load_dwordx4 v160, s[52:55], s89 offen lds
    v_lshrrev_b32 v161, 5, v1
    v_and_b32 v162, 31, v1
    v_lshlrev_b32 v162, 4, v162
    v_lshl_add_u32 v161, v161, 10, v162
    s_lshr_b32 s3, s2, 1
    s_lshl_b32 s3, s3, 2
    s_add_u32 s3, s3, s88
    s_lshl_b32 s3, s3, 12
    s_and_b32 s6, s2, 1
    s_lshl_b32 s6, s6, 9
    s_add_u32 s3, s3, s6
    s_mul_i32 s6, s88, 2176
    s_add_u32 m0, s6, 32768
    s_add_u32 s89, s3, 0
    buffer_load_dwordx4 v161, s[56:59], s89 offen lds
    s_add_u32 m0, s6, 33856
    s_add_u32 s89, s3, 2048
    buffer_load_dwordx4 v161, s[56:59], s89 offen lds
    s_or_b32 s3, s2, s88
    s_cmp_lg_u32 s3, 0
    s_cbranch_scc1 L_non_5
    s_or_b32 s18, s18, 1
    v_mov_b32 v160, 0
    v_mov_b32 v162, s18
    v_mov_b32 v163, s19
    s_mov_b64 exec, 1
    global_store_dwordx2 v160, v[162:163], s[4:5] sc1
    s_mov_b32 s3, 0x5ffffc
    buffer_store_dword v160, v160, s[8:11], s3 offen sc1
    s_mov_b64 exec, -1
L_non_5:
    v_and_b32 v12, 15, v1
    v_lshrrev_b32 v13, 4, v1
    s_cmp_lt_u32 s88, 2
    s_cselect_b32 s25, 8, -252
    s_cmp_eq_u32 s21, 0
    s_cselect_b32 s25, s25, s21
    s_lshl_b32 s24, s88, 4
    v_add_u32 v14, s24, v12
    v_lshl_add_u32 v15, v14, 3, s25
    s_lshl_b32 s24, s21, 6
    v_add_u32 v6, s24, v14
    v_lshlrev_b32 v6, 2, v6
    v_lshl_add_u32 v7, v13, 18, v6
    v_cvt_f32_u32 v8, v15
    v_mul_f32 v8, 0x3b000000, v8
    v_lshlrev_b32 v9, 3, v13
    v_cvt_f32_u32 v9, v9
    v_mul_f32 v9, v9, v8
    v_mul_f32 v10, 0x42000000, v8
    v_add_f32 v10, v10, v9
    v_fract_f32 v64, v9
    v_add_f32 v9, v9, v8
    v_fract_f32 v65, v9
    v_add_f32 v9, v9, v8
    v_fract_f32 v66, v9
    v_add_f32 v9, v9, v8
    v_fract_f32 v67, v9
    v_add_f32 v9, v9, v8
    v_fract_f32 v68, v9
    v_add_f32 v9, v9, v8
    v_fract_f32 v69, v9
    v_add_f32 v9, v9, v8
    v_fract_f32 v70, v9
    v_add_f32 v9, v9, v8
    v_fract_f32 v71, v9
    v_cos_f32 v48, v64
    v_sin_f32 v56, v64
    v_cos_f32 v49, v65
    v_sin_f32 v57, v65
    v_cos_f32 v50, v66
    v_sin_f32 v58, v66
    v_cos_f32 v51, v67
    v_sin_f32 v59, v67
    v_cos_f32 v52, v68
    v_sin_f32 v60, v68
    v_cos_f32 v53, v69
    v_sin_f32 v61, v69
    v_cos_f32 v54, v70
    v_sin_f32 v62, v70
    v_cos_f32 v55, v71
    v_sin_f32 v63, v71
    v_cvt_pk_bf16_f32 v80, v48, v49
    v_cvt_pk_bf16_f32 v88, v56, v57
    v_cvt_pk_bf16_f32 v81, v50, v51
    v_cvt_pk_bf16_f32 v89, v58, v59
    v_cvt_pk_bf16_f32 v82, v52, v53
    v_cvt_pk_bf16_f32 v90, v60, v61
    v_cvt_pk_bf16_f32 v83, v54, v55
    v_cvt_pk_bf16_f32 v91, v62, v63
    v_fract_f32 v64, v10
    v_add_f32 v10, v10, v8
    v_fract_f32 v65, v10
    v_add_f32 v10, v10, v8
    v_fract_f32 v66, v10
    v_add_f32 v10, v10, v8
    v_fract_f32 v67, v10
    v_add_f32 v10, v10, v8
    v_fract_f32 v68, v10
    v_add_f32 v10, v10, v8
    v_fract_f32 v69, v10
    v_add_f32 v10, v10, v8
    v_fract_f32 v70, v10
    v_add_f32 v10, v10, v8
    v_fract_f32 v71, v10
    v_cos_f32 v48, v64
    v_sin_f32 v56, v64
    v_cos_f32 v49, v65
    v_sin_f32 v57, v65
    v_cos_f32 v50, v66
    v_sin_f32 v58, v66
    v_cos_f32 v51, v67
    v_sin_f32 v59, v67
    v_cos_f32 v52, v68
    v_sin_f32 v60, v68
    v_cos_f32 v53, v69
    v_sin_f32 v61, v69
    v_cos_f32 v54, v70
    v_sin_f32 v62, v70
    v_cos_f32 v55, v71
    v_sin_f32 v63, v71
    v_cvt_pk_bf16_f32 v84, v48, v49
    v_cvt_pk_bf16_f32 v92, v56, v57
    v_cvt_pk_bf16_f32 v85, v50, v51
    v_cvt_pk_bf16_f32 v93, v58, v59
    v_cvt_pk_bf16_f32 v86, v52, v53
    v_cvt_pk_bf16_f32 v94, v60, v61
    v_cvt_pk_bf16_f32 v87, v54, v55
    v_cvt_pk_bf16_f32 v95, v62, v63
    v_accvgpr_write_b32 a236, v80
    v_accvgpr_write_b32 a237, v81
    v_accvgpr_write_b32 a238, v82
    v_accvgpr_write_b32 a239, v83
    v_accvgpr_write_b32 a240, v84
    v_accvgpr_write_b32 a241, v85
    v_accvgpr_write_b32 a242, v86
    v_accvgpr_write_b32 a243, v87
    v_accvgpr_write_b32 a244, v88
    v_accvgpr_write_b32 a245, v89
    v_accvgpr_write_b32 a246, v90
    v_accvgpr_write_b32 a247, v91
    v_accvgpr_write_b32 a248, v92
    v_accvgpr_write_b32 a249, v93
    v_accvgpr_write_b32 a250, v94
    v_accvgpr_write_b32 a251, v95
    v_lshlrev_b32 v9, 8, v13
    v_add_u32 v9, s33, v9
    v_cvt_f32_u32 v9, v9
    v_cvt_f32_u32 v10, v12
    v_mul_f32 v10, 0x3a000000, v10
    v_add_f32 v11, 0xbc000000, v10
    v_add_f32 v64, 0x0, v9
    v_mul_f32 v64, v64, v11
    v_fract_f32 v64, v64
    v_add_f32 v65, 0x42800000, v9
    v_mul_f32 v65, v65, v11
    v_fract_f32 v65, v65
    v_add_f32 v66, 0x43000000, v9
    v_mul_f32 v66, v66, v11
    v_fract_f32 v66, v66
    v_add_f32 v67, 0x43400000, v9
    v_mul_f32 v67, v67, v11
    v_fract_f32 v67, v67
    v_add_f32 v68, 0x44800000, v9
    v_mul_f32 v68, v68, v11
    v_fract_f32 v68, v68
    v_add_f32 v69, 0x44880000, v9
    v_mul_f32 v69, v69, v11
    v_fract_f32 v69, v69
    v_add_f32 v70, 0x44900000, v9
    v_mul_f32 v70, v70, v11
    v_fract_f32 v70, v70
    v_add_f32 v71, 0x44980000, v9
    v_mul_f32 v71, v71, v11
    v_fract_f32 v71, v71
    v_cos_f32 v48, v64
    v_sin_f32 v56, v64
    v_cos_f32 v49, v65
    v_sin_f32 v57, v65
    v_cos_f32 v50, v66
    v_sin_f32 v58, v66
    v_cos_f32 v51, v67
    v_sin_f32 v59, v67
    v_cos_f32 v52, v68
    v_sin_f32 v60, v68
    v_cos_f32 v53, v69
    v_sin_f32 v61, v69
    v_cos_f32 v54, v70
    v_sin_f32 v62, v70
    v_cos_f32 v55, v71
    v_sin_f32 v63, v71
    v_cvt_pk_bf16_f32 v96, v48, v49
    v_cvt_pk_bf16_f32 v104, v56, v57
    v_cvt_pk_bf16_f32 v97, v50, v51
    v_cvt_pk_bf16_f32 v105, v58, v59
    v_cvt_pk_bf16_f32 v98, v52, v53
    v_cvt_pk_bf16_f32 v106, v60, v61
    v_cvt_pk_bf16_f32 v99, v54, v55
    v_cvt_pk_bf16_f32 v107, v62, v63
    v_mov_b32 v11, v10
    v_add_f32 v64, 0x0, v9
    v_mul_f32 v64, v64, v11
    v_fract_f32 v64, v64
    v_add_f32 v65, 0x42800000, v9
    v_mul_f32 v65, v65, v11
    v_fract_f32 v65, v65
    v_add_f32 v66, 0x43000000, v9
    v_mul_f32 v66, v66, v11
    v_fract_f32 v66, v66
    v_add_f32 v67, 0x43400000, v9
    v_mul_f32 v67, v67, v11
    v_fract_f32 v67, v67
    v_add_f32 v68, 0x44800000, v9
    v_mul_f32 v68, v68, v11
    v_fract_f32 v68, v68
    v_add_f32 v69, 0x44880000, v9
    v_mul_f32 v69, v69, v11
    v_fract_f32 v69, v69
    v_add_f32 v70, 0x44900000, v9
    v_mul_f32 v70, v70, v11
    v_fract_f32 v70, v70
    v_add_f32 v71, 0x44980000, v9
    v_mul_f32 v71, v71, v11
    v_fract_f32 v71, v71
    v_cos_f32 v48, v64
    v_sin_f32 v56, v64
    v_cos_f32 v49, v65
    v_sin_f32 v57, v65
    v_cos_f32 v50, v66
    v_sin_f32 v58, v66
    v_cos_f32 v51, v67
    v_sin_f32 v59, v67
    v_cos_f32 v52, v68
    v_sin_f32 v60, v68
    v_cos_f32 v53, v69
    v_sin_f32 v61, v69
    v_cos_f32 v54, v70
    v_sin_f32 v62, v70
    v_cos_f32 v55, v71
    v_sin_f32 v63, v71
    v_cvt_pk_bf16_f32 v100, v48, v49
    v_cvt_pk_bf16_f32 v108, v56, v57
    v_cvt_pk_bf16_f32 v101, v50, v51
    v_cvt_pk_bf16_f32 v109, v58, v59
    v_cvt_pk_bf16_f32 v102, v52, v53
    v_cvt_pk_bf16_f32 v110, v60, v61
    v_cvt_pk_bf16_f32 v103, v54, v55
    v_cvt_pk_bf16_f32 v111, v62, v63
    v_cvt_f32_u32 v128, s33
    v_mul_f32 v128, 0x3c800000, v128
    v_fract_f32 v128, v128
    v_sin_f32 v129, v128
    v_cos_f32 v128, v128
    s_mov_b32 s40, 0x3f800000
    s_mov_b32 s41, 0x3f800000
    s_mov_b32 s42, 0x3f800000
    s_mov_b32 s43, 0x3f800000
    s_mov_b32 s44, 0x3f800000
    s_mov_b32 s45, 0xbf800000
    s_mov_b32 s46, 0x3f800000
    s_mov_b32 s47, 0xbf800000
    s_mov_b32 s48, 0x3f80
    s_mov_b32 s49, 0x3f800000
    s_mov_b32 s50, 0xc1000000
    s_cmp_eq_u32 s21, 1
    s_cselect_b32 s40, 0x3f800000, s40
    s_cselect_b32 s41, 0x3f3504f3, s41
    s_cselect_b32 s42, 0x0, s42
    s_cselect_b32 s43, 0xbf3504f3, s43
    s_cselect_b32 s44, 0x0, s44
    s_cselect_b32 s45, 0xbf3504f3, s45
    s_cselect_b32 s46, 0xbf800000, s46
    s_cselect_b32 s47, 0xbf3504f3, s47
    s_cselect_b32 s48, 0xbf80, s48
    s_cselect_b32 s49, 0xbf800000, s49
    s_cselect_b32 s50, 0x0, s50
    s_cmp_eq_u32 s21, 2
    s_cselect_b32 s40, 0x3f800000, s40
    s_cselect_b32 s41, 0x0, s41
    s_cselect_b32 s42, 0xbf800000, s42
    s_cselect_b32 s43, 0x0, s43
    s_cselect_b32 s44, 0x0, s44
    s_cselect_b32 s45, 0xbf800000, s45
    s_cselect_b32 s46, 0x0, s46
    s_cselect_b32 s47, 0x3f800000, s47
    s_cselect_b32 s48, 0x3f80, s48
    s_cselect_b32 s49, 0x3f800000, s49
    s_cselect_b32 s50, 0x0, s50
    s_cmp_eq_u32 s21, 3
    s_cselect_b32 s40, 0x3f800000, s40
    s_cselect_b32 s41, 0xbf3504f3, s41
    s_cselect_b32 s42, 0x0, s42
    s_cselect_b32 s43, 0x3f3504f3, s43
    s_cselect_b32 s44, 0x0, s44
    s_cselect_b32 s45, 0xbf3504f3, s45
    s_cselect_b32 s46, 0x3f800000, s46
    s_cselect_b32 s47, 0xbf3504f3, s47
    s_cselect_b32 s48, 0xbf80, s48
    s_cselect_b32 s49, 0xbf800000, s49
    s_cselect_b32 s50, 0x0, s50
    s_and_b32 s24, s88, 1
    s_lshl_b32 s24, s24, 3
    v_add_u32 v8, s24, v2
    v_xor_b32 v8, v8, v3
    v_lshlrev_b32 v8, 4, v8
    v_lshl_add_u32 v8, v3, 8, v8
    s_lshr_b32 s24, s88, 1
    s_lshl_b32 s24, s24, 11
    s_add_u32 s24, s24, 0
    v_add_u32 v8, s24, v8
    v_xor_b32 v9, v12, v13
    v_lshlrev_b32 v9, 4, v9
    v_lshl_add_u32 v9, v13, 8, v9
    v_xor_b32 v10, 64, v9
    s_lshr_b32 s24, s88, 1
    s_lshl_b32 s24, s24, 12
    s_cmp_eq_u32 s21, 0
    s_cselect_b32 s24, s24, 0
    s_cselect_b32 s37, 0, -1
    s_add_u32 s24, s24, 0
    s_mov_b32 s25, 4096
    s_add_u32 s26, s24, 8192
    v_add_u32 v140, s24, v9
    v_add_u32 v141, s24, v10
    v_add_u32 v142, s25, v9
    v_add_u32 v143, s25, v10
    v_add_u32 v144, s26, v9
    v_add_u32 v145, s26, v10
    s_mov_b32 s30, 0x3f803f80
    s_mov_b32 s31, 0x3f80
    s_mov_b32 s32, 0x3f800000
    v_xor_b32 v112, 0x80008000, v104
    v_xor_b32 v113, 0x80008000, v105
    v_xor_b32 v114, 0x80008000, v106
    v_xor_b32 v115, 0x80008000, v107
    v_xor_b32 v116, 0x80008000, v108
    v_xor_b32 v117, 0x80008000, v109
    v_xor_b32 v118, 0x80008000, v110
    v_xor_b32 v119, 0x80008000, v111
    v_lshlrev_b32 v160, 4, v0
    v_mov_b32 v164, -1
    v_mov_b32 v165, -1
    v_mov_b32 v166, -1
    v_mov_b32 v167, -1
    v_lshrrev_b32 v161, 4, v1
    v_and_b32 v162, 15, v1
    v_lshlrev_b32 v162, 4, v162
    v_lshl_add_u32 v161, v161, 16, v162
    v_cmp_gt_u32 vcc, 16, v0
    v_mov_b32 v163, 0x7f000000
    s_nop 0
    v_cndmask_b32 v162, v163, v162, vcc
    s_and_b32 s3, s33, 63
    s_lshl_b32 s3, s3, 2
    s_add_u32 s3, s3, s21
    s_lshl_b32 s3, s3, 8
    s_add_u32 s6, s3, 0x800000
    s_lshl_b32 s89, s88, 19
    s_add_u32 s3, s3, s89
    s_add_u32 s89, s3, 0x600000
    buffer_store_dwordx4 v[164:167], v161, s[8:11], s89 offen sc1
    s_add_u32 s89, s3, 0x640000
    buffer_store_dwordx4 v[164:167], v161, s[8:11], s89 offen sc1
    buffer_store_dwordx4 v[164:167], v162, s[8:11], s6 offen sc1
    s_lshl_b32 s3, s2, 12
    s_add_u32 s89, s3, 0x820000
    buffer_store_dwordx4 v[164:167], v160, s[8:11], s89 offen sc1
    s_add_u32 s89, s3, 0x920000
    buffer_store_dwordx4 v[164:167], v160, s[8:11], s89 offen sc1
    s_add_u32 s89, s3, 0xa20000
    s_cmp_lt_u32 s2, 64
    s_cselect_b32 s89, s89, 0x7f000000
    buffer_store_dwordx4 v[164:167], v160, s[8:11], s89 offen sc1
    v_mov_b32 v160, 0
    global_load_dwordx2 v[220:221], v160, s[4:5] sc1
    v_bfe_u32 v160, v1, 2, 2
    v_lshrrev_b32 v161, 5, v1
    v_lshl_add_u32 v160, v161, 3, v160
    v_and_b32 v161, 1, v1
    v_bfe_u32 v162, v1, 1, 1
    v_lshl_add_u32 v161, v161, 1, v162
    v_lshlrev_b32 v161, 3, v161
    v_bfe_u32 v162, v1, 4, 1
    v_lshl_add_u32 v163, v160, 7, v161
    v_lshl_add_u32 v163, v162, 13, v163
    s_lshl_b32 s3, s88, 5
    s_add_u32 s3, s3, 16384
    v_add_u32 v163, s3, v163
    v_lshrrev_b32 v222, 1, v160
    v_mul_u32_u24 v222, 1088, v222
    v_and_b32 v160, 1, v160
    v_lshl_add_u32 v222, v160, 9, v222
    v_add_u32 v222, v222, v161
    v_lshl_add_u32 v222, v162, 5, v222
    s_lshl_b32 s3, s88, 7
    s_add_u32 s3, s3, 32768
    v_add_u32 v222, s3, v222
    s_lshr_b32 s3, s2, 3
    s_lshl_b32 s3, s3, 2
    s_add_u32 s3, s3, s88
    s_and_b32 s6, s2, 7
    s_lshl_b32 s98, s3, 15
    s_lshl_b32 s99, s6, 12
    s_add_u32 s98, s98, s99
    s_mul_i32 s99, s6, 14336
    s_lshl_b32 s3, s3, 7
    s_add_u32 s99, s99, s3
    s_add_u32 s99, s99, 0x540000
    s_lshr_b32 s3, s2, 1
    s_mul_i32 s6, s3, 147
    s_lshr_b32 s6, s6, 10
    s_mul_i32 s100, s6, 7
    s_sub_u32 s3, s3, s100
    s_lshl_b32 s3, s3, 2
    s_and_b32 s100, s6, 3
    s_add_u32 s3, s3, s100
    s_lshr_b32 s6, s6, 2
    s_mul_i32 s6, s6, 28
    s_add_u32 s3, s3, s6
    s_and_b32 s6, s2, 1
    s_lshl_b32 s6, s6, 2
    s_add_u32 s6, s6, s88
    s_mul_i32 s6, s6, 224
    s_add_u32 s3, s3, s6
    s_lshl_b32 s3, s3, 10
    s_add_u32 s100, s3, 0x380000
    s_cmp_lt_u32 s2, 224
    s_cselect_b32 s98, s98, 0x7f000000
    s_cselect_b32 s99, s99, 0x7f000000
    s_cselect_b32 s100, s100, 0x7f000000
    s_add_u32 s101, s100, 114688
    v_mov_b32 v216, 0x3f803f80
    v_mov_b32 v217, 0x3f803f80
    v_mov_b32 v218, 0x3f803f80
    v_mov_b32 v219, 0x3f803f80
    v_and_b32 v160, 31, v1
    v_cmp_eq_u32 s[52:53], 1, v160
    v_cmp_eq_u32 s[54:55], 2, v160
    v_cmp_eq_u32 s[56:57], 3, v160
    v_cmp_gt_u32 vcc, 4, v160
    v_lshrrev_b32 v161, 5, v1
    v_lshl_add_u32 v160, v161, 2, v160
    v_lshlrev_b32 v160, 4, v160
    v_mov_b32 v161, 0x7f000000
    v_cndmask_b32 v160, v161, v160, vcc
    s_waitcnt vmcnt(7)
    s_barrier
    ds_read_b64_tr_b16 v[168:169], v163 offset:0
    ds_read_b64_tr_b16 v[170:171], v163 offset:512
    ds_read_b64_tr_b16 v[172:173], v163 offset:2048
    ds_read_b64_tr_b16 v[174:175], v163 offset:2560
    ds_read_b64_tr_b16 v[176:177], v163 offset:4096
    ds_read_b64_tr_b16 v[178:179], v163 offset:4608
    ds_read_b64_tr_b16 v[180:181], v163 offset:6144
    ds_read_b64_tr_b16 v[182:183], v163 offset:6656
    ds_read_b64_tr_b16 v[184:185], v222 offset:0
    ds_read_b64_tr_b16 v[186:187], v222 offset:2176
    ds_read_b64_tr_b16 v[188:189], v222 offset:64
    ds_read_b64_tr_b16 v[190:191], v222 offset:2240
    s_waitcnt lgkmcnt(10)
    buffer_store_dwordx4 v[168:171], v130, s[8:11], s98 offen offset:0 sc1
    v_mfma_f32_32x32x16_bf16 v[200:215], v[168:171], v[216:219], 0
    s_waitcnt lgkmcnt(8)
    buffer_store_dwordx4 v[172:175], v130, s[8:11], s98 offen offset:1024 sc1
    v_mfma_f32_32x32x16_bf16 v[200:215], v[172:175], v[216:219], v[200:215]
    s_waitcnt lgkmcnt(6)
    buffer_store_dwordx4 v[176:179], v130, s[8:11], s98 offen offset:2048 sc1
    v_mfma_f32_32x32x16_bf16 v[200:215], v[176:179], v[216:219], v[200:215]
    s_waitcnt lgkmcnt(4)
    buffer_store_dwordx4 v[180:183], v130, s[8:11], s98 offen offset:3072 sc1
    v_mfma_f32_32x32x16_bf16 v[200:215], v[180:183], v[216:219], v[200:215]
    s_waitcnt lgkmcnt(2)
    buffer_store_dwordx4 v[184:187], v130, s[8:11], s100 offen sc1
    s_waitcnt lgkmcnt(0)
    buffer_store_dwordx4 v[188:191], v130, s[8:11], s101 offen sc1
    s_nop 7
    v_cndmask_b32 v200, v200, v204, s[52:53]
    v_cndmask_b32 v201, v201, v205, s[52:53]
    v_cndmask_b32 v202, v202, v206, s[52:53]
    v_cndmask_b32 v203, v203, v207, s[52:53]
    v_cndmask_b32 v200, v200, v208, s[54:55]
    v_cndmask_b32 v201, v201, v209, s[54:55]
    v_cndmask_b32 v202, v202, v210, s[54:55]
    v_cndmask_b32 v203, v203, v211, s[54:55]
    v_cndmask_b32 v200, v200, v212, s[56:57]
    v_cndmask_b32 v201, v201, v213, s[56:57]
    v_cndmask_b32 v202, v202, v214, s[56:57]
    v_cndmask_b32 v203, v203, v215, s[56:57]
    buffer_store_dwordx4 v[200:203], v160, s[8:11], s99 offen sc1
    s_waitcnt vmcnt(20)
    v_dot2_f32_bf16 v146, v16, s30, 0
    v_dot2_f32_bf16 v147, v17, s30, 0
    v_dot2_f32_bf16 v148, v18, s30, 0
    v_dot2_f32_bf16 v149, v19, s30, 0
    v_dot2_f32_bf16 v150, v16, v16, 0
    v_dot2_f32_bf16 v151, v17, v17, 0
    v_dot2_f32_bf16 v152, v18, v18, 0
    v_dot2_f32_bf16 v153, v19, v19, 0
    v_dot2_f32_bf16 v146, v20, s30, v146
    v_dot2_f32_bf16 v147, v21, s30, v147
    v_dot2_f32_bf16 v148, v22, s30, v148
    v_dot2_f32_bf16 v149, v23, s30, v149
    v_dot2_f32_bf16 v150, v20, v20, v150
    v_dot2_f32_bf16 v151, v21, v21, v151
    v_dot2_f32_bf16 v152, v22, v22, v152
    v_dot2_f32_bf16 v153, v23, v23, v153
    v_dot2_f32_bf16 v146, v24, s30, v146
    v_dot2_f32_bf16 v147, v25, s30, v147
    v_dot2_f32_bf16 v148, v26, s30, v148
    v_dot2_f32_bf16 v149, v27, s30, v149
    v_dot2_f32_bf16 v150, v24, v24, v150
    v_dot2_f32_bf16 v151, v25, v25, v151
    v_dot2_f32_bf16 v152, v26, v26, v152
    v_dot2_f32_bf16 v153, v27, v27, v153
    v_dot2_f32_bf16 v146, v28, s30, v146
    v_dot2_f32_bf16 v147, v29, s30, v147
    v_dot2_f32_bf16 v148, v30, s30, v148
    v_dot2_f32_bf16 v149, v31, s30, v149
    v_dot2_f32_bf16 v150, v28, v28, v150
    v_dot2_f32_bf16 v151, v29, v29, v151
    v_dot2_f32_bf16 v152, v30, v30, v152
    v_dot2_f32_bf16 v153, v31, v31, v153
    v_dot2_f32_bf16 v146, v32, s30, v146
    v_dot2_f32_bf16 v147, v33, s30, v147
    v_dot2_f32_bf16 v148, v34, s30, v148
    v_dot2_f32_bf16 v149, v35, s30, v149
    v_dot2_f32_bf16 v150, v32, v32, v150
    v_dot2_f32_bf16 v151, v33, v33, v151
    v_dot2_f32_bf16 v152, v34, v34, v152
    v_dot2_f32_bf16 v153, v35, v35, v153
    v_dot2_f32_bf16 v146, v36, s30, v146
    v_dot2_f32_bf16 v147, v37, s30, v147
    v_dot2_f32_bf16 v148, v38, s30, v148
    v_dot2_f32_bf16 v149, v39, s30, v149
    v_dot2_f32_bf16 v150, v36, v36, v150
    v_dot2_f32_bf16 v151, v37, v37, v151
    v_dot2_f32_bf16 v152, v38, v38, v152
    v_dot2_f32_bf16 v153, v39, v39, v153
    v_dot2_f32_bf16 v146, v40, s30, v146
    v_dot2_f32_bf16 v147, v41, s30, v147
    v_dot2_f32_bf16 v148, v42, s30, v148
    v_dot2_f32_bf16 v149, v43, s30, v149
    v_dot2_f32_bf16 v150, v40, v40, v150
    v_dot2_f32_bf16 v151, v41, v41, v151
    v_dot2_f32_bf16 v152, v42, v42, v152
    v_dot2_f32_bf16 v153, v43, v43, v153
    v_dot2_f32_bf16 v146, v44, s30, v146
    v_dot2_f32_bf16 v147, v45, s30, v147
    v_dot2_f32_bf16 v148, v46, s30, v148
    v_dot2_f32_bf16 v149, v47, s30, v149
    v_dot2_f32_bf16 v150, v44, v44, v150
    v_dot2_f32_bf16 v151, v45, v45, v151
    v_dot2_f32_bf16 v152, v46, v46, v152
    v_dot2_f32_bf16 v153, v47, v47, v153
    v_dot2_f32_bf16 v48, v16, s31, 0
    v_dot2_f32_bf16 v49, v16, s32, 0
    v_dot2_f32_bf16 v50, v20, s31, 0
    v_dot2_f32_bf16 v51, v20, s32, 0
    v_add_f32 v146, v146, v147
    v_dot2_f32_bf16 v52, v24, s31, 0
    v_dot2_f32_bf16 v53, v24, s32, 0
    v_add_f32 v148, v148, v149
    v_dot2_f32_bf16 v54, v28, s31, 0
    v_dot2_f32_bf16 v55, v28, s32, 0
    v_add_f32 v150, v150, v151
    v_dot2_f32_bf16 v48, v32, s48, v48
    v_dot2_f32_bf16 v49, v32, s49, v49
    v_add_f32 v152, v152, v153
    v_dot2_f32_bf16 v50, v36, s48, v50
    v_dot2_f32_bf16 v51, v36, s49, v51
    v_add_f32 v146, v146, v148
    v_dot2_f32_bf16 v52, v40, s48, v52
    v_dot2_f32_bf16 v53, v40, s49, v53
    v_add_f32 v150, v150, v152
    v_dot2_f32_bf16 v54, v44, s48, v54
    v_dot2_f32_bf16 v55, v44, s49, v55
    v_add_f32_dpp v146, v146, v146 quad_perm:[1,0,3,2] row_mask:0xf bank_mask:0xf
    v_dot2_f32_bf16 v56, v17, s31, 0
    v_dot2_f32_bf16 v57, v17, s32, 0
    v_add_f32_dpp v150, v150, v150 quad_perm:[1,0,3,2] row_mask:0xf bank_mask:0xf
    v_dot2_f32_bf16 v58, v21, s31, 0
    v_dot2_f32_bf16 v59, v21, s32, 0
    v_add_f32_dpp v146, v146, v146 quad_perm:[2,3,0,1] row_mask:0xf bank_mask:0xf
    v_dot2_f32_bf16 v60, v25, s31, 0
    v_dot2_f32_bf16 v61, v25, s32, 0
    v_add_f32_dpp v150, v150, v150 quad_perm:[2,3,0,1] row_mask:0xf bank_mask:0xf
    v_dot2_f32_bf16 v62, v29, s31, 0
    v_dot2_f32_bf16 v63, v29, s32, 0
    v_add_f32_dpp v146, v146, v146 row_half_mirror row_mask:0xf bank_mask:0xf
    v_dot2_f32_bf16 v56, v33, s48, v56
    v_dot2_f32_bf16 v57, v33, s49, v57
    v_add_f32_dpp v150, v150, v150 row_half_mirror row_mask:0xf bank_mask:0xf
    v_dot2_f32_bf16 v58, v37, s48, v58
    v_dot2_f32_bf16 v59, v37, s49, v59
    v_mul_f32 v146, 0x3b000000, v146
    v_dot2_f32_bf16 v60, v41, s48, v60
    v_dot2_f32_bf16 v61, v41, s49, v61
    v_mul_f32 v150, 0x3b000000, v150
    v_dot2_f32_bf16 v62, v45, s48, v62
    v_dot2_f32_bf16 v63, v45, s49, v63
    v_fma_f32 v150, -v146, v146, v150
    v_dot2_f32_bf16 v64, v18, s31, 0
    v_dot2_f32_bf16 v65, v18, s32, 0
    v_max_f32 v150, 0, v150
    v_dot2_f32_bf16 v66, v22, s31, 0
    v_dot2_f32_bf16 v67, v22, s32, 0
    v_add_f32 v150, 0x3727c5ac, v150
    v_dot2_f32_bf16 v68, v26, s31, 0
    v_dot2_f32_bf16 v69, v26, s32, 0
    v_rsq_f32 v150, v150
    v_dot2_f32_bf16 v70, v30, s31, 0
    v_dot2_f32_bf16 v71, v30, s32, 0
    v_mul_f32 v146, s50, v146
    v_dot2_f32_bf16 v64, v34, s48, v64
    v_dot2_f32_bf16 v65, v34, s49, v65
    v_mul_f32 v146, v146, v150
    v_dot2_f32_bf16 v66, v38, s48, v66
    v_dot2_f32_bf16 v67, v38, s49, v67
    v_mul_f32 v120, s40, v150
    v_dot2_f32_bf16 v68, v42, s48, v68
    v_dot2_f32_bf16 v69, v42, s49, v69
    v_mul_f32 v121, s40, v150
    v_dot2_f32_bf16 v70, v46, s48, v70
    v_dot2_f32_bf16 v71, v46, s49, v71
    v_mul_f32 v122, s41, v150
    v_dot2_f32_bf16 v72, v19, s31, 0
    v_dot2_f32_bf16 v73, v19, s32, 0
    v_mul_f32 v123, s41, v150
    v_dot2_f32_bf16 v74, v23, s31, 0
    v_dot2_f32_bf16 v75, v23, s32, 0
    v_mul_f32 v124, s42, v150
    v_dot2_f32_bf16 v76, v27, s31, 0
    v_dot2_f32_bf16 v77, v27, s32, 0
    v_mul_f32 v125, s42, v150
    v_dot2_f32_bf16 v78, v31, s31, 0
    v_dot2_f32_bf16 v79, v31, s32, 0
    v_mul_f32 v126, s43, v150
    v_dot2_f32_bf16 v72, v35, s48, v72
    v_dot2_f32_bf16 v73, v35, s49, v73
    v_mul_f32 v127, s43, v150
    v_dot2_f32_bf16 v74, v39, s48, v74
    v_dot2_f32_bf16 v75, v39, s49, v75
    v_mul_f32 v132, s44, v150
    v_dot2_f32_bf16 v76, v43, s48, v76
    v_dot2_f32_bf16 v77, v43, s49, v77
    v_mul_f32 v133, s44, v150
    v_dot2_f32_bf16 v78, v47, s48, v78
    v_dot2_f32_bf16 v79, v47, s49, v79
    v_mul_f32 v134, s45, v150
    v_mul_f32 v135, s45, v150
    v_mul_f32 v136, s46, v150
    v_mul_f32 v137, s46, v150
    v_mul_f32 v138, s47, v150
    v_mul_f32 v139, s47, v150
    v_mov_b32 v147, v146
    v_pk_fma_f32 v[16:17], v[48:49], v[120:121], v[146:147]
    v_pk_mul_f32 v[24:25], v[48:49], v[132:133]
    v_pk_fma_f32 v[18:19], v[56:57], v[120:121], v[146:147]
    v_pk_mul_f32 v[26:27], v[56:57], v[132:133]
    v_pk_fma_f32 v[20:21], v[64:65], v[120:121], v[146:147]
    v_pk_mul_f32 v[28:29], v[64:65], v[132:133]
    v_pk_fma_f32 v[22:23], v[72:73], v[120:121], v[146:147]
    v_pk_mul_f32 v[30:31], v[72:73], v[132:133]
    v_pk_fma_f32 v[16:17], v[50:51], v[122:123], v[16:17]
    v_pk_fma_f32 v[24:25], v[50:51], v[134:135], v[24:25]
    v_pk_fma_f32 v[18:19], v[58:59], v[122:123], v[18:19]
    v_pk_fma_f32 v[26:27], v[58:59], v[134:135], v[26:27]
    v_pk_fma_f32 v[20:21], v[66:67], v[122:123], v[20:21]
    v_pk_fma_f32 v[28:29], v[66:67], v[134:135], v[28:29]
    v_pk_fma_f32 v[22:23], v[74:75], v[122:123], v[22:23]
    v_pk_fma_f32 v[30:31], v[74:75], v[134:135], v[30:31]
    v_pk_fma_f32 v[16:17], v[52:53], v[124:125], v[16:17]
    v_pk_fma_f32 v[24:25], v[52:53], v[136:137], v[24:25]
    v_pk_fma_f32 v[18:19], v[60:61], v[124:125], v[18:19]
    v_pk_fma_f32 v[26:27], v[60:61], v[136:137], v[26:27]
    v_pk_fma_f32 v[20:21], v[68:69], v[124:125], v[20:21]
    v_pk_fma_f32 v[28:29], v[68:69], v[136:137], v[28:29]
    v_pk_fma_f32 v[22:23], v[76:77], v[124:125], v[22:23]
    v_pk_fma_f32 v[30:31], v[76:77], v[136:137], v[30:31]
    v_pk_fma_f32 v[16:17], v[54:55], v[126:127], v[16:17]
    v_pk_fma_f32 v[24:25], v[54:55], v[138:139], v[24:25]
    v_pk_fma_f32 v[18:19], v[62:63], v[126:127], v[18:19]
    v_pk_fma_f32 v[26:27], v[62:63], v[138:139], v[26:27]
    v_pk_fma_f32 v[20:21], v[70:71], v[126:127], v[20:21]
    v_pk_fma_f32 v[28:29], v[70:71], v[138:139], v[28:29]
    v_pk_fma_f32 v[22:23], v[78:79], v[126:127], v[22:23]
    v_pk_fma_f32 v[30:31], v[78:79], v[138:139], v[30:31]
    v_cvt_pk_bf16_f32 v32, v16, v17
    v_cvt_pk_bf16_f32 v36, v24, v25
    v_cvt_pk_bf16_f32 v33, v18, v19
    v_cvt_pk_bf16_f32 v37, v26, v27
    v_cvt_pk_bf16_f32 v34, v20, v21
    v_cvt_pk_bf16_f32 v38, v28, v29
    v_cvt_pk_bf16_f32 v35, v22, v23
    v_cvt_pk_bf16_f32 v39, v30, v31
    ds_write_b128 v8, v[32:35] offset:0
    ds_write_b128 v8, v[36:39] offset:4096
    v_xor_b32 v40, 0x80008000, v32
    v_xor_b32 v44, 0x80008000, v36
    v_xor_b32 v41, 0x80008000, v33
    v_xor_b32 v45, 0x80008000, v37
    v_xor_b32 v42, 0x80008000, v34
    v_xor_b32 v46, 0x80008000, v38
    v_xor_b32 v43, 0x80008000, v35
    v_xor_b32 v47, 0x80008000, v39
    ds_write_b128 v8, v[40:43] offset:8192
    ds_write_b128 v8, v[44:47] offset:12288
    s_waitcnt vmcnt(0) lgkmcnt(0)
    s_barrier
    v_readfirstlane_b32 s18, v220
    v_readfirstlane_b32 s19, v221
    s_cmp_eq_u32 s18, 0
    s_cbranch_scc1 L_tagsp_7
L_tag_6:
    v_cmp_eq_u32 vcc, 0, v0
    v_mov_b32 v161, 0x7f000000
    s_nop 0
    v_cndmask_b32 v160, v161, v0, vcc
    s_lshl_b32 s3, s2, 7
    s_add_u32 s3, s3, 0x570000
    buffer_store_dwordx2 v[220:221], v160, s[8:11], s3 offen sc1
    ds_read_b128 v[48:51], v140 offset:0
    ds_read_b128 v[64:67], v142 offset:0
    ds_read_b128 v[16:19], v144 offset:0
    ds_read_b128 v[52:55], v141 offset:1024
    ds_read_b128 v[68:71], v143 offset:1024
    ds_read_b128 v[20:23], v145 offset:1024
    ds_read_b128 v[56:59], v140 offset:2048
    ds_read_b128 v[72:75], v142 offset:2048
    ds_read_b128 v[24:27], v144 offset:2048
    ds_read_b128 v[60:63], v141 offset:3072
    ds_read_b128 v[76:79], v143 offset:3072
    ds_read_b128 v[28:31], v145 offset:3072
    v_and_b32 v40, s37, v80
    v_and_b32 v146, s37, v88
    v_and_b32 v41, s37, v81
    v_and_b32 v147, s37, v89
    v_and_b32 v42, s37, v82
    v_and_b32 v148, s37, v90
    v_and_b32 v43, s37, v83
    v_and_b32 v149, s37, v91
    v_and_b32 v44, s37, v84
    v_and_b32 v150, s37, v92
    v_and_b32 v45, s37, v85
    v_and_b32 v151, s37, v93
    v_and_b32 v46, s37, v86
    v_and_b32 v152, s37, v94
    v_and_b32 v47, s37, v87
    v_and_b32 v153, s37, v95
    s_waitcnt lgkmcnt(9)
    v_mfma_f32_16x16x32_bf16 v[120:123], v[48:51], v[80:83], 0
    v_mfma_f32_16x16x32_bf16 v[132:135], v[64:67], v[40:43], 0
    v_mfma_f32_16x16x32_bf16 v[120:123], v[64:67], v[146:149], v[120:123]
    v_mfma_f32_16x16x32_bf16 v[132:135], v[16:19], v[88:91], v[132:135]
    s_waitcnt lgkmcnt(6)
    v_mfma_f32_16x16x32_bf16 v[120:123], v[52:55], v[84:87], v[120:123]
    v_mfma_f32_16x16x32_bf16 v[132:135], v[68:71], v[44:47], v[132:135]
    v_mfma_f32_16x16x32_bf16 v[120:123], v[68:71], v[150:153], v[120:123]
    v_mfma_f32_16x16x32_bf16 v[132:135], v[20:23], v[92:95], v[132:135]
    s_waitcnt lgkmcnt(3)
    v_mfma_f32_16x16x32_bf16 v[124:127], v[56:59], v[80:83], 0
    v_mfma_f32_16x16x32_bf16 v[136:139], v[72:75], v[40:43], 0
    v_mfma_f32_16x16x32_bf16 v[124:127], v[72:75], v[146:149], v[124:127]
    v_mfma_f32_16x16x32_bf16 v[136:139], v[24:27], v[88:91], v[136:139]
    s_waitcnt lgkmcnt(0)
    v_mfma_f32_16x16x32_bf16 v[124:127], v[60:63], v[84:87], v[124:127]
    v_mfma_f32_16x16x32_bf16 v[136:139], v[76:79], v[44:47], v[136:139]
    v_mfma_f32_16x16x32_bf16 v[124:127], v[76:79], v[150:153], v[124:127]
    v_mfma_f32_16x16x32_bf16 v[136:139], v[28:31], v[92:95], v[136:139]
    v_cvt_pk_bf16_f32 v32, v120, v121
    v_cvt_pk_bf16_f32 v36, v132, v133
    v_cvt_pk_bf16_f32 v33, v122, v123
    v_cvt_pk_bf16_f32 v37, v134, v135
    s_nop 2
    v_cvt_pk_bf16_f32 v34, v124, v125
    v_cvt_pk_bf16_f32 v38, v136, v137
    v_cvt_pk_bf16_f32 v35, v126, v127
    v_cvt_pk_bf16_f32 v39, v138, v139
    s_nop 1
    v_mfma_f32_16x16x32_bf16 v[48:51], v[96:99], v[32:35], 0
    v_mfma_f32_16x16x32_bf16 v[56:59], v[96:99], v[36:39], 0
    v_mfma_f32_16x16x32_bf16 v[52:55], v[100:103], v[32:35], 0
    v_mfma_f32_16x16x32_bf16 v[60:63], v[100:103], v[36:39], 0
    v_mfma_f32_16x16x32_bf16 v[48:51], v[104:107], v[36:39], v[48:51]
    v_mfma_f32_16x16x32_bf16 v[56:59], v[112:115], v[32:35], v[56:59]
    v_mfma_f32_16x16x32_bf16 v[52:55], v[108:111], v[36:39], v[52:55]
    v_mfma_f32_16x16x32_bf16 v[60:63], v[116:119], v[32:35], v[60:63]
    s_and_b32 s23, s33, 63
    s_lshl_b32 s23, s23, 10
    s_add_u32 s23, s23, 0x600000
    s_nop 2
    v_cvt_pk_bf16_f32 v64, v48, v56
    s_add_u32 s24, s23, 0
    buffer_store_dword v64, v7, s[8:11], s24 offen sc1
    v_cvt_pk_bf16_f32 v65, v49, v57
    s_add_u32 s24, s23, 65536
    buffer_store_dword v65, v7, s[8:11], s24 offen sc1
    v_cvt_pk_bf16_f32 v66, v50, v58
    s_add_u32 s24, s23, 131072
    buffer_store_dword v66, v7, s[8:11], s24 offen sc1
    v_cvt_pk_bf16_f32 v67, v51, v59
    s_add_u32 s24, s23, 196608
    buffer_store_dword v67, v7, s[8:11], s24 offen sc1
    v_cvt_pk_bf16_f32 v68, v52, v60
    s_add_u32 s24, s23, 1048576
    buffer_store_dword v68, v7, s[8:11], s24 offen sc1
    v_cvt_pk_bf16_f32 v69, v53, v61
    s_add_u32 s24, s23, 1114112
    buffer_store_dword v69, v7, s[8:11], s24 offen sc1
    v_cvt_pk_bf16_f32 v70, v54, v62
    s_add_u32 s24, s23, 1179648
    buffer_store_dword v70, v7, s[8:11], s24 offen sc1
    v_cvt_pk_bf16_f32 v71, v55, v63
    s_add_u32 s24, s23, 1245184
    buffer_store_dword v71, v7, s[8:11], s24 offen sc1
    v_mul_f32 v72, v48, v128
    v_mul_f32 v73, v56, v128
    v_fmac_f32 v72, v56, v129
    v_fma_f32 v73, -v48, v129, v73
    v_cvt_pk_bf16_f32 v72, v72, v73
    s_add_u32 s24, s23, 2097152
    s_mov_b64 exec, 0xffff
    buffer_store_dword v72, v7, s[8:11], s24 offen sc1
    s_mov_b64 exec, -1
    s_and_b32 s27, s2, 7
    s_lshr_b32 s28, s2, 3
    s_and_b32 s23, s27, 1
    s_lshl_b32 s23, s23, 3
    s_and_b32 s29, s28, 7
    s_add_u32 s23, s23, s29
    s_lshr_b32 s20, s27, 1
    s_lshl_b32 s20, s20, 2
    s_lshr_b32 s29, s28, 3
    s_add_u32 s20, s20, s29
    s_lshr_b32 s21, s23, 3
    s_and_b32 s22, s23, 7
    s_mov_b32 s25, s20
    s_add_u32 s26, s20, 16
    s_lshl_b32 s24, s21, 4
    s_add_u32 s24, s24, s20
    v_and_b32 v1, 63, v0
    v_lshlrev_b32 v2, 4, v1
    s_mul_i32 s43, s23, 7
    s_lshl_b32 s44, s43, 15
    s_lshl_b32 s45, s88, 12
    s_add_u32 s59, s44, 0x27c00
    s_add_u32 s44, s44, s45
    s_lshl_b32 s47, s43, 7
    s_add_u32 s47, s47, 0x540000
    s_and_b32 s41, s88, 1
    s_lshr_b32 s39, s88, 1
    s_mul_i32 s48, s88, 28
    s_lshl_b32 s49, s22, 1
    s_add_u32 s58, s49, s41
    s_xor_b32 s49, s58, 1
    s_mul_i32 s53, s58, 112
    s_mul_i32 s49, s49, 112
    s_add_u32 s53, s53, s48
    s_add_u32 s49, s49, s48
    s_lshl_b32 s53, s53, 10
    s_lshl_b32 s49, s49, 10
    s_add_u32 s98, s53, 0x380000
    s_add_u32 s99, s49, 0x380000
    v_and_b32 v201, 63, v0
    v_bfe_u32 v204, v201, 2, 3
    s_cmp_ge_u32 s22, 4
    s_cselect_b32 s36, 0x11, 0
    s_or_b32 s36, s36, 0xe0
    v_lshrrev_b32 v205, v204, s36
    v_and_b32 v205, 1, v205
    v_cmp_eq_u32 vcc, 1, v205
    v_sub_u32 v206, 8, v204
    v_and_b32 v206, 7, v206
    s_lshl_b32 s37, s22, 3
    s_sub_u32 s38, 56, s37
    s_and_b32 s37, s37, 0x30
    s_and_b32 s38, s38, 0x30
    v_mov_b32 v207, s37
    v_mov_b32 v208, s38
    v_cndmask_b32 v206, v204, v206, vcc
    v_cndmask_b32 v207, v207, v208, vcc
    s_sub_u32 s38, 32, s24
    v_mov_b32 v208, s24
    v_mov_b32 v209, s38
    v_cndmask_b32 v208, v208, v209, vcc
    v_and_b32 v209, 3, v206
    v_lshl_add_u32 v207, v209, 6, v207
    v_lshrrev_b32 v209, 2, v206
    v_lshl_add_u32 v207, v209, 5, v207
    v_mul_u32_u24 v209, 3, v205
    v_lshrrev_b32 v210, 1, v204
    v_xor_b32 v209, v209, v210
    v_xor_b32 v209, v209, v201
    v_and_b32 v209, 3, v209
    v_lshl_add_u32 v207, v209, 2, v207
    v_or_b32 v205, v205, v206
    v_cmp_eq_u32 vcc, 0, v205
    v_lshlrev_b32 v208, 14, v208
    v_add_u32 v207, v207, v208
    v_lshrrev_b32 v209, 5, v201
    v_lshl_add_u32 v207, v209, 8, v207
    v_subb_co_u32 v207, vcc, v207, 0, vcc
    v_add_u32 v207, 1, v207
    v_lshlrev_b32 v207, 2, v207
    s_lshl_b32 s4, s88, 14
    s_add_u32 s4, s4, 0x5ffffc
    s_lshl_b32 s5, s88, 13
    v_and_b32 v202, 31, v201
    v_lshrrev_b32 v203, 5, v201
    s_and_b32 s27, s88, 1
    s_lshr_b32 s34, s88, 1
    s_lshl_b32 s35, s22, 1
    s_add_u32 s35, s35, s27
    v_lshlrev_b32 v213, 4, v201
    s_lshl_b32 s37, s24, 1
    s_add_u32 s36, s37, s34
    s_lshl_b32 s37, s34, 5
    s_add_u32 s37, s37, s24
    s_add_u32 s37, s37, 2032
    v_lshlrev_b32 v212, 6, v202
    v_add_u32 v212, s37, v212
    v_and_b32 v212, 2047, v212
    v_lshlrev_b32 v212, 10, v212
    v_lshl_add_u32 v212, v203, 4, v212
    s_lshl_b32 s38, s35, 6
    buffer_load_dwordx4 v[96:99], v212, s[12:15], s38 offen
    buffer_load_dwordx4 v[100:103], v212, s[12:15], s38 offen offset:32
    s_lshl_b32 s37, s36, 15
    s_lshl_b32 s38, s35, 11
    s_add_u32 s37, s37, s38
    v_and_b32 v204, 3, v202
    v_bfe_u32 v205, v202, 3, 1
    v_lshl_add_u32 v204, v205, 2, v204
    v_bfe_u32 v205, v202, 4, 1
    v_bfe_u32 v206, v202, 2, 1
    v_lshl_add_u32 v205, v205, 1, v206
    s_lshl_b32 s38, s27, 2
    v_add_u32 v205, s38, v205
    s_cmp_ge_u32 s22, 4
    s_cselect_b32 s38, 0x11, 0
    s_or_b32 s38, s38, 0xe0
    v_lshrrev_b32 v206, v204, s38
    v_and_b32 v206, 1, v206
    v_lshlrev_b32 v214, 31, v206
    v_mul_u32_u24 v206, 3, v206
    v_xor_b32 v206, v206, v205
    s_and_b32 s38, s22, 1
    s_lshl_b32 s38, s38, 3
    v_xor_b32 v206, s38, v206
    v_lshrrev_b32 v208, 1, v204
    v_lshlrev_b32 v208, 2, v208
    v_xor_b32 v206, v206, v208
    v_lshl_add_u32 v206, v204, 4, v206
    v_lshl_add_u32 v206, v203, 9, v206
    v_lshlrev_b32 v208, 2, v206
    v_add_u32 v208, 0x20000, v208
    v_or_b32 v204, v204, v205
    v_or_b32 v204, s22, v204
    v_cmp_ne_u32 vcc, 0, v204
    s_nop 1
    v_cndmask_b32 v209, 0, -1, vcc
    v_lshl_add_u32 v211, v202, 1, s34
    v_cvt_f32_u32 v211, v211
    v_mul_f32 v211, 0x3c800000, v211
    v_lshlrev_b32 v210, 2, v203
    v_cvt_f32_u32 v210, v210
    v_mul_f32 v210, v210, v211
    v_mul_f32 v215, 0x40a00000, v211
    v_fract_f32 v104, v210
    v_add_f32 v210, v210, v211
    v_fract_f32 v105, v210
    v_add_f32 v210, v210, v211
    v_fract_f32 v106, v210
    v_add_f32 v210, v210, v211
    v_fract_f32 v107, v210
    v_cos_f32 v108, v104
    v_sin_f32 v112, v104
    v_cos_f32 v109, v105
    v_sin_f32 v113, v105
    v_cos_f32 v110, v106
    v_sin_f32 v114, v106
    v_cos_f32 v111, v107
    v_sin_f32 v115, v107
    v_cvt_pk_bf16_f32 v48, v108, v112
    v_cvt_pk_bf16_f32 v49, v109, v113
    v_cvt_pk_bf16_f32 v50, v110, v114
    v_cvt_pk_bf16_f32 v51, v111, v115
    v_add_f32 v210, v210, v215
    v_fract_f32 v104, v210
    v_add_f32 v210, v210, v211
    v_fract_f32 v105, v210
    v_add_f32 v210, v210, v211
    v_fract_f32 v106, v210
    v_add_f32 v210, v210, v211
    v_fract_f32 v107, v210
    v_cos_f32 v108, v104
    v_sin_f32 v112, v104
    v_cos_f32 v109, v105
    v_sin_f32 v113, v105
    v_cos_f32 v110, v106
    v_sin_f32 v114, v106
    v_cos_f32 v111, v107
    v_sin_f32 v115, v107
    v_cvt_pk_bf16_f32 v52, v108, v112
    v_cvt_pk_bf16_f32 v53, v109, v113
    v_cvt_pk_bf16_f32 v54, v110, v114
    v_cvt_pk_bf16_f32 v55, v111, v115
    s_lshl_b32 s38, s34, 15
    v_and_b32 v210, 1, v202
    v_sub_u32 v210, 0, v210
    v_and_b32 v210, 0x80008000, v210
    v_xor_b32 v210, s38, v210
    s_lshl_b32 s38, s34, 4
    s_mul_i32 s31, s34, 0x80008000
    v_alignbit_b32 v56, v48, v48, s38
    v_alignbit_b32 v57, v49, v49, s38
    v_alignbit_b32 v58, v50, v50, s38
    v_alignbit_b32 v59, v51, v51, s38
    v_alignbit_b32 v60, v52, v52, s38
    v_alignbit_b32 v61, v53, v53, s38
    v_alignbit_b32 v62, v54, v54, s38
    v_alignbit_b32 v63, v55, v55, s38
    v_xor_b32 v56, v210, v56
    v_xor_b32 v57, v210, v57
    v_xor_b32 v58, v210, v58
    v_xor_b32 v59, v210, v59
    v_xor_b32 v60, v210, v60
    v_xor_b32 v61, v210, v61
    v_xor_b32 v62, v210, v62
    v_xor_b32 v63, v210, v63
    v_xor_b32 v64, s31, v48
    v_xor_b32 v65, s31, v49
    v_xor_b32 v66, s31, v50
    v_xor_b32 v67, s31, v51
    v_xor_b32 v68, s31, v52
    v_xor_b32 v69, s31, v53
    v_xor_b32 v70, s31, v54
    v_xor_b32 v71, s31, v55
    v_xor_b32 v72, s31, v56
    v_xor_b32 v73, s31, v57
    v_xor_b32 v74, s31, v58
    v_xor_b32 v75, s31, v59
    v_xor_b32 v76, s31, v60
    v_xor_b32 v77, s31, v61
    v_xor_b32 v78, s31, v62
    v_xor_b32 v79, s31, v63
    s_mov_b32 s31, 0x3f803f80
    s_add_u32 s37, s37, 0x820000
    s_lshl_b32 s36, s36, 12
    s_lshl_b32 s38, s22, 9
    s_add_u32 s36, s36, s38
    s_lshl_b32 s38, s27, 3
    s_add_u32 s36, s36, s38
    s_add_u32 s36, s36, 0xa20000
    v_lshlrev_b32 v212, 4, v202
    v_lshlrev_b32 v210, 7, v0
    s_mov_b32 s3, 0x570000
    buffer_load_dwordx2 v[216:217], v210, s[8:11], s3 offen sc1
    v_lshlrev_b32 v218, 4, v0
    v_mov_b32 v232, -1
    v_mov_b32 v233, -1
    v_mov_b32 v234, -1
    v_mov_b32 v235, -1
    s_lshl_b32 s3, s2, 12
    s_add_u32 s89, s3, 0xa60000
    buffer_store_dwordx4 v[232:235], v218, s[8:11], s89 offen sc1
    s_add_u32 s89, s3, 0xb60000
    buffer_store_dwordx4 v[232:235], v218, s[8:11], s89 offen sc1
    s_add_u32 s89, s3, 0xc60000
    buffer_store_dwordx4 v[232:235], v218, s[8:11], s89 offen sc1
    s_add_u32 s89, s3, 0xd60000
    buffer_store_dwordx4 v[232:235], v218, s[8:11], s89 offen sc1
    s_add_u32 s89, s3, 0xe60000
    s_cmp_lt_u32 s2, 80
    s_cselect_b32 s89, s89, 0x7f000000
    buffer_store_dwordx4 v[232:235], v218, s[8:11], s89 offen sc1
    s_mov_b32 s3, 0x570000
    s_waitcnt vmcnt(6)
    v_lshlrev_b32 v80, 16, v96
    v_and_b32 v81, 0xffff0000, v96
    v_lshlrev_b32 v82, 16, v97
    v_and_b32 v83, 0xffff0000, v97
    v_lshlrev_b32 v84, 16, v98
    v_and_b32 v85, 0xffff0000, v98
    v_lshlrev_b32 v86, 16, v99
    v_and_b32 v87, 0xffff0000, v99
    v_lshlrev_b32 v88, 16, v100
    v_and_b32 v89, 0xffff0000, v100
    v_lshlrev_b32 v90, 16, v101
    v_and_b32 v91, 0xffff0000, v101
    v_lshlrev_b32 v92, 16, v102
    v_and_b32 v93, 0xffff0000, v102
    v_lshlrev_b32 v94, 16, v103
    v_and_b32 v95, 0xffff0000, v103
    s_waitcnt vmcnt(5)
    v_cmp_eq_u64 vcc, s[18:19], v[216:217]
    s_cmp_eq_u64 vcc, -1
    s_cbranch_scc0 L_spin_9
L_ok_8:
    s_barrier
    s_add_u32 m0, s5, 131072
    s_add_u32 s3, s4, 0
    buffer_load_dwordx4 v207, s[8:11], s3 offen sc1 lds
    s_add_u32 m0, s5, 132096
    s_add_u32 s3, s4, 2048
    buffer_load_dwordx4 v207, s[8:11], s3 offen sc1 lds
    s_add_u32 m0, s5, 133120
    s_add_u32 s3, s4, 4096
    buffer_load_dwordx4 v207, s[8:11], s3 offen sc1 lds
    s_add_u32 m0, s5, 134144
    s_add_u32 s3, s4, 6144
    buffer_load_dwordx4 v207, s[8:11], s3 offen sc1 lds
    s_add_u32 m0, s5, 135168
    s_add_u32 s3, s4, 8192
    buffer_load_dwordx4 v207, s[8:11], s3 offen sc1 lds
    s_add_u32 m0, s5, 136192
    s_add_u32 s3, s4, 10240
    buffer_load_dwordx4 v207, s[8:11], s3 offen sc1 lds
    s_add_u32 m0, s5, 137216
    s_add_u32 s3, s4, 12288
    buffer_load_dwordx4 v207, s[8:11], s3 offen sc1 lds
    s_add_u32 m0, s5, 138240
    s_add_u32 s3, s4, 14336
    buffer_load_dwordx4 v207, s[8:11], s3 offen sc1 lds
    s_add_u32 s3, s5, 131072
    v_add_u32 v210, s3, v213
    v_lshlrev_b32 v220, 2, v1
    s_mul_i32 s57, s88, 224
    v_add_u32 v220, s57, v220
    s_add_u32 s57, s47, 0
    buffer_load_dword v224, v220, s[8:11], s57 offen sc1
    s_add_u32 s57, s47, 14336
    buffer_load_dword v225, v220, s[8:11], s57 offen sc1
    s_add_u32 s57, s47, 28672
    buffer_load_dword v226, v220, s[8:11], s57 offen sc1
    s_add_u32 s57, s47, 43008
    buffer_load_dword v227, v220, s[8:11], s57 offen sc1
    s_add_u32 s57, s47, 57344
    buffer_load_dword v228, v220, s[8:11], s57 offen sc1
    s_add_u32 s57, s47, 71680
    buffer_load_dword v229, v220, s[8:11], s57 offen sc1
    s_add_u32 s57, s47, 86016
    buffer_load_dword v230, v220, s[8:11], s57 offen sc1
    s_add_u32 s57, s47, 100352
    buffer_load_dword v231, v220, s[8:11], s57 offen sc1
    buffer_load_dwordx4 a[224:227], v2, s[8:11], s59 offen sc1
    s_add_u32 m0, s45, 0
    s_add_u32 s89, s44, 0
    buffer_load_dwordx4 v2, s[8:11], s89 offen offset:0 sc1 lds
    buffer_load_dwordx4 v2, s[8:11], s89 offen offset:1024 sc1 lds
    buffer_load_dwordx4 v2, s[8:11], s89 offen offset:2048 sc1 lds
    buffer_load_dwordx4 v2, s[8:11], s89 offen offset:3072 sc1 lds
    s_add_u32 m0, s45, 16384
    s_add_u32 s89, s44, 16384
    buffer_load_dwordx4 v2, s[8:11], s89 offen offset:0 sc1 lds
    buffer_load_dwordx4 v2, s[8:11], s89 offen offset:1024 sc1 lds
    s_waitcnt vmcnt(15)
    ds_read_b128 v[16:19], v210 offset:0
    ds_read_b128 v[20:23], v210 offset:1024
    ds_read_b128 v[24:27], v210 offset:2048
    ds_read_b128 v[28:31], v210 offset:3072
    ds_read_b128 v[32:35], v210 offset:4096
    ds_read_b128 v[36:39], v210 offset:5120
    ds_read_b128 v[40:43], v210 offset:6144
    ds_read_b128 v[44:47], v210 offset:7168
    s_waitcnt lgkmcnt(0)
    v_max3_u32 v104, v16, v17, v18
    v_max3_u32 v105, v19, v20, v21
    v_max3_u32 v104, v104, v22, v23
    v_max3_u32 v105, v105, v24, v25
    v_max3_u32 v104, v104, v26, v27
    v_max3_u32 v105, v105, v28, v29
    v_max3_u32 v104, v104, v30, v31
    v_max3_u32 v105, v105, v32, v33
    v_max3_u32 v104, v104, v34, v35
    v_max3_u32 v105, v105, v36, v37
    v_max3_u32 v104, v104, v38, v39
    v_max3_u32 v105, v105, v40, v41
    v_max3_u32 v104, v104, v42, v43
    v_max3_u32 v105, v105, v44, v45
    v_max3_u32 v104, v104, v46, v47
    v_max3_u32 v104, v104, v105, v105
    v_cmp_eq_u32 vcc, -1, v104
    s_cbranch_vccnz L_vsp_11
L_vok_10:
    s_barrier
    ds_read2st64_b32 v[16:17], v208 offset0:0 offset1:2
    ds_read2st64_b32 v[18:19], v208 offset0:4 offset1:6
    ds_read2st64_b32 v[20:21], v208 offset0:16 offset1:18
    ds_read2st64_b32 v[22:23], v208 offset0:20 offset1:22
    ds_read2st64_b32 v[24:25], v208 offset0:32 offset1:34
    ds_read2st64_b32 v[26:27], v208 offset0:36 offset1:38
    ds_read2st64_b32 v[28:29], v208 offset0:48 offset1:50
    ds_read2st64_b32 v[30:31], v208 offset0:52 offset1:54
    ds_read2st64_b32 v[32:33], v208 offset0:64 offset1:66
    ds_read2st64_b32 v[34:35], v208 offset0:68 offset1:70
    ds_read2st64_b32 v[36:37], v208 offset0:80 offset1:82
    ds_read2st64_b32 v[38:39], v208 offset0:84 offset1:86
    ds_read2st64_b32 v[40:41], v208 offset0:96 offset1:98
    ds_read2st64_b32 v[42:43], v208 offset0:100 offset1:102
    ds_read2st64_b32 v[44:45], v208 offset0:112 offset1:114
    ds_read2st64_b32 v[46:47], v208 offset0:116 offset1:118
    s_waitcnt lgkmcnt(14)
    v_bitop3_b32 v16, v214, v16, v209 bitop3:0x28
    v_bitop3_b32 v17, v214, v17, v209 bitop3:0x28
    v_bitop3_b32 v18, v214, v18, v209 bitop3:0x28
    v_bitop3_b32 v19, v214, v19, v209 bitop3:0x28
    s_nop 2
    v_mfma_f32_32x32x16_bf16 v[80:95], v[16:19], v[48:51], v[80:95]
    s_add_u32 m0, s45, 16384
    s_add_u32 s89, s44, 16384
    buffer_load_dwordx4 v2, s[8:11], s89 offen offset:2048 sc1 lds
    s_waitcnt lgkmcnt(12)
    v_bitop3_b32 v20, v214, v20, v209 bitop3:0x28
    v_bitop3_b32 v21, v214, v21, v209 bitop3:0x28
    v_bitop3_b32 v22, v214, v22, v209 bitop3:0x28
    v_bitop3_b32 v23, v214, v23, v209 bitop3:0x28
    s_nop 2
    v_mfma_f32_32x32x16_bf16 v[80:95], v[20:23], v[52:55], v[80:95]
    buffer_load_dwordx4 v2, s[8:11], s89 offen offset:3072 sc1 lds
    s_waitcnt lgkmcnt(10)
    v_bitop3_b32 v24, v214, v24, v209 bitop3:0x28
    v_bitop3_b32 v25, v214, v25, v209 bitop3:0x28
    v_bitop3_b32 v26, v214, v26, v209 bitop3:0x28
    v_bitop3_b32 v27, v214, v27, v209 bitop3:0x28
    s_nop 2
    v_mfma_f32_32x32x16_bf16 v[80:95], v[24:27], v[56:59], v[80:95]
    s_add_u32 m0, s45, 32768
    s_add_u32 s89, s44, 32768
    buffer_load_dwordx4 v2, s[8:11], s89 offen offset:0 sc1 lds
    s_waitcnt lgkmcnt(8)
    v_bitop3_b32 v28, v214, v28, v209 bitop3:0x28
    v_bitop3_b32 v29, v214, v29, v209 bitop3:0x28
    v_bitop3_b32 v30, v214, v30, v209 bitop3:0x28
    v_bitop3_b32 v31, v214, v31, v209 bitop3:0x28
    s_nop 2
    v_mfma_f32_32x32x16_bf16 v[80:95], v[28:31], v[60:63], v[80:95]
    buffer_load_dwordx4 v2, s[8:11], s89 offen offset:1024 sc1 lds
    s_waitcnt lgkmcnt(6)
    v_bitop3_b32 v32, v214, v32, v209 bitop3:0x28
    v_bitop3_b32 v33, v214, v33, v209 bitop3:0x28
    v_bitop3_b32 v34, v214, v34, v209 bitop3:0x28
    v_bitop3_b32 v35, v214, v35, v209 bitop3:0x28
    s_nop 2
    v_mfma_f32_32x32x16_bf16 v[80:95], v[32:35], v[64:67], v[80:95]
    buffer_load_dwordx4 v2, s[8:11], s89 offen offset:2048 sc1 lds
    s_waitcnt lgkmcnt(4)
    v_bitop3_b32 v36, v214, v36, v209 bitop3:0x28
    v_bitop3_b32 v37, v214, v37, v209 bitop3:0x28
    v_bitop3_b32 v38, v214, v38, v209 bitop3:0x28
    v_bitop3_b32 v39, v214, v39, v209 bitop3:0x28
    s_nop 2
    v_mfma_f32_32x32x16_bf16 v[80:95], v[36:39], v[68:71], v[80:95]
    buffer_load_dwordx4 v2, s[8:11], s89 offen offset:3072 sc1 lds
    s_waitcnt lgkmcnt(2)
    v_bitop3_b32 v40, v214, v40, v209 bitop3:0x28
    v_bitop3_b32 v41, v214, v41, v209 bitop3:0x28
    v_bitop3_b32 v42, v214, v42, v209 bitop3:0x28
    v_bitop3_b32 v43, v214, v43, v209 bitop3:0x28
    s_nop 2
    v_mfma_f32_32x32x16_bf16 v[80:95], v[40:43], v[72:75], v[80:95]
    s_add_u32 m0, s45, 49152
    s_add_u32 s89, s44, 49152
    buffer_load_dwordx4 v2, s[8:11], s89 offen offset:0 sc1 lds
    s_waitcnt lgkmcnt(0)
    v_bitop3_b32 v44, v214, v44, v209 bitop3:0x28
    v_bitop3_b32 v45, v214, v45, v209 bitop3:0x28
    v_bitop3_b32 v46, v214, v46, v209 bitop3:0x28
    v_bitop3_b32 v47, v214, v47, v209 bitop3:0x28
    s_nop 2
    v_mfma_f32_32x32x16_bf16 v[80:95], v[44:47], v[76:79], v[80:95]
    buffer_load_dwordx4 v2, s[8:11], s89 offen offset:1024 sc1 lds
    s_nop 10
    v_cvt_pk_bf16_f32 v16, v80, v81
    v_cvt_pk_bf16_f32 v17, v82, v83
    v_cvt_pk_bf16_f32 v18, v84, v85
    v_cvt_pk_bf16_f32 v19, v86, v87
    v_cvt_pk_bf16_f32 v20, v88, v89
    v_cvt_pk_bf16_f32 v21, v90, v91
    v_cvt_pk_bf16_f32 v22, v92, v93
    v_cvt_pk_bf16_f32 v23, v94, v95
    buffer_store_dwordx4 v[16:19], v213, s[8:11], s37 offen sc1
    buffer_store_dwordx4 v[20:23], v213, s[8:11], s37 offen offset:1024 sc1
    v_dot2_f32_bf16 v104, v16, s31, 0
    v_dot2_f32_bf16 v105, v16, v16, 0
    v_dot2_f32_bf16 v106, v17, s31, 0
    v_dot2_f32_bf16 v107, v17, v17, 0
    v_dot2_f32_bf16 v104, v18, s31, v104
    v_dot2_f32_bf16 v105, v18, v18, v105
    v_dot2_f32_bf16 v106, v19, s31, v106
    v_dot2_f32_bf16 v107, v19, v19, v107
    v_dot2_f32_bf16 v104, v20, s31, v104
    v_dot2_f32_bf16 v105, v20, v20, v105
    v_dot2_f32_bf16 v106, v21, s31, v106
    v_dot2_f32_bf16 v107, v21, v21, v107
    v_dot2_f32_bf16 v104, v22, s31, v104
    v_dot2_f32_bf16 v105, v22, v22, v105
    v_dot2_f32_bf16 v106, v23, s31, v106
    v_dot2_f32_bf16 v107, v23, v23, v107
    v_accvgpr_write_b32 a228, v16
    v_accvgpr_write_b32 a229, v17
    v_accvgpr_write_b32 a230, v18
    v_pk_add_f32 v[104:105], v[104:105], v[106:107]
    v_accvgpr_write_b32 a231, v19
    v_mov_b32 v106, v104
    v_mov_b32 v107, v105
    v_accvgpr_write_b32 a232, v20
    v_accvgpr_write_b32 a233, v21
    v_permlane32_swap_b32 v104, v106
    v_permlane32_swap_b32 v105, v107
    v_pk_add_f32 v[104:105], v[104:105], v[106:107]
    buffer_store_dwordx2 v[104:105], v212, s[8:11], s36 offen sc1
    v_accvgpr_write_b32 a234, v22
    v_accvgpr_write_b32 a235, v23
    s_barrier
    v_add_u32 v3, 0x10000, v2
    v_add_u32 v4, 0x20000, v2
    v_lshrrev_b32 v5, 5, v1
    v_lshlrev_b32 v5, 6, v5
    v_add_u32 v5, 0x27c00, v5
    s_cmp_lt_u32 s88, 2
    s_cselect_b32 s40, s25, s26
    s_lshl_b32 s40, s40, 1
    s_add_u32 s40, s40, s41
    s_lshl_b32 s42, s40, 15
    s_add_u32 s42, s42, 0x820000
    s_mul_i32 s46, s40, 112
    s_lshr_b32 s53, s23, 2
    s_mul_i32 s53, s53, 28
    s_add_u32 s46, s46, s53
    s_and_b32 s53, s23, 3
    s_add_u32 s46, s46, s53
    s_lshl_b32 s46, s46, 10
    s_add_u32 s46, s46, 0x1200000
    s_lshl_b32 s49, s24, 1
    s_add_u32 s49, s49, s39
    s_xor_b32 s50, s49, 1
    s_mul_i32 s53, s49, 112
    s_mul_i32 s50, s50, 112
    s_add_u32 s53, s53, s48
    s_add_u32 s50, s50, s48
    s_lshl_b32 s53, s53, 10
    s_lshl_b32 s50, s50, 10
    s_mov_b32 s101, 0x1200000
    s_add_u32 s100, s53, s101
    s_add_u32 s101, s50, s101
    s_lshl_b32 s49, s49, 15
    s_lshl_b32 s50, s58, 11
    s_add_u32 s49, s49, s50
    s_add_u32 s49, s49, 0xa60000
    s_lshl_b32 s50, s40, 12
    s_add_u32 s50, s50, 0xa20000
    v_and_b32 v127, 31, v1
    v_lshlrev_b32 v127, 4, v127
    v_lshrrev_b32 v126, 5, v1
    v_lshl_add_u32 v127, v126, 11, v127
    s_lshl_b32 s51, s20, 13
    s_add_u32 s51, s51, 0x5a0000
    s_lshl_b32 s52, s23, 2
    s_add_u32 s52, s52, s88
    s_lshl_b32 s52, s52, 7
    s_add_u32 s52, s52, s51
    v_and_b32 v6, 3, v1
    v_bfe_u32 v13, v1, 2, 1
    v_lshl_add_u32 v6, v6, 2, v13
    s_lshl_b32 s53, s88, 4
    s_lshl_b32 s54, s21, 1
    s_add_u32 s53, s53, s54
    v_add_u32 v6, s53, v6
    v_lshlrev_b32 v6, 7, v6
    v_mov_b32 v7, 0x7f000000
    v_cmp_eq_u32 vcc, 0, v1
    s_nop 1
    v_cndmask_b32 v7, v7, v1, vcc
    s_waitcnt vmcnt(18)
    v_pk_add_f32 v[224:225], v[224:225], v[226:227]
    v_pk_add_f32 v[228:229], v[228:229], v[230:231]
    v_add_u32 v220, 0x27c00, v220
    v_pk_add_f32 v[224:225], v[224:225], v[228:229]
    v_add_f32 v224, v224, v225
    ds_write_b32 v220, v224
    buffer_load_dwordx4 v2, s[8:11], s89 offen offset:2048 sc1 lds
    buffer_load_dwordx4 v2, s[8:11], s89 offen offset:3072 sc1 lds
    s_add_u32 m0, s45, 65536
    s_add_u32 s89, s44, 65536
    buffer_load_dwordx4 v2, s[8:11], s89 offen offset:0 sc1 lds
    buffer_load_dwordx4 v2, s[8:11], s89 offen offset:1024 sc1 lds
    buffer_load_dwordx4 v2, s[8:11], s89 offen offset:2048 sc1 lds
    buffer_load_dwordx4 v2, s[8:11], s89 offen offset:3072 sc1 lds
    s_add_u32 m0, s45, 81920
    s_add_u32 s89, s44, 81920
    buffer_load_dwordx4 v2, s[8:11], s89 offen offset:0 sc1 lds
    buffer_load_dwordx4 v2, s[8:11], s89 offen offset:1024 sc1 lds
    buffer_load_dwordx4 v2, s[8:11], s89 offen offset:2048 sc1 lds
    buffer_load_dwordx4 v2, s[8:11], s89 offen offset:3072 sc1 lds
    s_add_u32 m0, s45, 98304
    s_add_u32 s89, s44, 98304
    buffer_load_dwordx4 v2, s[8:11], s89 offen offset:0 sc1 lds
    buffer_load_dwordx4 v2, s[8:11], s89 offen offset:1024 sc1 lds
    s_add_u32 s56, s42, 0
    buffer_load_dwordx4 v[128:131], v2, s[8:11], s56 offen offset:0 sc1
    buffer_load_dwordx4 v[132:135], v2, s[8:11], s56 offen offset:1024 sc1
    buffer_load_dwordx4 v[136:139], v2, s[8:11], s56 offen offset:2048 sc1
    buffer_load_dwordx4 v[140:143], v2, s[8:11], s56 offen offset:3072 sc1
    s_add_u32 s56, s42, 4096
    buffer_load_dwordx4 v[144:147], v2, s[8:11], s56 offen offset:0 sc1
    buffer_load_dwordx4 v[148:151], v2, s[8:11], s56 offen offset:1024 sc1
    buffer_load_dwordx4 v[152:155], v2, s[8:11], s56 offen offset:2048 sc1
    buffer_load_dwordx4 v[156:159], v2, s[8:11], s56 offen offset:3072 sc1
    s_add_u32 s56, s42, 8192
    buffer_load_dwordx4 v[160:163], v2, s[8:11], s56 offen offset:0 sc1
    buffer_load_dwordx4 v[164:167], v2, s[8:11], s56 offen offset:1024 sc1
    buffer_load_dwordx4 v[168:171], v2, s[8:11], s56 offen offset:2048 sc1
    buffer_load_dwordx4 v[172:175], v2, s[8:11], s56 offen offset:3072 sc1
    s_add_u32 s56, s42, 12288
    buffer_load_dwordx4 v[176:179], v2, s[8:11], s56 offen offset:0 sc1
    buffer_load_dwordx4 v[180:183], v2, s[8:11], s56 offen offset:1024 sc1
    buffer_load_dwordx4 v[184:187], v2, s[8:11], s56 offen offset:2048 sc1
    buffer_load_dwordx4 v[188:191], v2, s[8:11], s56 offen offset:3072 sc1
    s_add_u32 s56, s42, 16384
    buffer_load_dwordx4 v[192:195], v2, s[8:11], s56 offen offset:0 sc1
    buffer_load_dwordx4 v[196:199], v2, s[8:11], s56 offen offset:1024 sc1
    buffer_load_dwordx4 v[200:203], v2, s[8:11], s56 offen offset:2048 sc1
    buffer_load_dwordx4 v[204:207], v2, s[8:11], s56 offen offset:3072 sc1
    s_waitcnt vmcnt(16) lgkmcnt(0)
    s_barrier
    ds_read_b128 v[64:67], v2 offset:0
    ds_read_b128 v[68:71], v2 offset:32768
    ds_read_b128 v[72:75], v2 offset:1024
    ds_read_b128 v[76:79], v2 offset:33792
    ds_read_b128 v[80:83], v2 offset:2048
    ds_read_b128 v[84:87], v2 offset:34816
    ds_read_b128 v[88:91], v2 offset:3072
    ds_read_b128 v[96:99], v5 offset:0
    ds_read_b128 v[100:103], v5 offset:16
    ds_read_b128 v[104:107], v5 offset:32
    ds_read_b128 v[108:111], v5 offset:48
    s_waitcnt vmcnt(16)
    v_max3_u32 v12, v128, v129, v130
    v_max3_u32 v13, v131, v132, v133
    v_max3_u32 v12, v12, v134, v135
    v_max3_u32 v13, v13, v136, v137
    v_max3_u32 v12, v12, v138, v139
    v_max3_u32 v13, v13, v140, v141
    v_max3_u32 v12, v12, v142, v143
    v_max3_u32 v12, v12, v13, v13
    v_cmp_eq_u32 vcc, -1, v12
    s_cbranch_vccnz L_vsp_13
L_vok_12:
    s_waitcnt lgkmcnt(7)
    v_mfma_f32_32x32x16_bf16 v[16:31], v[64:67], v[128:131], 0
    ds_read_b128 v[92:95], v2 offset:35840
    buffer_load_dwordx4 v[48:51], v127, s[8:11], s50 offen offset:0 sc1
    v_mfma_f32_32x32x16_bf16 v[32:47], v[68:71], v[128:131], 0
    ds_read_b128 v[64:67], v2 offset:4096
    v_mfma_f32_32x32x16_bf16 v[16:31], v[72:75], v[132:135], v[16:31]
    ds_read_b128 v[68:71], v2 offset:36864
    s_waitcnt vmcnt(13)
    v_max3_u32 v12, v144, v145, v146
    v_max3_u32 v13, v147, v148, v149
    buffer_load_dwordx4 v[52:55], v127, s[8:11], s50 offen offset:512 sc1
    v_mfma_f32_32x32x16_bf16 v[32:47], v[76:79], v[132:135], v[32:47]
    ds_read_b128 v[72:75], v2 offset:5120
    v_max3_u32 v12, v12, v150, v151
    v_max3_u32 v13, v13, v152, v153
    v_max3_u32 v12, v12, v154, v155
    s_waitcnt lgkmcnt(3)
    v_mfma_f32_32x32x16_bf16 v[16:31], v[80:83], v[136:139], v[16:31]
    ds_read_b128 v[76:79], v2 offset:37888
    v_max3_u32 v13, v13, v156, v157
    v_max3_u32 v12, v12, v158, v159
    v_max3_u32 v12, v12, v13, v13
    buffer_load_dwordx4 v[56:59], v127, s[8:11], s50 offen offset:1024 sc1
    v_mfma_f32_32x32x16_bf16 v[32:47], v[84:87], v[136:139], v[32:47]
    ds_read_b128 v[80:83], v2 offset:6144
    v_cmp_eq_u32 vcc, -1, v12
    s_cbranch_vccnz L_vsp_15
L_vok_14:
    v_mfma_f32_32x32x16_bf16 v[16:31], v[88:91], v[140:143], v[16:31]
    ds_read_b128 v[84:87], v2 offset:38912
    buffer_load_dwordx4 v[60:63], v127, s[8:11], s50 offen offset:1536 sc1
    v_mfma_f32_32x32x16_bf16 v[32:47], v[92:95], v[140:143], v[32:47]
    ds_read_b128 v[88:91], v2 offset:7168
    s_waitcnt lgkmcnt(3)
    v_mfma_f32_32x32x16_bf16 v[16:31], v[64:67], v[144:147], v[16:31]
    ds_read_b128 v[92:95], v2 offset:39936
    s_add_u32 s56, s42, 20480
    buffer_load_dwordx4 v[208:211], v2, s[8:11], s56 offen offset:0 sc1
    v_mfma_f32_32x32x16_bf16 v[32:47], v[68:71], v[144:147], v[32:47]
    ds_read_b128 v[64:67], v2 offset:8192
    v_mfma_f32_32x32x16_bf16 v[16:31], v[72:75], v[148:151], v[16:31]
    ds_read_b128 v[68:71], v2 offset:40960
    s_waitcnt vmcnt(13)
    v_max3_u32 v12, v160, v161, v162
    v_max3_u32 v13, v163, v164, v165
    buffer_load_dwordx4 v[212:215], v2, s[8:11], s56 offen offset:1024 sc1
    v_mfma_f32_32x32x16_bf16 v[32:47], v[76:79], v[148:151], v[32:47]
    ds_read_b128 v[72:75], v2 offset:9216
    v_max3_u32 v12, v12, v166, v167
    v_max3_u32 v13, v13, v168, v169
    v_max3_u32 v12, v12, v170, v171
    s_waitcnt lgkmcnt(3)
    v_mfma_f32_32x32x16_bf16 v[16:31], v[80:83], v[152:155], v[16:31]
    ds_read_b128 v[76:79], v2 offset:41984
    v_max3_u32 v13, v13, v172, v173
    v_max3_u32 v12, v12, v174, v175
    v_max3_u32 v12, v12, v13, v13
    buffer_load_dwordx4 v[216:219], v2, s[8:11], s56 offen offset:2048 sc1
    v_mfma_f32_32x32x16_bf16 v[32:47], v[84:87], v[152:155], v[32:47]
    ds_read_b128 v[80:83], v2 offset:10240
    v_cmp_eq_u32 vcc, -1, v12
    s_cbranch_vccnz L_vsp_17
L_vok_16:
    v_mfma_f32_32x32x16_bf16 v[16:31], v[88:91], v[156:159], v[16:31]
    ds_read_b128 v[84:87], v2 offset:43008
    buffer_load_dwordx4 v[220:223], v2, s[8:11], s56 offen offset:3072 sc1
    v_mfma_f32_32x32x16_bf16 v[32:47], v[92:95], v[156:159], v[32:47]
    ds_read_b128 v[88:91], v2 offset:11264
    s_waitcnt lgkmcnt(3)
    v_mfma_f32_32x32x16_bf16 v[16:31], v[64:67], v[160:163], v[16:31]
    ds_read_b128 v[92:95], v2 offset:44032
    s_add_u32 s56, s42, 24576
    buffer_load_dwordx4 v[224:227], v2, s[8:11], s56 offen offset:0 sc1
    v_mfma_f32_32x32x16_bf16 v[32:47], v[68:71], v[160:163], v[32:47]
    ds_read_b128 v[64:67], v2 offset:12288
    v_mfma_f32_32x32x16_bf16 v[16:31], v[72:75], v[164:167], v[16:31]
    ds_read_b128 v[68:71], v2 offset:45056
    s_waitcnt vmcnt(13)
    v_max3_u32 v12, v176, v177, v178
    v_max3_u32 v13, v179, v180, v181
    buffer_load_dwordx4 v[228:231], v2, s[8:11], s56 offen offset:1024 sc1
    v_mfma_f32_32x32x16_bf16 v[32:47], v[76:79], v[164:167], v[32:47]
    ds_read_b128 v[72:75], v2 offset:13312
    v_max3_u32 v12, v12, v182, v183
    v_max3_u32 v13, v13, v184, v185
    v_max3_u32 v12, v12, v186, v187
    s_waitcnt lgkmcnt(3)
    v_mfma_f32_32x32x16_bf16 v[16:31], v[80:83], v[168:171], v[16:31]
    ds_read_b128 v[76:79], v2 offset:46080
    v_max3_u32 v13, v13, v188, v189
    v_max3_u32 v12, v12, v190, v191
    v_max3_u32 v12, v12, v13, v13
    buffer_load_dwordx4 v[232:235], v2, s[8:11], s56 offen offset:2048 sc1
    v_mfma_f32_32x32x16_bf16 v[32:47], v[84:87], v[168:171], v[32:47]
    ds_read_b128 v[80:83], v2 offset:14336
    v_cmp_eq_u32 vcc, -1, v12
    s_cbranch_vccnz L_vsp_19
L_vok_18:
    v_mfma_f32_32x32x16_bf16 v[16:31], v[88:91], v[172:175], v[16:31]
    ds_read_b128 v[84:87], v2 offset:47104
    buffer_load_dwordx4 v[236:239], v2, s[8:11], s56 offen offset:3072 sc1
    v_mfma_f32_32x32x16_bf16 v[32:47], v[92:95], v[172:175], v[32:47]
    ds_read_b128 v[88:91], v2 offset:15360
    s_waitcnt lgkmcnt(3)
    v_mfma_f32_32x32x16_bf16 v[16:31], v[64:67], v[176:179], v[16:31]
    ds_read_b128 v[92:95], v2 offset:48128
    s_add_u32 s56, s42, 28672
    buffer_load_dwordx4 v[240:243], v2, s[8:11], s56 offen offset:0 sc1
    v_mfma_f32_32x32x16_bf16 v[32:47], v[68:71], v[176:179], v[32:47]
    ds_read_b128 v[64:67], v2 offset:16384
    v_mfma_f32_32x32x16_bf16 v[16:31], v[72:75], v[180:183], v[16:31]
    ds_read_b128 v[68:71], v2 offset:49152
    s_waitcnt vmcnt(13)
    v_max3_u32 v12, v192, v193, v194
    v_max3_u32 v13, v195, v196, v197
    buffer_load_dwordx4 v[244:247], v2, s[8:11], s56 offen offset:1024 sc1
    v_mfma_f32_32x32x16_bf16 v[32:47], v[76:79], v[180:183], v[32:47]
    ds_read_b128 v[72:75], v2 offset:17408
    v_max3_u32 v12, v12, v198, v199
    v_max3_u32 v13, v13, v200, v201
    v_max3_u32 v12, v12, v202, v203
    s_waitcnt lgkmcnt(3)
    v_mfma_f32_32x32x16_bf16 v[16:31], v[80:83], v[184:187], v[16:31]
    ds_read_b128 v[76:79], v2 offset:50176
    v_max3_u32 v13, v13, v204, v205
    v_max3_u32 v12, v12, v206, v207
    v_max3_u32 v12, v12, v13, v13
    buffer_load_dwordx4 v[248:251], v2, s[8:11], s56 offen offset:2048 sc1
    v_mfma_f32_32x32x16_bf16 v[32:47], v[84:87], v[184:187], v[32:47]
    ds_read_b128 v[80:83], v2 offset:18432
    v_cmp_eq_u32 vcc, -1, v12
    s_cbranch_vccnz L_vsp_21
L_vok_20:
    v_mfma_f32_32x32x16_bf16 v[16:31], v[88:91], v[188:191], v[16:31]
    ds_read_b128 v[84:87], v2 offset:51200
    buffer_load_dwordx4 v[252:255], v2, s[8:11], s56 offen offset:3072 sc1
    v_mfma_f32_32x32x16_bf16 v[32:47], v[92:95], v[188:191], v[32:47]
    ds_read_b128 v[88:91], v2 offset:19456
    s_waitcnt vmcnt(12)
    v_max3_u32 v14, v48, v49, v50
    v_max3_u32 v15, v51, v52, v53
    v_max3_u32 v14, v14, v54, v55
    v_max3_u32 v15, v15, v56, v57
    v_max3_u32 v14, v14, v58, v59
    v_max3_u32 v15, v15, v60, v61
    v_max3_u32 v14, v14, v62, v63
    v_max3_u32 v14, v14, v15, v15
    v_cmp_eq_u32 vcc, -1, v14
    s_cbranch_vccnz L_vsp_23
L_vok_22:
    v_pk_add_f32 v[48:49], v[48:49], v[56:57]
    v_pk_add_f32 v[50:51], v[50:51], v[58:59]
    v_pk_add_f32 v[52:53], v[52:53], v[60:61]
    v_pk_add_f32 v[54:55], v[54:55], v[62:63]
    v_pk_add_f32 v[48:49], v[48:49], v[52:53]
    v_pk_add_f32 v[50:51], v[50:51], v[54:55]
    s_waitcnt lgkmcnt(3)
    v_mfma_f32_32x32x16_bf16 v[16:31], v[64:67], v[192:195], v[16:31]
    ds_read_b128 v[92:95], v2 offset:52224
    buffer_load_dwordx4 v2, s[8:11], s89 offen offset:2048 sc1 lds
    v_pk_add_f32 v[48:49], v[48:49], v[50:51]
    v_mov_b32 v50, v48
    v_mov_b32 v51, v49
    v_mfma_f32_32x32x16_bf16 v[32:47], v[68:71], v[192:195], v[32:47]
    ds_read_b128 v[64:67], v2 offset:20480
    s_nop 0
    s_nop 0
    v_permlane32_swap_b32 v48, v50
    v_permlane32_swap_b32 v49, v51
    v_add_f32 v48, v48, v50
    v_add_f32 v49, v49, v51
    v_mul_f32 v8, 0x3b000000, v48
    v_mfma_f32_32x32x16_bf16 v[16:31], v[72:75], v[196:199], v[16:31]
    ds_read_b128 v[68:71], v2 offset:53248
    s_waitcnt vmcnt(9)
    v_max3_u32 v12, v208, v209, v210
    v_max3_u32 v13, v211, v212, v213
    buffer_load_dwordx4 v2, s[8:11], s89 offen offset:3072 sc1 lds
    v_mfma_f32_32x32x16_bf16 v[32:47], v[76:79], v[196:199], v[32:47]
    ds_read_b128 v[72:75], v2 offset:21504
    v_max3_u32 v12, v12, v214, v215
    v_max3_u32 v13, v13, v216, v217
    v_max3_u32 v12, v12, v218, v219
    v_mul_f32 v49, 0x3b000000, v49
    v_fma_f32 v49, -v8, v8, v49
    v_max_f32 v49, 0, v49
    v_add_f32 v49, 0x3727c5ac, v49
    s_waitcnt lgkmcnt(3)
    v_mfma_f32_32x32x16_bf16 v[16:31], v[80:83], v[200:203], v[16:31]
    ds_read_b128 v[76:79], v2 offset:54272
    v_max3_u32 v13, v13, v220, v221
    v_max3_u32 v12, v12, v222, v223
    v_max3_u32 v12, v12, v13, v13
    s_add_u32 m0, s45, 114688
    s_add_u32 s89, s44, 114688
    buffer_load_dwordx4 v2, s[8:11], s89 offen offset:0 sc1 lds
    v_mfma_f32_32x32x16_bf16 v[32:47], v[84:87], v[200:203], v[32:47]
    ds_read_b128 v[80:83], v2 offset:22528
    v_cmp_eq_u32 vcc, -1, v12
    s_cbranch_vccnz L_vsp_25
L_vok_24:
    v_rsq_f32 v10, v49
    s_nop 0
    v_mul_f32 v9, 0xbfb8aa3b, v10
    v_mfma_f32_32x32x16_bf16 v[16:31], v[88:91], v[204:207], v[16:31]
    ds_read_b128 v[84:87], v2 offset:55296
    buffer_load_dwordx4 v2, s[8:11], s89 offen offset:1024 sc1 lds
    v_mfma_f32_32x32x16_bf16 v[32:47], v[92:95], v[204:207], v[32:47]
    ds_read_b128 v[88:91], v2 offset:23552
    s_waitcnt lgkmcnt(3)
    v_mfma_f32_32x32x16_bf16 v[16:31], v[64:67], v[208:211], v[16:31]
    ds_read_b128 v[92:95], v2 offset:56320
    buffer_load_dwordx4 v2, s[8:11], s89 offen offset:2048 sc1 lds
    v_mfma_f32_32x32x16_bf16 v[32:47], v[68:71], v[208:211], v[32:47]
    ds_read_b128 v[64:67], v2 offset:24576
    v_mfma_f32_32x32x16_bf16 v[16:31], v[72:75], v[212:215], v[16:31]
    ds_read_b128 v[68:71], v2 offset:57344
    s_waitcnt vmcnt(9)
    v_max3_u32 v12, v224, v225, v226
    v_max3_u32 v13, v227, v228, v229
    buffer_load_dwordx4 v2, s[8:11], s89 offen offset:3072 sc1 lds
    v_mfma_f32_32x32x16_bf16 v[32:47], v[76:79], v[212:215], v[32:47]
    ds_read_b128 v[72:75], v2 offset:25600
    v_max3_u32 v12, v12, v230, v231
    v_max3_u32 v13, v13, v232, v233
    v_max3_u32 v12, v12, v234, v235
    s_waitcnt lgkmcnt(3)
    v_mfma_f32_32x32x16_bf16 v[16:31], v[80:83], v[216:219], v[16:31]
    ds_read_b128 v[76:79], v2 offset:58368
    v_max3_u32 v13, v13, v236, v237
    v_max3_u32 v12, v12, v238, v239
    v_max3_u32 v12, v12, v13, v13
    s_add_u32 m0, s45, 131072
    s_add_u32 s89, s44, 131072
    buffer_load_dwordx4 v2, s[8:11], s89 offen offset:0 sc1 lds
    v_mfma_f32_32x32x16_bf16 v[32:47], v[84:87], v[216:219], v[32:47]
    ds_read_b128 v[80:83], v2 offset:26624
    v_cmp_eq_u32 vcc, -1, v12
    s_cbranch_vccnz L_vsp_27
L_vok_26:
    v_mfma_f32_32x32x16_bf16 v[16:31], v[88:91], v[220:223], v[16:31]
    ds_read_b128 v[84:87], v2 offset:59392
    buffer_load_dwordx4 v2, s[8:11], s89 offen offset:1024 sc1 lds
    v_mfma_f32_32x32x16_bf16 v[32:47], v[92:95], v[220:223], v[32:47]
    ds_read_b128 v[88:91], v2 offset:27648
    s_waitcnt lgkmcnt(3)
    v_mfma_f32_32x32x16_bf16 v[16:31], v[64:67], v[224:227], v[16:31]
    ds_read_b128 v[92:95], v2 offset:60416
    buffer_load_dwordx4 v2, s[8:11], s89 offen offset:2048 sc1 lds
    v_mfma_f32_32x32x16_bf16 v[32:47], v[68:71], v[224:227], v[32:47]
    ds_read_b128 v[64:67], v2 offset:28672
    v_mfma_f32_32x32x16_bf16 v[16:31], v[72:75], v[228:231], v[16:31]
    ds_read_b128 v[68:71], v2 offset:61440
    s_waitcnt vmcnt(9)
    v_max3_u32 v12, v240, v241, v242
    v_max3_u32 v13, v243, v244, v245
    buffer_load_dwordx4 v2, s[8:11], s89 offen offset:3072 sc1 lds
    v_mfma_f32_32x32x16_bf16 v[32:47], v[76:79], v[228:231], v[32:47]
    ds_read_b128 v[72:75], v2 offset:29696
    v_max3_u32 v12, v12, v246, v247
    v_max3_u32 v13, v13, v248, v249
    v_max3_u32 v12, v12, v250, v251
    s_waitcnt lgkmcnt(3)
    v_mfma_f32_32x32x16_bf16 v[16:31], v[80:83], v[232:235], v[16:31]
    ds_read_b128 v[76:79], v2 offset:62464
    v_max3_u32 v13, v13, v252, v253
    v_max3_u32 v12, v12, v254, v255
    v_max3_u32 v12, v12, v13, v13
    s_add_u32 m0, s45, 147456
    s_add_u32 s89, s44, 147456
    buffer_load_dwordx4 v2, s[8:11], s89 offen offset:0 sc1 lds
    v_mfma_f32_32x32x16_bf16 v[32:47], v[84:87], v[232:235], v[32:47]
    ds_read_b128 v[80:83], v2 offset:30720
    v_cmp_eq_u32 vcc, -1, v12
    s_cbranch_vccnz L_vsp_29
L_vok_28:
    v_mfma_f32_32x32x16_bf16 v[16:31], v[88:91], v[236:239], v[16:31]
    ds_read_b128 v[84:87], v2 offset:63488
    buffer_load_dwordx4 v2, s[8:11], s89 offen offset:1024 sc1 lds
    v_mfma_f32_32x32x16_bf16 v[32:47], v[92:95], v[236:239], v[32:47]
    ds_read_b128 v[88:91], v2 offset:31744
    s_waitcnt lgkmcnt(3)
    v_mfma_f32_32x32x16_bf16 v[16:31], v[64:67], v[240:243], v[16:31]
    ds_read_b128 v[92:95], v2 offset:64512
    buffer_load_dwordx4 v2, s[8:11], s89 offen offset:2048 sc1 lds
    v_mfma_f32_32x32x16_bf16 v[32:47], v[68:71], v[240:243], v[32:47]
    ds_read_b128 v[64:67], v3 offset:0
    v_mfma_f32_32x32x16_bf16 v[16:31], v[72:75], v[244:247], v[16:31]
    ds_read_b128 v[68:71], v3 offset:1024
    s_cmp_eq_u32 s88, 3
    s_cselect_b32 s57, 1024, 0
    s_sub_u32 s89, s89, s57
    s_sub_u32 m0, m0, s57
    s_nop 0
    buffer_load_dwordx4 v2, s[8:11], s89 offen offset:3072 sc1 lds
    v_mfma_f32_32x32x16_bf16 v[32:47], v[76:79], v[244:247], v[32:47]
    ds_read_b128 v[72:75], v3 offset:2048
    s_waitcnt lgkmcnt(3)
    v_mfma_f32_32x32x16_bf16 v[16:31], v[80:83], v[248:251], v[16:31]
    ds_read_b128 v[76:79], v3 offset:3072
    v_mov_b32 v120, -1
    v_mov_b32 v121, -1
    v_mov_b32 v122, -1
    v_mov_b32 v123, -1
    s_add_u32 s57, s46, 12288
    buffer_store_dwordx4 v[120:123], v2, s[8:11], s57 offen sc1
    v_mfma_f32_32x32x16_bf16 v[32:47], v[84:87], v[248:251], v[32:47]
    ds_read_b128 v[80:83], v3 offset:4096
    v_mfma_f32_32x32x16_bf16 v[16:31], v[88:91], v[252:255], v[16:31]
    ds_read_b128 v[84:87], v3 offset:5120
    s_add_u32 s57, s46, 16384
    buffer_store_dwordx4 v[120:123], v2, s[8:11], s57 offen sc1
    v_mfma_f32_32x32x16_bf16 v[32:47], v[92:95], v[252:255], v[32:47]
    ds_read_b128 v[88:91], v3 offset:6144
    s_waitcnt lgkmcnt(3)
    v_mfma_f32_32x32x16_bf16 v[48:63], v[64:67], v[128:131], 0
    ds_read_b128 v[92:95], v3 offset:7168
    s_add_u32 s57, s46, 20480
    buffer_store_dwordx4 v[120:123], v2, s[8:11], s57 offen sc1
    v_mfma_f32_32x32x16_bf16 v[48:63], v[68:71], v[132:135], v[48:63]
    ds_read_b128 v[64:67], v3 offset:8192
    v_mfma_f32_32x32x16_bf16 v[48:63], v[72:75], v[136:139], v[48:63]
    ds_read_b128 v[68:71], v3 offset:9216
    s_add_u32 s57, s46, 24576
    buffer_store_dwordx4 v[120:123], v2, s[8:11], s57 offen sc1
    s_waitcnt lgkmcnt(15)
    v_fma_f32 v16, -v8, v96, v16
    v_fma_f32 v17, -v8, v97, v17
    v_mfma_f32_32x32x16_bf16 v[48:63], v[76:79], v[140:143], v[48:63]
    ds_read_b128 v[72:75], v3 offset:10240
    v_fma_f32 v18, -v8, v98, v18
    v_fma_f32 v19, -v8, v99, v19
    v_fma_f32 v20, -v8, v100, v20
    v_fma_f32 v21, -v8, v101, v21
    v_fma_f32 v22, -v8, v102, v22
    v_fma_f32 v23, -v8, v103, v23
    v_fma_f32 v24, -v8, v104, v24
    s_waitcnt lgkmcnt(3)
    v_mfma_f32_32x32x16_bf16 v[48:63], v[80:83], v[144:147], v[48:63]
    ds_read_b128 v[76:79], v3 offset:11264
    v_fma_f32 v25, -v8, v105, v25
    v_fma_f32 v26, -v8, v106, v26
    v_fma_f32 v27, -v8, v107, v27
    v_fma_f32 v28, -v8, v108, v28
    v_fma_f32 v29, -v8, v109, v29
    v_fma_f32 v30, -v8, v110, v30
    v_fma_f32 v31, -v8, v111, v31
    v_mfma_f32_32x32x16_bf16 v[48:63], v[84:87], v[148:151], v[48:63]
    ds_read_b128 v[80:83], v3 offset:12288
    v_mul_f32 v16, v16, v9
    v_mul_f32 v17, v17, v9
    v_mul_f32 v18, v18, v9
    v_mul_f32 v19, v19, v9
    v_mul_f32 v20, v20, v9
    v_mul_f32 v21, v21, v9
    v_mul_f32 v22, v22, v9
    v_mfma_f32_32x32x16_bf16 v[48:63], v[88:91], v[152:155], v[48:63]
    ds_read_b128 v[84:87], v3 offset:13312
    v_mul_f32 v23, v23, v9
    ds_read_b128 v[96:99], v5 offset:128
    ds_read_b128 v[100:103], v5 offset:144
    ds_read_b128 v[104:107], v5 offset:160
    ds_read_b128 v[108:111], v5 offset:176
    v_exp_f32 v16, v16
    v_mfma_f32_32x32x16_bf16 v[48:63], v[92:95], v[156:159], v[48:63]
    ds_read_b128 v[88:91], v3 offset:14336
    v_mul_f32 v24, v24, v10
    v_exp_f32 v17, v17
    v_mul_f32 v25, v25, v10
    v_exp_f32 v18, v18
    v_mul_f32 v26, v26, v10
    s_waitcnt lgkmcnt(7)
    v_mfma_f32_32x32x16_bf16 v[48:63], v[64:67], v[160:163], v[48:63]
    ds_read_b128 v[92:95], v3 offset:15360
    v_exp_f32 v19, v19
    v_mul_f32 v27, v27, v10
    v_exp_f32 v20, v20
    v_mul_f32 v28, v28, v10
    v_mfma_f32_32x32x16_bf16 v[48:63], v[68:71], v[164:167], v[48:63]
    ds_read_b128 v[64:67], v3 offset:16384
    v_exp_f32 v21, v21
    v_mul_f32 v29, v29, v10
    v_exp_f32 v22, v22
    v_mul_f32 v30, v30, v10
    v_mfma_f32_32x32x16_bf16 v[48:63], v[72:75], v[168:171], v[48:63]
    ds_read_b128 v[68:71], v3 offset:17408
    v_exp_f32 v23, v23
    v_mul_f32 v31, v31, v10
    v_add_f32 v16, 1.0, v16
    v_add_f32 v17, 1.0, v17
    v_add_f32 v18, 1.0, v18
    v_add_f32 v19, 1.0, v19
    v_mfma_f32_32x32x16_bf16 v[48:63], v[76:79], v[172:175], v[48:63]
    ds_read_b128 v[72:75], v3 offset:18432
    v_add_f32 v20, 1.0, v20
    v_add_f32 v21, 1.0, v21
    v_add_f32 v22, 1.0, v22
    v_add_f32 v23, 1.0, v23
    v_rcp_f32 v16, v16
    s_waitcnt lgkmcnt(3)
    v_mfma_f32_32x32x16_bf16 v[48:63], v[80:83], v[176:179], v[48:63]
    ds_read_b128 v[76:79], v3 offset:19456
    v_rcp_f32 v17, v17
    v_rcp_f32 v18, v18
    v_rcp_f32 v19, v19
    v_mfma_f32_32x32x16_bf16 v[48:63], v[84:87], v[180:183], v[48:63]
    ds_read_b128 v[80:83], v3 offset:20480
    v_rcp_f32 v20, v20
    v_rcp_f32 v21, v21
    v_rcp_f32 v22, v22
    v_mfma_f32_32x32x16_bf16 v[48:63], v[88:91], v[184:187], v[48:63]
    ds_read_b128 v[84:87], v3 offset:21504
    v_rcp_f32 v23, v23
    v_mul_f32 v16, v16, v24
    v_mul_f32 v17, v17, v25
    v_mul_f32 v18, v18, v26
    v_mul_f32 v19, v19, v27
    v_mul_f32 v20, v20, v28
    v_mfma_f32_32x32x16_bf16 v[48:63], v[92:95], v[188:191], v[48:63]
    ds_read_b128 v[88:91], v3 offset:22528
    v_mul_f32 v21, v21, v29
    v_mul_f32 v22, v22, v30
    v_mul_f32 v23, v23, v31
    v_cvt_pk_bf16_f32 v112, v16, v17
    v_cvt_pk_bf16_f32 v113, v18, v19
    v_cvt_pk_bf16_f32 v114, v20, v21
    v_cvt_pk_bf16_f32 v115, v22, v23
    s_waitcnt lgkmcnt(3)
    v_mfma_f32_32x32x16_bf16 v[48:63], v[64:67], v[192:195], v[48:63]
    ds_read_b128 v[92:95], v3 offset:23552
    s_add_u32 s57, s46, 0
    buffer_store_dwordx4 v[112:115], v2, s[8:11], s57 offen sc1
    s_waitcnt lgkmcnt(10)
    v_fma_f32 v32, -v8, v96, v32
    v_fma_f32 v33, -v8, v97, v33
    v_mfma_f32_32x32x16_bf16 v[48:63], v[68:71], v[196:199], v[48:63]
    ds_read_b128 v[64:67], v3 offset:24576
    v_fma_f32 v34, -v8, v98, v34
    v_fma_f32 v35, -v8, v99, v35
    v_fma_f32 v36, -v8, v100, v36
    v_fma_f32 v37, -v8, v101, v37
    v_fma_f32 v38, -v8, v102, v38
    v_fma_f32 v39, -v8, v103, v39
    v_fma_f32 v40, -v8, v104, v40
    v_mfma_f32_32x32x16_bf16 v[48:63], v[72:75], v[200:203], v[48:63]
    ds_read_b128 v[68:71], v3 offset:25600
    v_fma_f32 v41, -v8, v105, v41
    v_fma_f32 v42, -v8, v106, v42
    v_fma_f32 v43, -v8, v107, v43
    v_fma_f32 v44, -v8, v108, v44
    v_fma_f32 v45, -v8, v109, v45
    v_fma_f32 v46, -v8, v110, v46
    v_fma_f32 v47, -v8, v111, v47
    v_mfma_f32_32x32x16_bf16 v[48:63], v[76:79], v[204:207], v[48:63]
    ds_read_b128 v[72:75], v3 offset:26624
    v_mul_f32 v32, v32, v9
    v_mul_f32 v33, v33, v9
    v_mul_f32 v34, v34, v9
    v_mul_f32 v35, v35, v9
    v_mul_f32 v36, v36, v9
    v_mul_f32 v37, v37, v9
    v_mul_f32 v38, v38, v9
    s_waitcnt lgkmcnt(3)
    v_mfma_f32_32x32x16_bf16 v[48:63], v[80:83], v[208:211], v[48:63]
    ds_read_b128 v[76:79], v3 offset:27648
    v_mul_f32 v39, v39, v9
    ds_read_b128 v[96:99], v5 offset:256
    ds_read_b128 v[100:103], v5 offset:272
    ds_read_b128 v[104:107], v5 offset:288
    ds_read_b128 v[108:111], v5 offset:304
    v_exp_f32 v32, v32
    v_mfma_f32_32x32x16_bf16 v[48:63], v[84:87], v[212:215], v[48:63]
    ds_read_b128 v[80:83], v3 offset:28672
    v_mul_f32 v40, v40, v10
    v_exp_f32 v33, v33
    v_mul_f32 v41, v41, v10
    v_exp_f32 v34, v34
    v_mul_f32 v42, v42, v10
    v_mfma_f32_32x32x16_bf16 v[48:63], v[88:91], v[216:219], v[48:63]
    ds_read_b128 v[84:87], v3 offset:29696
    v_exp_f32 v35, v35
    v_mul_f32 v43, v43, v10
    v_exp_f32 v36, v36
    v_mul_f32 v44, v44, v10
    v_mfma_f32_32x32x16_bf16 v[48:63], v[92:95], v[220:223], v[48:63]
    ds_read_b128 v[88:91], v3 offset:30720
    v_exp_f32 v37, v37
    v_mul_f32 v45, v45, v10
    v_exp_f32 v38, v38
    v_mul_f32 v46, v46, v10
    s_waitcnt lgkmcnt(7)
    v_mfma_f32_32x32x16_bf16 v[48:63], v[64:67], v[224:227], v[48:63]
    ds_read_b128 v[92:95], v3 offset:31744
    v_exp_f32 v39, v39
    v_mul_f32 v47, v47, v10
    v_add_f32 v32, 1.0, v32
    v_add_f32 v33, 1.0, v33
    v_add_f32 v34, 1.0, v34
    v_add_f32 v35, 1.0, v35
    s_waitcnt vmcnt(13)
    s_barrier
    v_mov_b32 v14, s18
    v_mov_b32 v15, s19
    v_cmp_eq_u32 vcc, 0, v0
    s_lshl_b32 s57, s2, 7
    s_add_u32 s57, s57, 0x570040
    v_mov_b32 v11, 0x7f000000
    v_cndmask_b32 v11, v11, v0, vcc
    buffer_store_dwordx2 v[14:15], v11, s[8:11], s57 offen sc1
    v_mfma_f32_32x32x16_bf16 v[48:63], v[68:71], v[228:231], v[48:63]
    ds_read_b128 v[64:67], v3 offset:32768
    s_add_u32 m0, s45, 0
    s_add_u32 s89, s44, 163840
    buffer_load_dwordx4 v2, s[8:11], s89 offen offset:0 sc1 lds
    v_add_f32 v36, 1.0, v36
    v_add_f32 v37, 1.0, v37
    v_add_f32 v38, 1.0, v38
    v_mfma_f32_32x32x16_bf16 v[48:63], v[72:75], v[232:235], v[48:63]
    ds_read_b128 v[68:71], v3 offset:33792
    buffer_load_dwordx4 v2, s[8:11], s89 offen offset:1024 sc1 lds
    v_add_f32 v39, 1.0, v39
    v_rcp_f32 v32, v32
    v_mfma_f32_32x32x16_bf16 v[48:63], v[76:79], v[236:239], v[48:63]
    ds_read_b128 v[72:75], v3 offset:34816
    v_rcp_f32 v33, v33
    v_rcp_f32 v34, v34
    v_rcp_f32 v35, v35
    s_waitcnt lgkmcnt(3)
    v_mfma_f32_32x32x16_bf16 v[48:63], v[80:83], v[240:243], v[48:63]
    ds_read_b128 v[76:79], v3 offset:35840
    buffer_load_dwordx4 v2, s[8:11], s89 offen offset:2048 sc1 lds
    v_rcp_f32 v36, v36
    v_mfma_f32_32x32x16_bf16 v[48:63], v[84:87], v[244:247], v[48:63]
    ds_read_b128 v[80:83], v3 offset:36864
    v_rcp_f32 v37, v37
    v_rcp_f32 v38, v38
    v_rcp_f32 v39, v39
    v_mul_f32 v32, v32, v40
    v_mfma_f32_32x32x16_bf16 v[48:63], v[88:91], v[248:251], v[48:63]
    ds_read_b128 v[84:87], v3 offset:37888
    buffer_load_dwordx4 v2, s[8:11], s89 offen offset:3072 sc1 lds
    v_mul_f32 v33, v33, v41
    v_mul_f32 v34, v34, v42
    v_mul_f32 v35, v35, v43
    v_mfma_f32_32x32x16_bf16 v[48:63], v[92:95], v[252:255], v[48:63]
    ds_read_b128 v[88:91], v3 offset:38912
    v_mul_f32 v36, v36, v44
    v_mul_f32 v37, v37, v45
    v_mul_f32 v38, v38, v46
    v_mul_f32 v39, v39, v47
    v_cvt_pk_bf16_f32 v116, v32, v33
    v_cvt_pk_bf16_f32 v117, v34, v35
    v_cvt_pk_bf16_f32 v118, v36, v37
    s_waitcnt lgkmcnt(3)
    v_mfma_f32_32x32x16_bf16 v[16:31], v[64:67], v[128:131], 0
    ds_read_b128 v[92:95], v3 offset:39936
    s_add_u32 m0, s45, 16384
    s_add_u32 s89, s44, 180224
    buffer_load_dwordx4 v2, s[8:11], s89 offen offset:0 sc1 lds
    v_cvt_pk_bf16_f32 v119, v38, v39
    v_mfma_f32_32x32x16_bf16 v[16:31], v[68:71], v[132:135], v[16:31]
    ds_read_b128 v[64:67], v3 offset:40960
    s_add_u32 s57, s46, 4096
    buffer_store_dwordx4 v[116:119], v2, s[8:11], s57 offen sc1
    v_mfma_f32_32x32x16_bf16 v[16:31], v[72:75], v[136:139], v[16:31]
    ds_read_b128 v[68:71], v3 offset:41984
    s_waitcnt lgkmcnt(14)
    v_fma_f32 v48, -v8, v96, v48
    v_fma_f32 v49, -v8, v97, v49
    v_fma_f32 v50, -v8, v98, v50
    v_fma_f32 v51, -v8, v99, v51
    v_fma_f32 v52, -v8, v100, v52
    v_fma_f32 v53, -v8, v101, v53
    v_mfma_f32_32x32x16_bf16 v[16:31], v[76:79], v[140:143], v[16:31]
    ds_read_b128 v[72:75], v3 offset:43008
    v_fma_f32 v54, -v8, v102, v54
    v_fma_f32 v55, -v8, v103, v55
    v_fma_f32 v56, -v8, v104, v56
    v_fma_f32 v57, -v8, v105, v57
    v_fma_f32 v58, -v8, v106, v58
    v_fma_f32 v59, -v8, v107, v59
    v_fma_f32 v60, -v8, v108, v60
    s_waitcnt lgkmcnt(3)
    v_mfma_f32_32x32x16_bf16 v[16:31], v[80:83], v[144:147], v[16:31]
    ds_read_b128 v[76:79], v3 offset:44032
    buffer_load_dwordx4 v2, s[8:11], s89 offen offset:1024 sc1 lds
    v_fma_f32 v61, -v8, v109, v61
    v_fma_f32 v62, -v8, v110, v62
    v_fma_f32 v63, -v8, v111, v63
    v_mfma_f32_32x32x16_bf16 v[16:31], v[84:87], v[148:151], v[16:31]
    ds_read_b128 v[80:83], v3 offset:45056
    v_mul_f32 v48, v48, v9
    v_mul_f32 v49, v49, v9
    v_mul_f32 v50, v50, v9
    v_mul_f32 v51, v51, v9
    v_mul_f32 v52, v52, v9
    v_mul_f32 v53, v53, v9
    v_mul_f32 v54, v54, v9
    v_mfma_f32_32x32x16_bf16 v[16:31], v[88:91], v[152:155], v[16:31]
    ds_read_b128 v[84:87], v3 offset:46080
    buffer_load_dwordx4 v2, s[8:11], s89 offen offset:2048 sc1 lds
    v_mul_f32 v55, v55, v9
    ds_read_b128 v[96:99], v5 offset:384
    ds_read_b128 v[100:103], v5 offset:400
    v_mfma_f32_32x32x16_bf16 v[16:31], v[92:95], v[156:159], v[16:31]
    ds_read_b128 v[88:91], v3 offset:47104
    ds_read_b128 v[104:107], v5 offset:416
    ds_read_b128 v[108:111], v5 offset:432
    v_exp_f32 v48, v48
    v_mul_f32 v56, v56, v10
    v_exp_f32 v49, v49
    s_waitcnt lgkmcnt(7)
    v_mfma_f32_32x32x16_bf16 v[16:31], v[64:67], v[160:163], v[16:31]
    ds_read_b128 v[92:95], v3 offset:48128
    buffer_load_dwordx4 v2, s[8:11], s89 offen offset:3072 sc1 lds
    v_mul_f32 v57, v57, v10
    v_exp_f32 v50, v50
    v_mfma_f32_32x32x16_bf16 v[16:31], v[68:71], v[164:167], v[16:31]
    ds_read_b128 v[64:67], v3 offset:49152
    v_mul_f32 v58, v58, v10
    v_exp_f32 v51, v51
    v_mul_f32 v59, v59, v10
    v_exp_f32 v52, v52
    v_mul_f32 v60, v60, v10
    v_mfma_f32_32x32x16_bf16 v[16:31], v[72:75], v[168:171], v[16:31]
    ds_read_b128 v[68:71], v3 offset:50176
    s_add_u32 m0, s45, 32768
    s_add_u32 s89, s44, 196608
    buffer_load_dwordx4 v2, s[8:11], s89 offen offset:0 sc1 lds
    v_exp_f32 v53, v53
    v_mul_f32 v61, v61, v10
    v_mfma_f32_32x32x16_bf16 v[16:31], v[76:79], v[172:175], v[16:31]
    ds_read_b128 v[72:75], v3 offset:51200
    v_exp_f32 v54, v54
    v_mul_f32 v62, v62, v10
    v_exp_f32 v55, v55
    v_mul_f32 v63, v63, v10
    v_add_f32 v48, 1.0, v48
    s_waitcnt lgkmcnt(3)
    v_mfma_f32_32x32x16_bf16 v[16:31], v[80:83], v[176:179], v[16:31]
    ds_read_b128 v[76:79], v3 offset:52224
    buffer_load_dwordx4 v2, s[8:11], s89 offen offset:1024 sc1 lds
    v_add_f32 v49, 1.0, v49
    v_add_f32 v50, 1.0, v50
    v_add_f32 v51, 1.0, v51
    v_mfma_f32_32x32x16_bf16 v[16:31], v[84:87], v[180:183], v[16:31]
    ds_read_b128 v[80:83], v3 offset:53248
    v_add_f32 v52, 1.0, v52
    v_add_f32 v53, 1.0, v53
    v_add_f32 v54, 1.0, v54
    v_add_f32 v55, 1.0, v55
    v_rcp_f32 v48, v48
    v_mfma_f32_32x32x16_bf16 v[16:31], v[88:91], v[184:187], v[16:31]
    ds_read_b128 v[84:87], v3 offset:54272
    buffer_load_dwordx4 v2, s[8:11], s89 offen offset:2048 sc1 lds
    v_rcp_f32 v49, v49
    v_mfma_f32_32x32x16_bf16 v[16:31], v[92:95], v[188:191], v[16:31]
    ds_read_b128 v[88:91], v3 offset:55296
    v_rcp_f32 v50, v50
    v_rcp_f32 v51, v51
    v_rcp_f32 v52, v52
    s_waitcnt lgkmcnt(3)
    v_mfma_f32_32x32x16_bf16 v[16:31], v[64:67], v[192:195], v[16:31]
    ds_read_b128 v[92:95], v3 offset:56320
    buffer_load_dwordx4 v2, s[8:11], s89 offen offset:3072 sc1 lds
    v_rcp_f32 v53, v53
    v_mfma_f32_32x32x16_bf16 v[16:31], v[68:71], v[196:199], v[16:31]
    ds_read_b128 v[64:67], v3 offset:57344
    v_rcp_f32 v54, v54
    v_rcp_f32 v55, v55
    v_mul_f32 v48, v48, v56
    v_mul_f32 v49, v49, v57
    v_mul_f32 v50, v50, v58
    v_mfma_f32_32x32x16_bf16 v[16:31], v[72:75], v[200:203], v[16:31]
    ds_read_b128 v[68:71], v3 offset:58368
    s_add_u32 m0, s45, 49152
    s_add_u32 s89, s44, 212992
    buffer_load_dwordx4 v2, s[8:11], s89 offen offset:0 sc1 lds
    v_mul_f32 v51, v51, v59
    v_mul_f32 v52, v52, v60
    v_mul_f32 v53, v53, v61
    v_mfma_f32_32x32x16_bf16 v[16:31], v[76:79], v[204:207], v[16:31]
    ds_read_b128 v[72:75], v3 offset:59392
    v_mul_f32 v54, v54, v62
    v_mul_f32 v55, v55, v63
    v_cvt_pk_bf16_f32 v112, v48, v49
    v_cvt_pk_bf16_f32 v113, v50, v51
    v_cvt_pk_bf16_f32 v114, v52, v53
    v_cvt_pk_bf16_f32 v115, v54, v55
    s_waitcnt lgkmcnt(3)
    v_mfma_f32_32x32x16_bf16 v[16:31], v[80:83], v[208:211], v[16:31]
    ds_read_b128 v[76:79], v3 offset:60416
    buffer_load_dwordx4 v2, s[8:11], s89 offen offset:1024 sc1 lds
    v_mfma_f32_32x32x16_bf16 v[16:31], v[84:87], v[212:215], v[16:31]
    ds_read_b128 v[80:83], v3 offset:61440
    s_add_u32 s57, s46, 8192
    buffer_store_dwordx4 v[112:115], v2, s[8:11], s57 offen sc1
    v_mfma_f32_32x32x16_bf16 v[16:31], v[88:91], v[216:219], v[16:31]
    ds_read_b128 v[84:87], v3 offset:62464
    v_mfma_f32_32x32x16_bf16 v[16:31], v[92:95], v[220:223], v[16:31]
    ds_read_b128 v[88:91], v3 offset:63488
    s_waitcnt lgkmcnt(3)
    v_mfma_f32_32x32x16_bf16 v[16:31], v[64:67], v[224:227], v[16:31]
    ds_read_b128 v[92:95], v3 offset:64512
    buffer_load_dwordx4 v2, s[8:11], s89 offen offset:2048 sc1 lds
    s_waitcnt vmcnt(23)
    s_barrier
    v_mfma_f32_32x32x16_bf16 v[16:31], v[68:71], v[228:231], v[16:31]
    ds_read_b128 v[64:67], v4 offset:0
    v_mfma_f32_32x32x16_bf16 v[16:31], v[72:75], v[232:235], v[16:31]
    ds_read_b128 v[68:71], v4 offset:1024
    buffer_load_dwordx4 v2, s[8:11], s89 offen offset:3072 sc1 lds
    v_mfma_f32_32x32x16_bf16 v[16:31], v[76:79], v[236:239], v[16:31]
    ds_read_b128 v[72:75], v4 offset:2048
    s_waitcnt lgkmcnt(3)
    v_mfma_f32_32x32x16_bf16 v[16:31], v[80:83], v[240:243], v[16:31]
    ds_read_b128 v[76:79], v4 offset:3072
    buffer_load_dwordx4 a[0:3], v2, s[8:11], s98 offen offset:0 sc1
    v_mfma_f32_32x32x16_bf16 v[16:31], v[84:87], v[244:247], v[16:31]
    ds_read_b128 v[80:83], v4 offset:4096
    v_mfma_f32_32x32x16_bf16 v[16:31], v[88:91], v[248:251], v[16:31]
    ds_read_b128 v[84:87], v4 offset:5120
    buffer_load_dwordx4 a[4:7], v2, s[8:11], s99 offen offset:0 sc1
    v_mfma_f32_32x32x16_bf16 v[16:31], v[92:95], v[252:255], v[16:31]
    ds_read_b128 v[88:91], v4 offset:6144
    s_waitcnt lgkmcnt(3)
    v_mfma_f32_32x32x16_bf16 v[32:47], v[64:67], v[128:131], 0
    ds_read_b128 v[92:95], v4 offset:7168
    buffer_load_dwordx4 a[8:11], v2, s[8:11], s98 offen offset:1024 sc1
    v_mfma_f32_32x32x16_bf16 v[32:47], v[68:71], v[132:135], v[32:47]
    ds_read_b128 v[64:67], v4 offset:8192
    v_mfma_f32_32x32x16_bf16 v[32:47], v[72:75], v[136:139], v[32:47]
    ds_read_b128 v[68:71], v4 offset:9216
    buffer_load_dwordx4 a[12:15], v2, s[8:11], s99 offen offset:1024 sc1
    s_waitcnt lgkmcnt(15)
    v_mfma_f32_32x32x16_bf16 v[32:47], v[76:79], v[140:143], v[32:47]
    ds_read_b128 v[72:75], v4 offset:10240
    v_fma_f32 v16, -v8, v96, v16
    v_fma_f32 v17, -v8, v97, v17
    v_fma_f32 v18, -v8, v98, v18
    v_fma_f32 v19, -v8, v99, v19
    v_fma_f32 v20, -v8, v100, v20
    s_waitcnt lgkmcnt(3)
    v_mfma_f32_32x32x16_bf16 v[32:47], v[80:83], v[144:147], v[32:47]
    ds_read_b128 v[76:79], v4 offset:11264
    buffer_load_dwordx4 a[16:19], v2, s[8:11], s98 offen offset:2048 sc1
    v_fma_f32 v21, -v8, v101, v21
    v_mfma_f32_32x32x16_bf16 v[32:47], v[84:87], v[148:151], v[32:47]
    ds_read_b128 v[80:83], v4 offset:12288
    v_fma_f32 v22, -v8, v102, v22
    v_fma_f32 v23, -v8, v103, v23
    v_fma_f32 v24, -v8, v104, v24
    v_fma_f32 v25, -v8, v105, v25
    v_fma_f32 v26, -v8, v106, v26
    v_mfma_f32_32x32x16_bf16 v[32:47], v[88:91], v[152:155], v[32:47]
    ds_read_b128 v[84:87], v4 offset:13312
    buffer_load_dwordx4 a[20:23], v2, s[8:11], s99 offen offset:2048 sc1
    v_fma_f32 v27, -v8, v107, v27
    v_mfma_f32_32x32x16_bf16 v[32:47], v[92:95], v[156:159], v[32:47]
    ds_read_b128 v[88:91], v4 offset:14336
    v_fma_f32 v28, -v8, v108, v28
    v_fma_f32 v29, -v8, v109, v29
    v_fma_f32 v30, -v8, v110, v30
    v_fma_f32 v31, -v8, v111, v31
    v_mul_f32 v16, v16, v9
    s_waitcnt lgkmcnt(3)
    v_mfma_f32_32x32x16_bf16 v[32:47], v[64:67], v[160:163], v[32:47]
    ds_read_b128 v[92:95], v4 offset:15360
    buffer_load_dwordx4 a[24:27], v2, s[8:11], s98 offen offset:3072 sc1
    v_mul_f32 v17, v17, v9
    v_mfma_f32_32x32x16_bf16 v[32:47], v[68:71], v[164:167], v[32:47]
    ds_read_b128 v[64:67], v4 offset:16384
    v_mul_f32 v18, v18, v9
    v_mul_f32 v19, v19, v9
    v_mul_f32 v20, v20, v9
    v_mul_f32 v21, v21, v9
    v_mul_f32 v22, v22, v9
    v_mfma_f32_32x32x16_bf16 v[32:47], v[72:75], v[168:171], v[32:47]
    ds_read_b128 v[68:71], v4 offset:17408
    buffer_load_dwordx4 a[28:31], v2, s[8:11], s99 offen offset:3072 sc1
    v_mul_f32 v23, v23, v9
    v_mfma_f32_32x32x16_bf16 v[32:47], v[76:79], v[172:175], v[32:47]
    ds_read_b128 v[72:75], v4 offset:18432
    ds_read_b128 v[96:99], v5 offset:512
    ds_read_b128 v[100:103], v5 offset:528
    ds_read_b128 v[104:107], v5 offset:544
    ds_read_b128 v[108:111], v5 offset:560
    s_waitcnt lgkmcnt(7)
    v_mfma_f32_32x32x16_bf16 v[32:47], v[80:83], v[176:179], v[32:47]
    ds_read_b128 v[76:79], v4 offset:19456
    s_add_u32 s98, s98, 4096
    buffer_load_dwordx4 a[32:35], v2, s[8:11], s98 offen offset:0 sc1
    v_mfma_f32_32x32x16_bf16 v[32:47], v[84:87], v[180:183], v[32:47]
    ds_read_b128 v[80:83], v4 offset:20480
    v_exp_f32 v16, v16
    v_mul_f32 v24, v24, v10
    v_exp_f32 v17, v17
    s_waitcnt vmcnt(11)
    v_mov_b32 v14, s18
    v_mov_b32 v15, s19
    buffer_store_dwordx2 v[14:15], v7, s[8:11], s52 offen sc1
    v_mfma_f32_32x32x16_bf16 v[32:47], v[88:91], v[184:187], v[32:47]
    ds_read_b128 v[84:87], v4 offset:21504
    s_add_u32 s99, s99, 4096
    buffer_load_dwordx4 a[36:39], v2, s[8:11], s99 offen offset:0 sc1
    v_mul_f32 v25, v25, v10
    v_mfma_f32_32x32x16_bf16 v[32:47], v[92:95], v[188:191], v[32:47]
    ds_read_b128 v[88:91], v4 offset:22528
    v_exp_f32 v18, v18
    v_mul_f32 v26, v26, v10
    v_exp_f32 v19, v19
    s_waitcnt lgkmcnt(3)
    v_mfma_f32_32x32x16_bf16 v[32:47], v[64:67], v[192:195], v[32:47]
    ds_read_b128 v[92:95], v4 offset:23552
    buffer_load_dwordx4 a[40:43], v2, s[8:11], s98 offen offset:1024 sc1
    v_mul_f32 v27, v27, v10
    v_mfma_f32_32x32x16_bf16 v[32:47], v[68:71], v[196:199], v[32:47]
    ds_read_b128 v[64:67], v4 offset:24576
    v_exp_f32 v20, v20
    v_mul_f32 v28, v28, v10
    v_exp_f32 v21, v21
    v_mfma_f32_32x32x16_bf16 v[32:47], v[72:75], v[200:203], v[32:47]
    ds_read_b128 v[68:71], v4 offset:25600
    buffer_load_dwordx4 a[44:47], v2, s[8:11], s99 offen offset:1024 sc1
    v_mul_f32 v29, v29, v10
    v_mfma_f32_32x32x16_bf16 v[32:47], v[76:79], v[204:207], v[32:47]
    ds_read_b128 v[72:75], v4 offset:26624
    v_exp_f32 v22, v22
    v_mul_f32 v30, v30, v10
    v_exp_f32 v23, v23
    s_waitcnt lgkmcnt(3)
    v_mfma_f32_32x32x16_bf16 v[32:47], v[80:83], v[208:211], v[32:47]
    ds_read_b128 v[76:79], v4 offset:27648
    buffer_load_dwordx4 a[48:51], v2, s[8:11], s98 offen offset:2048 sc1
    v_mul_f32 v31, v31, v10
    v_mfma_f32_32x32x16_bf16 v[32:47], v[84:87], v[212:215], v[32:47]
    ds_read_b128 v[80:83], v4 offset:28672
    v_add_f32 v16, 1.0, v16
    v_add_f32 v17, 1.0, v17
    v_add_f32 v18, 1.0, v18
    v_add_f32 v19, 1.0, v19
    v_add_f32 v20, 1.0, v20
    v_mfma_f32_32x32x16_bf16 v[32:47], v[88:91], v[216:219], v[32:47]
    ds_read_b128 v[84:87], v4 offset:29696
    buffer_load_dwordx4 a[52:55], v2, s[8:11], s99 offen offset:2048 sc1
    v_add_f32 v21, 1.0, v21
    v_mfma_f32_32x32x16_bf16 v[32:47], v[92:95], v[220:223], v[32:47]
    ds_read_b128 v[88:91], v4 offset:30720
    v_add_f32 v22, 1.0, v22
    v_add_f32 v23, 1.0, v23
    v_rcp_f32 v16, v16
    s_waitcnt lgkmcnt(3)
    v_mfma_f32_32x32x16_bf16 v[32:47], v[64:67], v[224:227], v[32:47]
    buffer_load_dwordx4 a[56:59], v2, s[8:11], s98 offen offset:3072 sc1
    s_waitcnt vmcnt(25)
    s_barrier
    v_mfma_f32_32x32x16_bf16 v[32:47], v[68:71], v[228:231], v[32:47]
    ds_read_b128 v[64:67], v2 offset:0
    v_rcp_f32 v17, v17
    v_rcp_f32 v18, v18
    v_mfma_f32_32x32x16_bf16 v[32:47], v[72:75], v[232:235], v[32:47]
    ds_read_b128 v[68:71], v2 offset:1024
    buffer_load_dwordx4 a[60:63], v2, s[8:11], s99 offen offset:3072 sc1
    v_mfma_f32_32x32x16_bf16 v[32:47], v[76:79], v[236:239], v[32:47]
    ds_read_b128 v[72:75], v2 offset:2048
    v_rcp_f32 v19, v19
    v_rcp_f32 v20, v20
    s_waitcnt lgkmcnt(3)
    v_mfma_f32_32x32x16_bf16 v[32:47], v[80:83], v[240:243], v[32:47]
    ds_read_b128 v[76:79], v2 offset:3072
    s_add_u32 s98, s98, 4096
    buffer_load_dwordx4 a[64:67], v2, s[8:11], s98 offen offset:0 sc1
    v_mfma_f32_32x32x16_bf16 v[32:47], v[84:87], v[244:247], v[32:47]
    ds_read_b128 v[80:83], v2 offset:4096
    v_rcp_f32 v21, v21
    v_rcp_f32 v22, v22
    v_mfma_f32_32x32x16_bf16 v[32:47], v[88:91], v[248:251], v[32:47]
    ds_read_b128 v[84:87], v2 offset:5120
    s_add_u32 s99, s99, 4096
    buffer_load_dwordx4 a[68:71], v2, s[8:11], s99 offen offset:0 sc1
    v_mfma_f32_32x32x16_bf16 v[32:47], a[224:227], v[252:255], v[32:47]
    ds_read_b128 v[88:91], v2 offset:6144
    v_rcp_f32 v23, v23
    v_mul_f32 v16, v16, v24
    v_mul_f32 v17, v17, v25
    v_mul_f32 v18, v18, v26
    s_waitcnt lgkmcnt(3)
    v_mfma_f32_32x32x16_bf16 v[48:63], v[64:67], v[128:131], 0
    ds_read_b128 v[92:95], v2 offset:7168
    buffer_load_dwordx4 a[72:75], v2, s[8:11], s98 offen offset:1024 sc1
    v_mul_f32 v19, v19, v27
    v_mfma_f32_32x32x16_bf16 v[48:63], v[68:71], v[132:135], v[48:63]
    ds_read_b128 v[64:67], v2 offset:8192
    v_mul_f32 v20, v20, v28
    v_mul_f32 v21, v21, v29
    v_mul_f32 v22, v22, v30
    v_mul_f32 v23, v23, v31
    v_cvt_pk_bf16_f32 v116, v16, v17
    buffer_load_dwordx2 v[124:125], v6, s[8:11], s51 offen sc1
    v_mfma_f32_32x32x16_bf16 v[48:63], v[72:75], v[136:139], v[48:63]
    ds_read_b128 v[68:71], v2 offset:9216
    buffer_load_dwordx4 a[76:79], v2, s[8:11], s99 offen offset:1024 sc1
    v_cvt_pk_bf16_f32 v117, v18, v19
    v_mfma_f32_32x32x16_bf16 v[48:63], v[76:79], v[140:143], v[48:63]
    ds_read_b128 v[72:75], v2 offset:10240
    v_cvt_pk_bf16_f32 v118, v20, v21
    v_cvt_pk_bf16_f32 v119, v22, v23
    s_waitcnt lgkmcnt(3)
    v_mfma_f32_32x32x16_bf16 v[48:63], v[80:83], v[144:147], v[48:63]
    ds_read_b128 v[76:79], v2 offset:11264
    buffer_load_dwordx4 a[80:83], v2, s[8:11], s98 offen offset:2048 sc1
    v_mfma_f32_32x32x16_bf16 v[48:63], v[84:87], v[148:151], v[48:63]
    ds_read_b128 v[80:83], v2 offset:12288
    s_add_u32 s57, s46, 12288
    buffer_store_dwordx4 v[116:119], v2, s[8:11], s57 offen sc1
    s_waitcnt lgkmcnt(15)
    v_mfma_f32_32x32x16_bf16 v[48:63], v[88:91], v[152:155], v[48:63]
    ds_read_b128 v[84:87], v2 offset:13312
    v_fma_f32 v32, -v8, v96, v32
    v_fma_f32 v33, -v8, v97, v33
    v_fma_f32 v34, -v8, v98, v34
    v_fma_f32 v35, -v8, v99, v35
    v_fma_f32 v36, -v8, v100, v36
    v_mfma_f32_32x32x16_bf16 v[48:63], v[92:95], v[156:159], v[48:63]
    ds_read_b128 v[88:91], v2 offset:14336
    v_fma_f32 v37, -v8, v101, v37
    v_fma_f32 v38, -v8, v102, v38
    v_fma_f32 v39, -v8, v103, v39
    v_fma_f32 v40, -v8, v104, v40
    v_fma_f32 v41, -v8, v105, v41
    s_waitcnt lgkmcnt(3)
    v_mfma_f32_32x32x16_bf16 v[48:63], v[64:67], v[160:163], v[48:63]
    ds_read_b128 v[92:95], v2 offset:15360
    buffer_load_dwordx4 a[84:87], v2, s[8:11], s99 offen offset:2048 sc1
    v_fma_f32 v42, -v8, v106, v42
    v_mfma_f32_32x32x16_bf16 v[48:63], v[68:71], v[164:167], v[48:63]
    ds_read_b128 v[64:67], v2 offset:16384
    v_fma_f32 v43, -v8, v107, v43
    v_fma_f32 v44, -v8, v108, v44
    v_fma_f32 v45, -v8, v109, v45
    v_fma_f32 v46, -v8, v110, v46
    v_fma_f32 v47, -v8, v111, v47
    v_mfma_f32_32x32x16_bf16 v[48:63], v[72:75], v[168:171], v[48:63]
    ds_read_b128 v[68:71], v2 offset:17408
    buffer_load_dwordx4 a[88:91], v2, s[8:11], s98 offen offset:3072 sc1
    v_mul_f32 v32, v32, v9
    v_mfma_f32_32x32x16_bf16 v[48:63], v[76:79], v[172:175], v[48:63]
    ds_read_b128 v[72:75], v2 offset:18432
    v_mul_f32 v33, v33, v9
    v_mul_f32 v34, v34, v9
    v_mul_f32 v35, v35, v9
    v_mul_f32 v36, v36, v9
    v_mul_f32 v37, v37, v9
    s_waitcnt lgkmcnt(3)
    v_mfma_f32_32x32x16_bf16 v[48:63], v[80:83], v[176:179], v[48:63]
    ds_read_b128 v[76:79], v2 offset:19456
    buffer_load_dwordx4 a[92:95], v2, s[8:11], s99 offen offset:3072 sc1
    v_mul_f32 v38, v38, v9
    v_mfma_f32_32x32x16_bf16 v[48:63], v[84:87], v[180:183], v[48:63]
    ds_read_b128 v[80:83], v2 offset:20480
    v_mul_f32 v39, v39, v9
    ds_read_b128 v[96:99], v5 offset:640
    ds_read_b128 v[100:103], v5 offset:656
    ds_read_b128 v[104:107], v5 offset:672
    ds_read_b128 v[108:111], v5 offset:688
    v_mfma_f32_32x32x16_bf16 v[48:63], v[88:91], v[184:187], v[48:63]
    ds_read_b128 v[84:87], v2 offset:21504
    s_add_u32 s98, s98, 4096
    buffer_load_dwordx4 a[96:99], v2, s[8:11], s98 offen offset:0 sc1
    v_mfma_f32_32x32x16_bf16 v[48:63], v[92:95], v[188:191], v[48:63]
    ds_read_b128 v[88:91], v2 offset:22528
    v_exp_f32 v32, v32
    v_mul_f32 v40, v40, v10
    v_exp_f32 v33, v33
    s_waitcnt lgkmcnt(7)
    v_mfma_f32_32x32x16_bf16 v[48:63], v[64:67], v[192:195], v[48:63]
    ds_read_b128 v[92:95], v2 offset:23552
    s_add_u32 s99, s99, 4096
    buffer_load_dwordx4 a[100:103], v2, s[8:11], s99 offen offset:0 sc1
    v_mul_f32 v41, v41, v10
    v_mfma_f32_32x32x16_bf16 v[48:63], v[68:71], v[196:199], v[48:63]
    ds_read_b128 v[64:67], v2 offset:24576
    v_exp_f32 v34, v34
    v_mul_f32 v42, v42, v10
    v_exp_f32 v35, v35
    v_mfma_f32_32x32x16_bf16 v[48:63], v[72:75], v[200:203], v[48:63]
    ds_read_b128 v[68:71], v2 offset:25600
    buffer_load_dwordx4 a[104:107], v2, s[8:11], s98 offen offset:1024 sc1
    v_mul_f32 v43, v43, v10
    v_mfma_f32_32x32x16_bf16 v[48:63], v[76:79], v[204:207], v[48:63]
    ds_read_b128 v[72:75], v2 offset:26624
    v_exp_f32 v36, v36
    v_mul_f32 v44, v44, v10
    v_exp_f32 v37, v37
    s_waitcnt lgkmcnt(3)
    v_mfma_f32_32x32x16_bf16 v[48:63], v[80:83], v[208:211], v[48:63]
    ds_read_b128 v[76:79], v2 offset:27648
    buffer_load_dwordx4 a[108:111], v2, s[8:11], s99 offen offset:1024 sc1
    v_mul_f32 v45, v45, v10
    v_mfma_f32_32x32x16_bf16 v[48:63], v[84:87], v[212:215], v[48:63]
    ds_read_b128 v[80:83], v2 offset:28672
    v_exp_f32 v38, v38
    v_mul_f32 v46, v46, v10
    v_exp_f32 v39, v39
    v_mfma_f32_32x32x16_bf16 v[48:63], v[88:91], v[216:219], v[48:63]
    ds_read_b128 v[84:87], v2 offset:29696
    buffer_load_dwordx4 a[112:115], v2, s[8:11], s98 offen offset:2048 sc1
    v_mul_f32 v47, v47, v10
    v_mfma_f32_32x32x16_bf16 v[48:63], v[92:95], v[220:223], v[48:63]
    ds_read_b128 v[88:91], v2 offset:30720
    v_add_f32 v32, 1.0, v32
    v_add_f32 v33, 1.0, v33
    v_add_f32 v34, 1.0, v34
    v_add_f32 v35, 1.0, v35
    v_add_f32 v36, 1.0, v36
    s_waitcnt lgkmcnt(3)
    v_mfma_f32_32x32x16_bf16 v[48:63], v[64:67], v[224:227], v[48:63]
    ds_read_b128 v[92:95], v2 offset:31744
    buffer_load_dwordx4 a[116:119], v2, s[8:11], s99 offen offset:2048 sc1
    v_add_f32 v37, 1.0, v37
    s_waitcnt vmcnt(33)
    s_barrier
    v_mfma_f32_32x32x16_bf16 v[48:63], v[68:71], v[228:231], v[48:63]
    ds_read_b128 v[64:67], v2 offset:32768
    v_add_f32 v38, 1.0, v38
    v_add_f32 v39, 1.0, v39
    v_rcp_f32 v32, v32
    s_waitcnt vmcnt(12)
    v_cmp_eq_u64 vcc, s[18:19], v[124:125]
    s_cmp_eq_u64 vcc, -1
    s_cbranch_scc0 L_spin_31
L_ok_30:
    v_mfma_f32_32x32x16_bf16 v[48:63], v[72:75], v[232:235], v[48:63]
    ds_read_b128 v[68:71], v2 offset:33792
    buffer_load_dwordx4 a[120:123], v2, s[8:11], s98 offen offset:3072 sc1
    v_mfma_f32_32x32x16_bf16 v[48:63], v[76:79], v[236:239], v[48:63]
    ds_read_b128 v[72:75], v2 offset:34816
    v_rcp_f32 v33, v33
    v_rcp_f32 v34, v34
    s_waitcnt lgkmcnt(3)
    v_mfma_f32_32x32x16_bf16 v[48:63], v[80:83], v[240:243], v[48:63]
    ds_read_b128 v[76:79], v2 offset:35840
    buffer_load_dwordx4 a[124:127], v2, s[8:11], s99 offen offset:3072 sc1
    v_mfma_f32_32x32x16_bf16 v[48:63], v[84:87], v[244:247], v[48:63]
    ds_read_b128 v[80:83], v2 offset:36864
    v_rcp_f32 v35, v35
    v_rcp_f32 v36, v36
    v_mfma_f32_32x32x16_bf16 v[48:63], v[88:91], v[248:251], v[48:63]
    ds_read_b128 v[84:87], v2 offset:37888
    s_add_u32 s98, s98, 4096
    buffer_load_dwordx4 a[128:131], v2, s[8:11], s98 offen offset:0 sc1
    v_mfma_f32_32x32x16_bf16 v[48:63], v[92:95], v[252:255], v[48:63]
    ds_read_b128 v[88:91], v2 offset:38912
    v_rcp_f32 v37, v37
    v_rcp_f32 v38, v38
    s_waitcnt lgkmcnt(3)
    v_mfma_f32_32x32x16_bf16 v[16:31], v[64:67], v[128:131], 0
    ds_read_b128 v[92:95], v2 offset:39936
    s_add_u32 s99, s99, 4096
    buffer_load_dwordx4 a[132:135], v2, s[8:11], s99 offen offset:0 sc1
    v_rcp_f32 v39, v39
    v_mfma_f32_32x32x16_bf16 v[16:31], v[68:71], v[132:135], v[16:31]
    ds_read_b128 v[64:67], v2 offset:40960
    v_mul_f32 v32, v32, v40
    v_mul_f32 v33, v33, v41
    v_mul_f32 v34, v34, v42
    v_mul_f32 v35, v35, v43
    v_mul_f32 v36, v36, v44
    v_mul_f32 v37, v37, v45
    v_mfma_f32_32x32x16_bf16 v[16:31], v[72:75], v[136:139], v[16:31]
    ds_read_b128 v[68:71], v2 offset:41984
    s_add_u32 s54, s100, 0
    buffer_load_dwordx4 v[128:131], v2, s[8:11], s54 offen offset:0 sc1
    v_mul_f32 v38, v38, v46
    v_mul_f32 v39, v39, v47
    v_mfma_f32_32x32x16_bf16 v[16:31], v[76:79], v[140:143], v[16:31]
    ds_read_b128 v[72:75], v2 offset:43008
    s_add_u32 s55, s101, 0
    buffer_load_dwordx4 v[132:135], v2, s[8:11], s55 offen offset:0 sc1
    v_cvt_pk_bf16_f32 v112, v32, v33
    v_cvt_pk_bf16_f32 v113, v34, v35
    s_waitcnt lgkmcnt(3)
    v_mfma_f32_32x32x16_bf16 v[16:31], v[80:83], v[144:147], v[16:31]
    ds_read_b128 v[76:79], v2 offset:44032
    buffer_load_dwordx4 v[136:139], v2, s[8:11], s54 offen offset:1024 sc1
    v_cvt_pk_bf16_f32 v114, v36, v37
    v_cvt_pk_bf16_f32 v115, v38, v39
    v_mfma_f32_32x32x16_bf16 v[16:31], v[84:87], v[148:151], v[16:31]
    ds_read_b128 v[80:83], v2 offset:45056
    buffer_load_dwordx4 v[140:143], v2, s[8:11], s55 offen offset:1024 sc1
    v_mfma_f32_32x32x16_bf16 v[16:31], v[88:91], v[152:155], v[16:31]
    ds_read_b128 v[84:87], v2 offset:46080
    buffer_load_dwordx4 v[144:147], v2, s[8:11], s54 offen offset:2048 sc1
    v_mfma_f32_32x32x16_bf16 v[16:31], v[92:95], v[156:159], v[16:31]
    ds_read_b128 v[88:91], v2 offset:47104
    s_add_u32 s57, s46, 16384
    buffer_store_dwordx4 v[112:115], v2, s[8:11], s57 offen sc1
    s_waitcnt lgkmcnt(15)
    v_fma_f32 v48, -v8, v96, v48
    v_fma_f32 v49, -v8, v97, v49
    s_waitcnt lgkmcnt(3)
    v_mfma_f32_32x32x16_bf16 v[16:31], v[64:67], v[160:163], v[16:31]
    ds_read_b128 v[92:95], v2 offset:48128
    v_fma_f32 v50, -v8, v98, v50
    v_fma_f32 v51, -v8, v99, v51
    v_fma_f32 v52, -v8, v100, v52
    v_fma_f32 v53, -v8, v101, v53
    v_fma_f32 v54, -v8, v102, v54
    v_fma_f32 v55, -v8, v103, v55
    v_mfma_f32_32x32x16_bf16 v[16:31], v[68:71], v[164:167], v[16:31]
    ds_read_b128 v[64:67], v2 offset:49152
    buffer_load_dwordx4 v[148:151], v2, s[8:11], s55 offen offset:2048 sc1
    v_fma_f32 v56, -v8, v104, v56
    v_fma_f32 v57, -v8, v105, v57
    v_mfma_f32_32x32x16_bf16 v[16:31], v[72:75], v[168:171], v[16:31]
    ds_read_b128 v[68:71], v2 offset:50176
    buffer_load_dwordx4 v[152:155], v2, s[8:11], s54 offen offset:3072 sc1
    v_fma_f32 v58, -v8, v106, v58
    v_fma_f32 v59, -v8, v107, v59
    v_mfma_f32_32x32x16_bf16 v[16:31], v[76:79], v[172:175], v[16:31]
    ds_read_b128 v[72:75], v2 offset:51200
    buffer_load_dwordx4 v[156:159], v2, s[8:11], s55 offen offset:3072 sc1
    v_fma_f32 v60, -v8, v108, v60
    v_fma_f32 v61, -v8, v109, v61
    v_fma_f32 v62, -v8, v110, v62
    s_waitcnt lgkmcnt(3)
    v_mfma_f32_32x32x16_bf16 v[16:31], v[80:83], v[176:179], v[16:31]
    ds_read_b128 v[76:79], v2 offset:52224
    s_add_u32 s54, s100, 4096
    buffer_load_dwordx4 v[160:163], v2, s[8:11], s54 offen offset:0 sc1
    v_fma_f32 v63, -v8, v111, v63
    v_mul_f32 v48, v48, v9
    v_mul_f32 v49, v49, v9
    v_mfma_f32_32x32x16_bf16 v[16:31], v[84:87], v[180:183], v[16:31]
    ds_read_b128 v[80:83], v2 offset:53248
    v_mul_f32 v50, v50, v9
    v_mul_f32 v51, v51, v9
    v_mul_f32 v52, v52, v9
    v_mul_f32 v53, v53, v9
    v_mul_f32 v54, v54, v9
    v_mul_f32 v55, v55, v9
    ds_read_b128 v[96:99], v5 offset:768
    v_mfma_f32_32x32x16_bf16 v[16:31], v[88:91], v[184:187], v[16:31]
    ds_read_b128 v[84:87], v2 offset:54272
    s_add_u32 s55, s101, 4096
    buffer_load_dwordx4 v[164:167], v2, s[8:11], s55 offen offset:0 sc1
    ds_read_b128 v[100:103], v5 offset:784
    ds_read_b128 v[104:107], v5 offset:800
    v_mfma_f32_32x32x16_bf16 v[16:31], v[92:95], v[188:191], v[16:31]
    ds_read_b128 v[88:91], v2 offset:55296
    buffer_load_dwordx4 v[168:171], v2, s[8:11], s54 offen offset:1024 sc1
    ds_read_b128 v[108:111], v5 offset:816
    v_exp_f32 v48, v48
    s_waitcnt lgkmcnt(7)
    v_mfma_f32_32x32x16_bf16 v[16:31], v[64:67], v[192:195], v[16:31]
    ds_read_b128 v[92:95], v2 offset:56320
    buffer_load_dwordx4 v[172:175], v2, s[8:11], s55 offen offset:1024 sc1
    v_mul_f32 v56, v56, v10
    v_exp_f32 v49, v49
    v_mfma_f32_32x32x16_bf16 v[16:31], v[68:71], v[196:199], v[16:31]
    ds_read_b128 v[64:67], v2 offset:57344
    buffer_load_dwordx4 v[176:179], v2, s[8:11], s54 offen offset:2048 sc1
    v_mul_f32 v57, v57, v10
    v_exp_f32 v50, v50
    v_mfma_f32_32x32x16_bf16 v[16:31], v[72:75], v[200:203], v[16:31]
    ds_read_b128 v[68:71], v2 offset:58368
    buffer_load_dwordx4 v[180:183], v2, s[8:11], s55 offen offset:2048 sc1
    v_mul_f32 v58, v58, v10
    v_exp_f32 v51, v51
    v_mfma_f32_32x32x16_bf16 v[16:31], v[76:79], v[204:207], v[16:31]
    ds_read_b128 v[72:75], v2 offset:59392
    v_mul_f32 v59, v59, v10
    v_exp_f32 v52, v52
    v_mul_f32 v60, v60, v10
    v_exp_f32 v53, v53
    v_mul_f32 v61, v61, v10
    s_waitcnt lgkmcnt(3)
    v_mfma_f32_32x32x16_bf16 v[16:31], v[80:83], v[208:211], v[16:31]
    ds_read_b128 v[76:79], v2 offset:60416
    buffer_load_dwordx4 v[184:187], v2, s[8:11], s54 offen offset:3072 sc1
    v_exp_f32 v54, v54
    v_mul_f32 v62, v62, v10
    v_mfma_f32_32x32x16_bf16 v[16:31], v[84:87], v[212:215], v[16:31]
    ds_read_b128 v[80:83], v2 offset:61440
    buffer_load_dwordx4 v[188:191], v2, s[8:11], s55 offen offset:3072 sc1
    v_exp_f32 v55, v55
    v_mul_f32 v63, v63, v10
    v_mfma_f32_32x32x16_bf16 v[16:31], v[88:91], v[216:219], v[16:31]
    ds_read_b128 v[84:87], v2 offset:62464
    s_add_u32 s54, s100, 8192
    buffer_load_dwordx4 v[192:195], v2, s[8:11], s54 offen offset:0 sc1
    v_add_f32 v48, 1.0, v48
    v_add_f32 v49, 1.0, v49
    v_add_f32 v50, 1.0, v50
    v_mfma_f32_32x32x16_bf16 v[16:31], v[92:95], v[220:223], v[16:31]
    ds_read_b128 v[88:91], v2 offset:63488
    s_add_u32 s55, s101, 8192
    buffer_load_dwordx4 v[196:199], v2, s[8:11], s55 offen offset:0 sc1
    v_add_f32 v51, 1.0, v51
    v_add_f32 v52, 1.0, v52
    v_add_f32 v53, 1.0, v53
    s_waitcnt lgkmcnt(3)
    v_mfma_f32_32x32x16_bf16 v[16:31], v[64:67], v[224:227], v[16:31]
    ds_read_b128 v[92:95], v2 offset:64512
    buffer_load_dwordx4 v[200:203], v2, s[8:11], s54 offen offset:1024 sc1
    v_add_f32 v54, 1.0, v54
    v_add_f32 v55, 1.0, v55
    v_mfma_f32_32x32x16_bf16 v[16:31], v[68:71], v[228:231], v[16:31]
    v_rcp_f32 v48, v48
    v_rcp_f32 v49, v49
    v_rcp_f32 v50, v50
    v_mfma_f32_32x32x16_bf16 v[16:31], v[72:75], v[232:235], v[16:31]
    buffer_load_dwordx4 v[204:207], v2, s[8:11], s55 offen offset:1024 sc1
    v_rcp_f32 v51, v51
    v_mfma_f32_32x32x16_bf16 v[16:31], v[76:79], v[236:239], v[16:31]
    buffer_load_dwordx4 v[208:211], v2, s[8:11], s54 offen offset:2048 sc1
    v_rcp_f32 v52, v52
    v_rcp_f32 v53, v53
    s_waitcnt lgkmcnt(0)
    v_mfma_f32_32x32x16_bf16 v[16:31], v[80:83], v[240:243], v[16:31]
    buffer_load_dwordx4 v[212:215], v2, s[8:11], s55 offen offset:2048 sc1
    v_rcp_f32 v54, v54
    v_rcp_f32 v55, v55
    v_mfma_f32_32x32x16_bf16 v[16:31], v[84:87], v[244:247], v[16:31]
    buffer_load_dwordx4 v[216:219], v2, s[8:11], s54 offen offset:3072 sc1
    v_mul_f32 v48, v48, v56
    v_mul_f32 v49, v49, v57
    v_mul_f32 v50, v50, v58
    v_mul_f32 v51, v51, v59
    v_mfma_f32_32x32x16_bf16 v[16:31], v[88:91], v[248:251], v[16:31]
    buffer_load_dwordx4 v[220:223], v2, s[8:11], s55 offen offset:3072 sc1
    v_mul_f32 v52, v52, v60
    v_mul_f32 v53, v53, v61
    v_mul_f32 v54, v54, v62
    v_mul_f32 v55, v55, v63
    v_cvt_pk_bf16_f32 v116, v48, v49
    v_mfma_f32_32x32x16_bf16 v[16:31], v[92:95], v[252:255], v[16:31]
    v_cvt_pk_bf16_f32 v117, v50, v51
    v_cvt_pk_bf16_f32 v118, v52, v53
    v_cvt_pk_bf16_f32 v119, v54, v55
    s_add_u32 s57, s46, 20480
    buffer_store_dwordx4 v[116:119], v2, s[8:11], s57 offen sc1
    s_waitcnt vmcnt(24)
    v_mfma_f32_32x32x16_bf16 v[32:47], a[0:3], v[128:131], 0
    s_waitcnt lgkmcnt(9)
    s_nop 3
    v_fma_f32 v16, -v8, v96, v16
    v_fma_f32 v17, -v8, v97, v17
    v_fma_f32 v18, -v8, v98, v18
    v_fma_f32 v19, -v8, v99, v19
    v_fma_f32 v20, -v8, v100, v20
    v_fma_f32 v21, -v8, v101, v21
    v_fma_f32 v22, -v8, v102, v22
    v_mfma_f32_32x32x16_bf16 v[48:63], a[4:7], v[128:131], 0
    s_add_u32 s54, s100, 12288
    buffer_load_dwordx4 v[224:227], v2, s[8:11], s54 offen offset:0 sc1
    v_fma_f32 v23, -v8, v103, v23
    v_fma_f32 v24, -v8, v104, v24
    v_fma_f32 v25, -v8, v105, v25
    v_fma_f32 v26, -v8, v106, v26
    v_mfma_f32_32x32x16_bf16 v[64:79], a[0:3], v[132:135], 0
    s_add_u32 s55, s101, 12288
    buffer_load_dwordx4 v[228:231], v2, s[8:11], s55 offen offset:0 sc1
    v_fma_f32 v27, -v8, v107, v27
    v_fma_f32 v28, -v8, v108, v28
    v_fma_f32 v29, -v8, v109, v29
    v_fma_f32 v30, -v8, v110, v30
    v_mfma_f32_32x32x16_bf16 v[80:95], a[4:7], v[132:135], 0
    buffer_load_dwordx4 v[232:235], v2, s[8:11], s54 offen offset:1024 sc1
    v_fma_f32 v31, -v8, v111, v31
    v_mul_f32 v16, v16, v9
    v_mul_f32 v17, v17, v9
    v_mul_f32 v18, v18, v9
    s_waitcnt vmcnt(25)
    v_mfma_f32_32x32x16_bf16 v[32:47], a[8:11], v[136:139], v[32:47]
    buffer_load_dwordx4 v[236:239], v2, s[8:11], s55 offen offset:1024 sc1
    v_mul_f32 v19, v19, v9
    v_mul_f32 v20, v20, v9
    v_mul_f32 v21, v21, v9
    v_mul_f32 v22, v22, v9
    v_mfma_f32_32x32x16_bf16 v[48:63], a[12:15], v[136:139], v[48:63]
    v_mul_f32 v23, v23, v9
    v_exp_f32 v16, v16
    v_mul_f32 v24, v24, v10
    v_exp_f32 v17, v17
    v_mul_f32 v25, v25, v10
    v_mfma_f32_32x32x16_bf16 v[64:79], a[8:11], v[140:143], v[64:79]
    buffer_load_dwordx4 v[240:243], v2, s[8:11], s54 offen offset:2048 sc1
    v_exp_f32 v18, v18
    v_mul_f32 v26, v26, v10
    v_mfma_f32_32x32x16_bf16 v[80:95], a[12:15], v[140:143], v[80:95]
    buffer_load_dwordx4 v[244:247], v2, s[8:11], s55 offen offset:2048 sc1
    v_exp_f32 v19, v19
    v_mul_f32 v27, v27, v10
    s_waitcnt vmcnt(25)
    v_mfma_f32_32x32x16_bf16 v[32:47], a[16:19], v[144:147], v[32:47]
    buffer_load_dwordx4 v[248:251], v2, s[8:11], s54 offen offset:3072 sc1
    v_exp_f32 v20, v20
    v_mul_f32 v28, v28, v10
    v_mfma_f32_32x32x16_bf16 v[48:63], a[20:23], v[144:147], v[48:63]
    buffer_load_dwordx4 v[252:255], v2, s[8:11], s55 offen offset:3072 sc1
    v_exp_f32 v21, v21
    v_mul_f32 v29, v29, v10
    v_mfma_f32_32x32x16_bf16 v[64:79], a[16:19], v[148:151], v[64:79]
    buffer_load_dwordx4 a[136:139], v2, s[8:11], s98 offen offset:1024 sc1
    v_exp_f32 v22, v22
    v_mul_f32 v30, v30, v10
    v_mfma_f32_32x32x16_bf16 v[80:95], a[20:23], v[148:151], v[80:95]
    v_exp_f32 v23, v23
    v_mul_f32 v31, v31, v10
    v_add_f32 v16, 1.0, v16
    v_add_f32 v17, 1.0, v17
    v_add_f32 v18, 1.0, v18
    v_add_f32 v19, 1.0, v19
    v_add_f32 v20, 1.0, v20
    s_waitcnt vmcnt(26)
    v_mfma_f32_32x32x16_bf16 v[32:47], a[24:27], v[152:155], v[32:47]
    s_add_u32 s54, s100, 16384
    buffer_load_dwordx4 v[128:131], v2, s[8:11], s54 offen offset:0 sc1
    v_add_f32 v21, 1.0, v21
    v_add_f32 v22, 1.0, v22
    v_add_f32 v23, 1.0, v23
    v_mfma_f32_32x32x16_bf16 v[48:63], a[28:31], v[152:155], v[48:63]
    s_add_u32 s55, s101, 16384
    buffer_load_dwordx4 v[132:135], v2, s[8:11], s55 offen offset:0 sc1
    v_rcp_f32 v16, v16
    v_rcp_f32 v17, v17
    v_mfma_f32_32x32x16_bf16 v[64:79], a[24:27], v[156:159], v[64:79]
    buffer_load_dwordx4 v[136:139], v2, s[8:11], s54 offen offset:1024 sc1
    v_rcp_f32 v18, v18
    v_rcp_f32 v19, v19
    v_mfma_f32_32x32x16_bf16 v[80:95], a[28:31], v[156:159], v[80:95]
    buffer_load_dwordx4 v[140:143], v2, s[8:11], s55 offen offset:1024 sc1
    v_rcp_f32 v20, v20
    v_rcp_f32 v21, v21
    s_waitcnt vmcnt(28)
    v_mfma_f32_32x32x16_bf16 v[32:47], a[32:35], v[160:163], v[32:47]
    buffer_load_dwordx4 a[140:143], v2, s[8:11], s99 offen offset:1024 sc1
    v_rcp_f32 v22, v22
    v_rcp_f32 v23, v23
    v_mfma_f32_32x32x16_bf16 v[48:63], a[36:39], v[160:163], v[48:63]
    v_mul_f32 v16, v16, v24
    v_mul_f32 v17, v17, v25
    v_mul_f32 v18, v18, v26
    v_mul_f32 v19, v19, v27
    v_mul_f32 v20, v20, v28
    v_mul_f32 v21, v21, v29
    v_mul_f32 v22, v22, v30
    v_mul_f32 v23, v23, v31
    v_mfma_f32_32x32x16_bf16 v[64:79], a[32:35], v[164:167], v[64:79]
    buffer_load_dwordx4 v[144:147], v2, s[8:11], s54 offen offset:2048 sc1
    v_cvt_pk_bf16_f32 v112, v16, v17
    v_cvt_pk_bf16_f32 v113, v18, v19
    v_cvt_pk_bf16_f32 v114, v20, v21
    v_cvt_pk_bf16_f32 v115, v22, v23
    v_mfma_f32_32x32x16_bf16 v[80:95], a[36:39], v[164:167], v[80:95]
    buffer_load_dwordx4 a[144:147], v2, s[8:11], s98 offen offset:2048 sc1
    s_add_u32 s57, s46, 24576
    buffer_store_dwordx4 v[112:115], v2, s[8:11], s57 offen sc1
    s_waitcnt vmcnt(30)
    v_mfma_f32_32x32x16_bf16 v[32:47], a[40:43], v[168:171], v[32:47]
    v_accvgpr_read_b32 v96, a228
    v_accvgpr_read_b32 v97, a229
    v_accvgpr_read_b32 v98, a230
    v_accvgpr_read_b32 v99, a231
    v_accvgpr_read_b32 v100, a232
    v_accvgpr_read_b32 v101, a233
    v_accvgpr_read_b32 v102, a234
    v_accvgpr_read_b32 v103, a235
    v_mfma_f32_32x32x16_bf16 v[48:63], a[44:47], v[168:171], v[48:63]
    buffer_load_dwordx4 v[148:151], v2, s[8:11], s55 offen offset:2048 sc1
    v_mfma_f32_32x32x16_bf16 v[64:79], a[40:43], v[172:175], v[64:79]
    buffer_load_dwordx4 a[148:151], v2, s[8:11], s99 offen offset:2048 sc1
    v_mfma_f32_32x32x16_bf16 v[80:95], a[44:47], v[172:175], v[80:95]
    buffer_load_dwordx4 v[152:155], v2, s[8:11], s54 offen offset:3072 sc1
    s_waitcnt vmcnt(31)
    v_mfma_f32_32x32x16_bf16 v[32:47], a[48:51], v[176:179], v[32:47]
    buffer_load_dwordx4 a[152:155], v2, s[8:11], s98 offen offset:3072 sc1
    v_mfma_f32_32x32x16_bf16 v[48:63], a[52:55], v[176:179], v[48:63]
    buffer_load_dwordx4 v[156:159], v2, s[8:11], s55 offen offset:3072 sc1
    v_mfma_f32_32x32x16_bf16 v[64:79], a[48:51], v[180:183], v[64:79]
    buffer_load_dwordx4 a[156:159], v2, s[8:11], s99 offen offset:3072 sc1
    v_mfma_f32_32x32x16_bf16 v[80:95], a[52:55], v[180:183], v[80:95]
    s_add_u32 s98, s98, 4096
    buffer_load_dwordx4 a[160:163], v2, s[8:11], s98 offen offset:0 sc1
    s_waitcnt vmcnt(33)
    v_mfma_f32_32x32x16_bf16 v[32:47], a[56:59], v[184:187], v[32:47]
    s_add_u32 s99, s99, 4096
    buffer_load_dwordx4 a[164:167], v2, s[8:11], s99 offen offset:0 sc1
    v_mfma_f32_32x32x16_bf16 v[48:63], a[60:63], v[184:187], v[48:63]
    v_mfma_f32_32x32x16_bf16 v[64:79], a[56:59], v[188:191], v[64:79]
    buffer_load_dwordx4 a[168:171], v2, s[8:11], s98 offen offset:1024 sc1
    v_mfma_f32_32x32x16_bf16 v[80:95], a[60:63], v[188:191], v[80:95]
    buffer_load_dwordx4 a[172:175], v2, s[8:11], s99 offen offset:1024 sc1
    s_waitcnt vmcnt(34)
    v_mfma_f32_32x32x16_bf16 v[32:47], a[64:67], v[192:195], v[32:47]
    s_add_u32 s54, s100, 20480
    buffer_load_dwordx4 v[160:163], v2, s[8:11], s54 offen offset:0 sc1
    v_mfma_f32_32x32x16_bf16 v[48:63], a[68:71], v[192:195], v[48:63]
    s_add_u32 s55, s101, 20480
    buffer_load_dwordx4 v[164:167], v2, s[8:11], s55 offen offset:0 sc1
    v_mfma_f32_32x32x16_bf16 v[64:79], a[64:67], v[196:199], v[64:79]
    buffer_load_dwordx4 v[168:171], v2, s[8:11], s54 offen offset:1024 sc1
    v_mfma_f32_32x32x16_bf16 v[80:95], a[68:71], v[196:199], v[80:95]
    buffer_load_dwordx4 v[172:175], v2, s[8:11], s55 offen offset:1024 sc1
    s_waitcnt vmcnt(36)
    v_mfma_f32_32x32x16_bf16 v[32:47], a[72:75], v[200:203], v[32:47]
    buffer_load_dwordx4 v[176:179], v2, s[8:11], s54 offen offset:2048 sc1
    v_mfma_f32_32x32x16_bf16 v[48:63], a[76:79], v[200:203], v[48:63]
    buffer_load_dwordx4 a[176:179], v2, s[8:11], s98 offen offset:2048 sc1
    v_mfma_f32_32x32x16_bf16 v[64:79], a[72:75], v[204:207], v[64:79]
    buffer_load_dwordx4 v[180:183], v2, s[8:11], s55 offen offset:2048 sc1
    v_mfma_f32_32x32x16_bf16 v[80:95], a[76:79], v[204:207], v[80:95]
    buffer_load_dwordx4 a[180:183], v2, s[8:11], s99 offen offset:2048 sc1
    s_waitcnt vmcnt(38)
    v_mfma_f32_32x32x16_bf16 v[32:47], a[80:83], v[208:211], v[32:47]
    s_waitcnt vmcnt(27)
    v_max3_u32 v12, v224, v225, v226
    v_max3_u32 v13, v227, v228, v229
    buffer_load_dwordx4 v[184:187], v2, s[8:11], s54 offen offset:3072 sc1
    v_mfma_f32_32x32x16_bf16 v[48:63], a[84:87], v[208:211], v[48:63]
    v_max3_u32 v12, v12, v230, v231
    v_max3_u32 v13, v13, v232, v233
    v_max3_u32 v12, v12, v234, v235
    v_mfma_f32_32x32x16_bf16 v[64:79], a[80:83], v[212:215], v[64:79]
    v_max3_u32 v13, v13, v236, v237
    v_max3_u32 v12, v12, v238, v239
    v_max3_u32 v13, v13, v240, v241
    buffer_load_dwordx4 a[184:187], v2, s[8:11], s98 offen offset:3072 sc1
    v_mfma_f32_32x32x16_bf16 v[80:95], a[84:87], v[212:215], v[80:95]
    v_max3_u32 v12, v12, v242, v243
    v_max3_u32 v13, v13, v244, v245
    v_max3_u32 v12, v12, v246, v247
    buffer_load_dwordx4 v[188:191], v2, s[8:11], s55 offen offset:3072 sc1
    s_waitcnt vmcnt(39)
    v_mfma_f32_32x32x16_bf16 v[32:47], a[88:91], v[216:219], v[32:47]
    v_max3_u32 v13, v13, v248, v249
    v_max3_u32 v12, v12, v250, v251
    v_max3_u32 v13, v13, v252, v253
    buffer_load_dwordx4 a[188:191], v2, s[8:11], s99 offen offset:3072 sc1
    v_mfma_f32_32x32x16_bf16 v[48:63], a[92:95], v[216:219], v[48:63]
    v_max3_u32 v12, v12, v254, v255
    v_max3_u32 v12, v12, v13, v13
    v_cmp_eq_u32 vcc, -1, v12
    s_cbranch_vccnz L_vsp_33
L_vok_32:
    s_add_u32 s98, s98, 4096
    buffer_load_dwordx4 a[192:195], v2, s[8:11], s98 offen offset:0 sc1
    v_lshlrev_b32 v11, 7, v0
    s_mov_b32 s3, 0x570040
    buffer_load_dwordx2 v[124:125], v11, s[8:11], s3 offen sc1
    v_mfma_f32_32x32x16_bf16 v[64:79], a[88:91], v[220:223], v[64:79]
    s_add_u32 s99, s99, 4096
    buffer_load_dwordx4 a[196:199], v2, s[8:11], s99 offen offset:0 sc1
    v_mfma_f32_32x32x16_bf16 v[80:95], a[92:95], v[220:223], v[80:95]
    s_waitcnt vmcnt(40)
    v_mfma_f32_32x32x16_bf16 v[32:47], a[96:99], v[224:227], v[32:47]
    s_add_u32 s54, s100, 24576
    buffer_load_dwordx4 v[192:195], v2, s[8:11], s54 offen offset:0 sc1
    v_mfma_f32_32x32x16_bf16 v[48:63], a[100:103], v[224:227], v[48:63]
    s_add_u32 s55, s101, 24576
    buffer_load_dwordx4 v[196:199], v2, s[8:11], s55 offen offset:0 sc1
    v_mfma_f32_32x32x16_bf16 v[64:79], a[96:99], v[228:231], v[64:79]
    buffer_load_dwordx4 v[200:203], v2, s[8:11], s54 offen offset:1024 sc1
    v_mfma_f32_32x32x16_bf16 v[80:95], a[100:103], v[228:231], v[80:95]
    buffer_load_dwordx4 a[200:203], v2, s[8:11], s98 offen offset:1024 sc1
    s_waitcnt vmcnt(42)
    v_mfma_f32_32x32x16_bf16 v[32:47], a[104:107], v[232:235], v[32:47]
    buffer_load_dwordx4 v[204:207], v2, s[8:11], s55 offen offset:1024 sc1
    v_mfma_f32_32x32x16_bf16 v[48:63], a[108:111], v[232:235], v[48:63]
    v_mfma_f32_32x32x16_bf16 v[64:79], a[104:107], v[236:239], v[64:79]
    buffer_load_dwordx4 a[204:207], v2, s[8:11], s99 offen offset:1024 sc1
    v_mfma_f32_32x32x16_bf16 v[80:95], a[108:111], v[236:239], v[80:95]
    buffer_load_dwordx4 v[208:211], v2, s[8:11], s54 offen offset:2048 sc1
    s_waitcnt vmcnt(43)
    v_mfma_f32_32x32x16_bf16 v[32:47], a[112:115], v[240:243], v[32:47]
    s_waitcnt vmcnt(27)
    v_max3_u32 v12, v128, v129, v130
    v_max3_u32 v13, v131, v132, v133
    buffer_load_dwordx4 a[208:211], v2, s[8:11], s98 offen offset:2048 sc1
    v_mfma_f32_32x32x16_bf16 v[48:63], a[116:119], v[240:243], v[48:63]
    v_max3_u32 v12, v12, v134, v135
    v_max3_u32 v13, v13, v136, v137
    v_max3_u32 v12, v12, v138, v139
    buffer_load_dwordx4 v[212:215], v2, s[8:11], s55 offen offset:2048 sc1
    v_mfma_f32_32x32x16_bf16 v[64:79], a[112:115], v[244:247], v[64:79]
    v_max3_u32 v13, v13, v140, v141
    v_max3_u32 v12, v12, v142, v143
    v_max3_u32 v13, v13, v144, v145
    buffer_load_dwordx4 a[212:215], v2, s[8:11], s99 offen offset:2048 sc1
    v_mfma_f32_32x32x16_bf16 v[80:95], a[116:119], v[244:247], v[80:95]
    v_max3_u32 v12, v12, v146, v147
    v_max3_u32 v13, v13, v148, v149
    v_max3_u32 v12, v12, v150, v151
    buffer_load_dwordx4 v[216:219], v2, s[8:11], s54 offen offset:3072 sc1
    s_waitcnt vmcnt(45)
    v_mfma_f32_32x32x16_bf16 v[32:47], a[120:123], v[248:251], v[32:47]
    v_max3_u32 v13, v13, v152, v153
    v_max3_u32 v12, v12, v154, v155
    v_max3_u32 v13, v13, v156, v157
    buffer_load_dwordx4 a[216:219], v2, s[8:11], s98 offen offset:3072 sc1
    v_mfma_f32_32x32x16_bf16 v[48:63], a[124:127], v[248:251], v[48:63]
    v_max3_u32 v12, v12, v158, v159
    v_max3_u32 v12, v12, v13, v13
    v_cmp_eq_u32 vcc, -1, v12
    s_cbranch_vccnz L_vsp_35
L_vok_34:
    buffer_load_dwordx4 v[220:223], v2, s[8:11], s55 offen offset:3072 sc1
    v_mfma_f32_32x32x16_bf16 v[64:79], a[120:123], v[252:255], v[64:79]
    buffer_load_dwordx4 a[220:223], v2, s[8:11], s99 offen offset:3072 sc1
    v_mfma_f32_32x32x16_bf16 v[80:95], a[124:127], v[252:255], v[80:95]
    s_waitcnt vmcnt(45)
    v_mfma_f32_32x32x16_bf16 v[32:47], a[128:131], v[128:131], v[32:47]
    v_mfma_f32_32x32x16_bf16 v[48:63], a[132:135], v[128:131], v[48:63]
    v_mfma_f32_32x32x16_bf16 v[64:79], a[128:131], v[132:135], v[64:79]
    v_mfma_f32_32x32x16_bf16 v[80:95], a[132:135], v[132:135], v[80:95]
    s_waitcnt vmcnt(42)
    v_mfma_f32_32x32x16_bf16 v[32:47], a[136:139], v[136:139], v[32:47]
    v_mfma_f32_32x32x16_bf16 v[48:63], a[140:143], v[136:139], v[48:63]
    v_mfma_f32_32x32x16_bf16 v[64:79], a[136:139], v[140:143], v[64:79]
    v_mfma_f32_32x32x16_bf16 v[80:95], a[140:143], v[140:143], v[80:95]
    s_waitcnt vmcnt(37)
    v_mfma_f32_32x32x16_bf16 v[32:47], a[144:147], v[144:147], v[32:47]
    s_waitcnt vmcnt(18)
    v_max3_u32 v12, v160, v161, v162
    v_max3_u32 v13, v163, v164, v165
    v_mfma_f32_32x32x16_bf16 v[48:63], a[148:151], v[144:147], v[48:63]
    v_max3_u32 v12, v12, v166, v167
    v_max3_u32 v13, v13, v168, v169
    v_max3_u32 v12, v12, v170, v171
    v_mfma_f32_32x32x16_bf16 v[64:79], a[144:147], v[148:151], v[64:79]
    v_max3_u32 v13, v13, v172, v173
    v_max3_u32 v12, v12, v174, v175
    v_max3_u32 v13, v13, v176, v177
    v_mfma_f32_32x32x16_bf16 v[80:95], a[148:151], v[148:151], v[80:95]
    v_max3_u32 v12, v12, v178, v179
    v_max3_u32 v13, v13, v180, v181
    v_max3_u32 v12, v12, v182, v183
    s_waitcnt vmcnt(33)
    v_mfma_f32_32x32x16_bf16 v[32:47], a[152:155], v[152:155], v[32:47]
    v_max3_u32 v13, v13, v184, v185
    v_max3_u32 v12, v12, v186, v187
    v_max3_u32 v13, v13, v188, v189
    v_mfma_f32_32x32x16_bf16 v[48:63], a[156:159], v[152:155], v[48:63]
    v_max3_u32 v12, v12, v190, v191
    v_max3_u32 v12, v12, v13, v13
    v_cmp_eq_u32 vcc, -1, v12
    s_cbranch_vccnz L_vsp_37
L_vok_36:
    v_mfma_f32_32x32x16_bf16 v[64:79], a[152:155], v[156:159], v[64:79]
    v_mfma_f32_32x32x16_bf16 v[80:95], a[156:159], v[156:159], v[80:95]
    s_waitcnt vmcnt(27)
    v_mfma_f32_32x32x16_bf16 v[32:47], a[160:163], v[160:163], v[32:47]
    v_mfma_f32_32x32x16_bf16 v[48:63], a[164:167], v[160:163], v[48:63]
    s_waitcnt vmcnt(15)
    v_cmp_eq_u64 vcc, s[18:19], v[124:125]
    s_cmp_eq_u64 vcc, -1
    s_cbranch_scc0 L_spin_39
L_ok_38:
    v_mfma_f32_32x32x16_bf16 v[64:79], a[160:163], v[164:167], v[64:79]
    v_mfma_f32_32x32x16_bf16 v[80:95], a[164:167], v[164:167], v[80:95]
    s_waitcnt vmcnt(25)
    v_mfma_f32_32x32x16_bf16 v[32:47], a[168:171], v[168:171], v[32:47]
    v_mfma_f32_32x32x16_bf16 v[48:63], a[172:175], v[168:171], v[48:63]
    v_mfma_f32_32x32x16_bf16 v[64:79], a[168:171], v[172:175], v[64:79]
    v_mfma_f32_32x32x16_bf16 v[80:95], a[172:175], v[172:175], v[80:95]
    s_waitcnt vmcnt(21)
    v_mfma_f32_32x32x16_bf16 v[32:47], a[176:179], v[176:179], v[32:47]
    s_waitcnt vmcnt(1)
    v_max3_u32 v12, v192, v193, v194
    v_max3_u32 v13, v195, v196, v197
    v_mfma_f32_32x32x16_bf16 v[48:63], a[180:183], v[176:179], v[48:63]
    v_max3_u32 v12, v12, v198, v199
    v_max3_u32 v13, v13, v200, v201
    v_max3_u32 v12, v12, v202, v203
    v_mfma_f32_32x32x16_bf16 v[64:79], a[176:179], v[180:183], v[64:79]
    v_max3_u32 v13, v13, v204, v205
    v_max3_u32 v12, v12, v206, v207
    v_max3_u32 v13, v13, v208, v209
    v_mfma_f32_32x32x16_bf16 v[80:95], a[180:183], v[180:183], v[80:95]
    v_max3_u32 v12, v12, v210, v211
    v_max3_u32 v13, v13, v212, v213
    v_max3_u32 v12, v12, v214, v215
    s_waitcnt vmcnt(17)
    v_mfma_f32_32x32x16_bf16 v[32:47], a[184:187], v[184:187], v[32:47]
    v_max3_u32 v13, v13, v216, v217
    v_max3_u32 v12, v12, v218, v219
    v_max3_u32 v13, v13, v220, v221
    v_mfma_f32_32x32x16_bf16 v[48:63], a[188:191], v[184:187], v[48:63]
    v_max3_u32 v12, v12, v222, v223
    v_max3_u32 v12, v12, v13, v13
    v_cmp_eq_u32 vcc, -1, v12
    s_cbranch_vccnz L_vsp_41
L_vok_40:
    v_mfma_f32_32x32x16_bf16 v[64:79], a[184:187], v[188:191], v[64:79]
    v_mfma_f32_32x32x16_bf16 v[80:95], a[188:191], v[188:191], v[80:95]
    s_waitcnt vmcnt(12)
    s_waitcnt vmcnt(8)
    s_waitcnt vmcnt(4)
    s_waitcnt vmcnt(0)
    s_xor_b32 s57, s88, 1
    s_mul_i32 s57, s57, 12288
    v_add_u32 v9, s57, v3
    s_xor_b32 s57, s88, 2
    s_mul_i32 s57, s57, 12288
    v_add_u32 v10, s57, v3
    s_xor_b32 s57, s88, 3
    s_mul_i32 s57, s57, 12288
    v_add_u32 v11, s57, v3
    v_mfma_f32_32x32x16_bf16 v[80:95], a[196:199], v[196:199], v[80:95]
    v_mfma_f32_32x32x16_bf16 v[80:95], a[204:207], v[204:207], v[80:95]
    v_mfma_f32_32x32x16_bf16 v[80:95], a[212:215], v[212:215], v[80:95]
    v_mfma_f32_32x32x16_bf16 v[80:95], a[220:223], v[220:223], v[80:95]
    v_mfma_f32_32x32x16_bf16 v[64:79], a[192:195], v[196:199], v[64:79]
    v_mfma_f32_32x32x16_bf16 v[64:79], a[200:203], v[204:207], v[64:79]
    v_mfma_f32_32x32x16_bf16 v[64:79], a[208:211], v[212:215], v[64:79]
    s_nop 8
    ds_write_b128 v11, v[80:83] offset:8192
    ds_write_b128 v11, v[84:87] offset:9216
    v_mfma_f32_32x32x16_bf16 v[64:79], a[216:219], v[220:223], v[64:79]
    ds_write_b128 v11, v[88:91] offset:10240
    ds_write_b128 v11, v[92:95] offset:11264
    v_mfma_f32_32x32x16_bf16 v[48:63], a[196:199], v[192:195], v[48:63]
    s_nop 8
    ds_write_b128 v10, v[64:67] offset:4096
    ds_write_b128 v10, v[68:71] offset:5120
    v_mfma_f32_32x32x16_bf16 v[48:63], a[204:207], v[200:203], v[48:63]
    ds_write_b128 v10, v[72:75] offset:6144
    ds_write_b128 v10, v[76:79] offset:7168
    v_mfma_f32_32x32x16_bf16 v[48:63], a[212:215], v[208:211], v[48:63]
    v_mfma_f32_32x32x16_bf16 v[48:63], a[220:223], v[216:219], v[48:63]
    v_mfma_f32_32x32x16_bf16 v[32:47], a[192:195], v[192:195], v[32:47]
    s_nop 10
    ds_write_b128 v9, v[48:51] offset:0
    v_mfma_f32_32x32x16_bf16 v[32:47], a[200:203], v[200:203], v[32:47]
    ds_write_b128 v9, v[52:55] offset:1024
    v_mfma_f32_32x32x16_bf16 v[32:47], a[208:211], v[208:211], v[32:47]
    ds_write_b128 v9, v[56:59] offset:2048
    v_mfma_f32_32x32x16_bf16 v[32:47], a[216:219], v[216:219], v[32:47]
    ds_write_b128 v9, v[60:63] offset:3072
    s_mul_i32 s57, s88, 12288
    v_add_u32 v8, s57, v3
    v_lshlrev_b32 v176, 16, v96
    v_and_b32 v177, 0xffff0000, v96
    v_lshlrev_b32 v178, 16, v97
    v_and_b32 v179, 0xffff0000, v97
    v_lshlrev_b32 v180, 16, v98
    v_and_b32 v181, 0xffff0000, v98
    v_lshlrev_b32 v182, 16, v99
    v_and_b32 v183, 0xffff0000, v99
    v_lshlrev_b32 v184, 16, v100
    v_and_b32 v185, 0xffff0000, v100
    v_lshlrev_b32 v186, 16, v101
    v_and_b32 v187, 0xffff0000, v101
    v_lshlrev_b32 v188, 16, v102
    v_and_b32 v189, 0xffff0000, v102
    v_lshlrev_b32 v190, 16, v103
    v_and_b32 v191, 0xffff0000, v103
    s_waitcnt lgkmcnt(0)
    s_barrier
    ds_read_b128 v[128:131], v8 offset:0
    ds_read_b128 v[132:135], v8 offset:1024
    ds_read_b128 v[136:139], v8 offset:2048
    ds_read_b128 v[140:143], v8 offset:3072
    ds_read_b128 v[144:147], v8 offset:4096
    ds_read_b128 v[148:151], v8 offset:5120
    ds_read_b128 v[152:155], v8 offset:6144
    ds_read_b128 v[156:159], v8 offset:7168
    ds_read_b128 v[160:163], v8 offset:8192
    ds_read_b128 v[164:167], v8 offset:9216
    ds_read_b128 v[168:171], v8 offset:10240
    ds_read_b128 v[172:175], v8 offset:11264
    v_pk_add_f32 v[32:33], v[32:33], v[176:177]
    v_pk_add_f32 v[34:35], v[34:35], v[178:179]
    v_pk_add_f32 v[36:37], v[36:37], v[180:181]
    v_pk_add_f32 v[38:39], v[38:39], v[182:183]
    v_pk_add_f32 v[40:41], v[40:41], v[184:185]
    v_pk_add_f32 v[42:43], v[42:43], v[186:187]
    v_pk_add_f32 v[44:45], v[44:45], v[188:189]
    v_pk_add_f32 v[46:47], v[46:47], v[190:191]
    s_waitcnt lgkmcnt(8)
    v_pk_add_f32 v[32:33], v[32:33], v[128:129]
    v_pk_add_f32 v[34:35], v[34:35], v[130:131]
    v_pk_add_f32 v[36:37], v[36:37], v[132:133]
    v_pk_add_f32 v[38:39], v[38:39], v[134:135]
    v_pk_add_f32 v[40:41], v[40:41], v[136:137]
    v_pk_add_f32 v[42:43], v[42:43], v[138:139]
    v_pk_add_f32 v[44:45], v[44:45], v[140:141]
    v_pk_add_f32 v[46:47], v[46:47], v[142:143]
    s_waitcnt lgkmcnt(4)
    v_pk_add_f32 v[32:33], v[32:33], v[144:145]
    v_pk_add_f32 v[34:35], v[34:35], v[146:147]
    v_pk_add_f32 v[36:37], v[36:37], v[148:149]
    v_pk_add_f32 v[38:39], v[38:39], v[150:151]
    v_pk_add_f32 v[40:41], v[40:41], v[152:153]
    v_pk_add_f32 v[42:43], v[42:43], v[154:155]
    v_pk_add_f32 v[44:45], v[44:45], v[156:157]
    v_pk_add_f32 v[46:47], v[46:47], v[158:159]
    s_waitcnt lgkmcnt(0)
    v_pk_add_f32 v[32:33], v[32:33], v[160:161]
    v_pk_add_f32 v[34:35], v[34:35], v[162:163]
    v_pk_add_f32 v[36:37], v[36:37], v[164:165]
    v_pk_add_f32 v[38:39], v[38:39], v[166:167]
    v_pk_add_f32 v[40:41], v[40:41], v[168:169]
    v_pk_add_f32 v[42:43], v[42:43], v[170:171]
    v_pk_add_f32 v[44:45], v[44:45], v[172:173]
    v_pk_add_f32 v[46:47], v[46:47], v[174:175]
    v_cvt_pk_bf16_f32 v128, v32, v33
    v_cvt_pk_bf16_f32 v129, v34, v35
    v_cvt_pk_bf16_f32 v130, v36, v37
    v_cvt_pk_bf16_f32 v131, v38, v39
    v_cvt_pk_bf16_f32 v132, v40, v41
    v_cvt_pk_bf16_f32 v133, v42, v43
    v_cvt_pk_bf16_f32 v134, v44, v45
    v_cvt_pk_bf16_f32 v135, v46, v47
    buffer_store_dwordx4 v[128:131], v2, s[8:11], s49 offen sc1
    buffer_store_dwordx4 v[132:135], v2, s[8:11], s49 offen offset:1024 sc1
    s_mov_b32 s57, 0x3f803f80
    s_lshl_b32 s53, s24, 1
    s_add_u32 s53, s53, s39
    s_lshl_b32 s53, s53, 12
    s_lshl_b32 s54, s22, 9
    s_add_u32 s53, s53, s54
    s_lshl_b32 s54, s41, 3
    s_add_u32 s53, s53, s54
    s_add_u32 s53, s53, 0xe70000
    v_and_b32 v12, 31, v1
    v_lshlrev_b32 v12, 4, v12
    v_dot2_f32_bf16 v136, v128, s57, 0
    v_dot2_f32_bf16 v137, v128, v128, 0
    v_dot2_f32_bf16 v138, v129, s57, 0
    v_dot2_f32_bf16 v139, v129, v129, 0
    v_dot2_f32_bf16 v136, v130, s57, v136
    v_dot2_f32_bf16 v137, v130, v130, v137
    v_dot2_f32_bf16 v138, v131, s57, v138
    v_dot2_f32_bf16 v139, v131, v131, v139
    v_dot2_f32_bf16 v136, v132, s57, v136
    v_dot2_f32_bf16 v137, v132, v132, v137
    v_dot2_f32_bf16 v138, v133, s57, v138
    v_dot2_f32_bf16 v139, v133, v133, v139
    v_dot2_f32_bf16 v136, v134, s57, v136
    v_dot2_f32_bf16 v137, v134, v134, v137
    v_dot2_f32_bf16 v138, v135, s57, v138
    v_dot2_f32_bf16 v139, v135, v135, v139
    v_accvgpr_write_b32 a228, v128
    v_accvgpr_write_b32 a229, v129
    v_accvgpr_write_b32 a230, v130
    v_pk_add_f32 v[136:137], v[136:137], v[138:139]
    v_accvgpr_write_b32 a231, v131
    v_mov_b32 v138, v136
    v_mov_b32 v139, v137
    v_accvgpr_write_b32 a232, v132
    v_accvgpr_write_b32 a233, v133
    v_permlane32_swap_b32 v136, v138
    v_permlane32_swap_b32 v137, v139
    v_pk_add_f32 v[136:137], v[136:137], v[138:139]
    buffer_store_dwordx2 v[136:137], v12, s[8:11], s53 offen sc1
    v_accvgpr_write_b32 a234, v134
    v_accvgpr_write_b32 a235, v135
L_second:
    s_lshl_b32 s20, s24, 1
    s_lshr_b32 s21, s22, 2
    s_add_u32 s20, s20, s21
    s_and_b32 s21, s22, 3
    v_and_b32 v1, 63, v0
    v_lshrrev_b32 v3, 3, v1
    v_and_b32 v2, 7, v1
    s_lshl_b32 s22, s88, 3
    v_add_u32 v4, s22, v2
    s_and_b32 s33, s20, 1
    s_lshl_b32 s33, s33, 5
    s_lshr_b32 s34, s20, 1
    s_add_u32 s33, s33, s34
    s_add_u32 s33, s33, 2032
    v_lshlrev_b32 v130, 4, v1
    v_accvgpr_read_b32 v80, a236
    v_accvgpr_read_b32 v81, a237
    v_accvgpr_read_b32 v82, a238
    v_accvgpr_read_b32 v83, a239
    v_accvgpr_read_b32 v84, a240
    v_accvgpr_read_b32 v85, a241
    v_accvgpr_read_b32 v86, a242
    v_accvgpr_read_b32 v87, a243
    v_accvgpr_read_b32 v88, a244
    v_accvgpr_read_b32 v89, a245
    v_accvgpr_read_b32 v90, a246
    v_accvgpr_read_b32 v91, a247
    v_accvgpr_read_b32 v92, a248
    v_accvgpr_read_b32 v93, a249
    v_accvgpr_read_b32 v94, a250
    v_accvgpr_read_b32 v95, a251
    v_lshlrev_b32 v5, 4, v4
    v_lshl_add_u32 v5, v3, 9, v5
    s_lshl_b32 s23, s20, 15
    s_add_u32 s23, s23, 0xa60000
    v_and_b32 v12, 15, v1
    v_lshrrev_b32 v13, 4, v1
    s_cmp_lt_u32 s88, 2
    s_cselect_b32 s25, 8, -252
    s_cmp_eq_u32 s21, 0
    s_cselect_b32 s25, s25, s21
    s_lshl_b32 s24, s88, 4
    v_add_u32 v14, s24, v12
    v_lshl_add_u32 v15, v14, 3, s25
    s_lshl_b32 s24, s21, 6
    v_add_u32 v6, s24, v14
    v_lshlrev_b32 v6, 2, v6
    v_lshl_add_u32 v7, v13, 18, v6
    v_cvt_f32_u32 v128, s33
    v_mul_f32 v128, 0x3c800000, v128
    v_fract_f32 v128, v128
    v_sin_f32 v129, v128
    v_cos_f32 v128, v128
    s_mov_b32 s40, 0x3f800000
    s_mov_b32 s41, 0x3f800000
    s_mov_b32 s42, 0x3f800000
    s_mov_b32 s43, 0x3f800000
    s_mov_b32 s44, 0x3f800000
    s_mov_b32 s45, 0xbf800000
    s_mov_b32 s46, 0x3f800000
    s_mov_b32 s47, 0xbf800000
    s_mov_b32 s48, 0x3f80
    s_mov_b32 s49, 0x3f800000
    s_mov_b32 s50, 0xc1000000
    s_cmp_eq_u32 s21, 1
    s_cselect_b32 s40, 0x3f800000, s40
    s_cselect_b32 s41, 0x3f3504f3, s41
    s_cselect_b32 s42, 0x0, s42
    s_cselect_b32 s43, 0xbf3504f3, s43
    s_cselect_b32 s44, 0x0, s44
    s_cselect_b32 s45, 0xbf3504f3, s45
    s_cselect_b32 s46, 0xbf800000, s46
    s_cselect_b32 s47, 0xbf3504f3, s47
    s_cselect_b32 s48, 0xbf80, s48
    s_cselect_b32 s49, 0xbf800000, s49
    s_cselect_b32 s50, 0x0, s50
    s_cmp_eq_u32 s21, 2
    s_cselect_b32 s40, 0x3f800000, s40
    s_cselect_b32 s41, 0x0, s41
    s_cselect_b32 s42, 0xbf800000, s42
    s_cselect_b32 s43, 0x0, s43
    s_cselect_b32 s44, 0x0, s44
    s_cselect_b32 s45, 0xbf800000, s45
    s_cselect_b32 s46, 0x0, s46
    s_cselect_b32 s47, 0x3f800000, s47
    s_cselect_b32 s48, 0x3f80, s48
    s_cselect_b32 s49, 0x3f800000, s49
    s_cselect_b32 s50, 0x0, s50
    s_cmp_eq_u32 s21, 3
    s_cselect_b32 s40, 0x3f800000, s40
    s_cselect_b32 s41, 0xbf3504f3, s41
    s_cselect_b32 s42, 0x0, s42
    s_cselect_b32 s43, 0x3f3504f3, s43
    s_cselect_b32 s44, 0x0, s44
    s_cselect_b32 s45, 0xbf3504f3, s45
    s_cselect_b32 s46, 0x3f800000, s46
    s_cselect_b32 s47, 0xbf3504f3, s47
    s_cselect_b32 s48, 0xbf80, s48
    s_cselect_b32 s49, 0xbf800000, s49
    s_cselect_b32 s50, 0x0, s50
    s_and_b32 s24, s88, 1
    s_lshl_b32 s24, s24, 3
    v_add_u32 v8, s24, v2
    v_xor_b32 v8, v8, v3
    v_lshlrev_b32 v8, 4, v8
    v_lshl_add_u32 v8, v3, 8, v8
    s_lshr_b32 s24, s88, 1
    s_lshl_b32 s24, s24, 11
    s_add_u32 s24, s24, 114688
    v_add_u32 v8, s24, v8
    v_xor_b32 v9, v12, v13
    v_lshlrev_b32 v9, 4, v9
    v_lshl_add_u32 v9, v13, 8, v9
    v_xor_b32 v10, 64, v9
    s_lshr_b32 s24, s88, 1
    s_lshl_b32 s24, s24, 12
    s_cmp_eq_u32 s21, 0
    s_cselect_b32 s24, s24, 0
    s_cselect_b32 s37, 0, -1
    s_add_u32 s24, s24, 114688
    s_mov_b32 s25, 118784
    s_add_u32 s26, s24, 8192
    v_add_u32 v140, s24, v9
    v_add_u32 v141, s24, v10
    v_add_u32 v142, s25, v9
    v_add_u32 v143, s25, v10
    v_add_u32 v144, s26, v9
    v_add_u32 v145, s26, v10
    s_mov_b32 s30, 0x3f803f80
    s_mov_b32 s31, 0x3f80
    s_mov_b32 s32, 0x3f800000
    s_add_u32 s24, s23, 0
    buffer_load_dwordx4 v[16:19], v5, s[8:11], s24 offen sc1
    s_add_u32 s24, s23, 4096
    buffer_load_dwordx4 v[20:23], v5, s[8:11], s24 offen sc1
    s_add_u32 s24, s23, 8192
    buffer_load_dwordx4 v[24:27], v5, s[8:11], s24 offen sc1
    s_add_u32 s24, s23, 12288
    buffer_load_dwordx4 v[28:31], v5, s[8:11], s24 offen sc1
    s_add_u32 s24, s23, 16384
    buffer_load_dwordx4 v[32:35], v5, s[8:11], s24 offen sc1
    s_add_u32 s24, s23, 20480
    buffer_load_dwordx4 v[36:39], v5, s[8:11], s24 offen sc1
    s_add_u32 s24, s23, 24576
    buffer_load_dwordx4 v[40:43], v5, s[8:11], s24 offen sc1
    s_add_u32 s24, s23, 28672
    buffer_load_dwordx4 v[44:47], v5, s[8:11], s24 offen sc1
    s_lshl_b32 s24, s20, 12
    s_add_u32 s24, s24, 0xe70000
    buffer_load_dwordx4 v[146:149], v5, s[8:11], s24 offen sc1
    v_mov_b32 v154, -1
    v_mov_b32 v155, -1
    v_mov_b32 v156, -1
    v_mov_b32 v157, -1
    s_lshl_b32 s24, s2, 2
    s_add_u32 s24, s24, s88
    s_lshl_b32 s25, s24, 8
    s_lshl_b32 s24, s24, 11
    s_add_u32 s24, s24, 0xf00000
    s_add_u32 s25, s25, 0x1100000
    v_lshlrev_b32 v6, 2, v1
    buffer_store_dwordx4 v[154:157], v130, s[8:11], s24 offen sc1
    buffer_store_dwordx4 v[154:157], v130, s[8:11], s24 offen offset:1024 sc1
    buffer_store_dword v154, v6, s[8:11], s25 offen sc1
    v_lshlrev_b32 v9, 8, v13
    v_add_u32 v9, s33, v9
    v_cvt_f32_u32 v9, v9
    v_cvt_f32_u32 v10, v12
    v_mul_f32 v10, 0x3a000000, v10
    v_add_f32 v11, 0xbc000000, v10
    v_add_f32 v64, 0x0, v9
    v_mul_f32 v64, v64, v11
    v_fract_f32 v64, v64
    v_add_f32 v65, 0x42800000, v9
    v_mul_f32 v65, v65, v11
    v_fract_f32 v65, v65
    v_add_f32 v66, 0x43000000, v9
    v_mul_f32 v66, v66, v11
    v_fract_f32 v66, v66
    v_add_f32 v67, 0x43400000, v9
    v_mul_f32 v67, v67, v11
    v_fract_f32 v67, v67
    v_add_f32 v68, 0x44800000, v9
    v_mul_f32 v68, v68, v11
    v_fract_f32 v68, v68
    v_add_f32 v69, 0x44880000, v9
    v_mul_f32 v69, v69, v11
    v_fract_f32 v69, v69
    v_add_f32 v70, 0x44900000, v9
    v_mul_f32 v70, v70, v11
    v_fract_f32 v70, v70
    v_add_f32 v71, 0x44980000, v9
    v_mul_f32 v71, v71, v11
    v_fract_f32 v71, v71
    v_cos_f32 v48, v64
    v_sin_f32 v56, v64
    v_cos_f32 v49, v65
    v_sin_f32 v57, v65
    v_cos_f32 v50, v66
    v_sin_f32 v58, v66
    v_cos_f32 v51, v67
    v_sin_f32 v59, v67
    v_cos_f32 v52, v68
    v_sin_f32 v60, v68
    v_cos_f32 v53, v69
    v_sin_f32 v61, v69
    v_cos_f32 v54, v70
    v_sin_f32 v62, v70
    v_cos_f32 v55, v71
    v_sin_f32 v63, v71
    v_cvt_pk_bf16_f32 v96, v48, v49
    v_cvt_pk_bf16_f32 v104, v56, v57
    v_cvt_pk_bf16_f32 v97, v50, v51
    v_cvt_pk_bf16_f32 v105, v58, v59
    v_cvt_pk_bf16_f32 v98, v52, v53
    v_cvt_pk_bf16_f32 v106, v60, v61
    v_cvt_pk_bf16_f32 v99, v54, v55
    v_cvt_pk_bf16_f32 v107, v62, v63
    v_mov_b32 v11, v10
    v_add_f32 v64, 0x0, v9
    v_mul_f32 v64, v64, v11
    v_fract_f32 v64, v64
    v_add_f32 v65, 0x42800000, v9
    v_mul_f32 v65, v65, v11
    v_fract_f32 v65, v65
    v_add_f32 v66, 0x43000000, v9
    v_mul_f32 v66, v66, v11
    v_fract_f32 v66, v66
    v_add_f32 v67, 0x43400000, v9
    v_mul_f32 v67, v67, v11
    v_fract_f32 v67, v67
    v_add_f32 v68, 0x44800000, v9
    v_mul_f32 v68, v68, v11
    v_fract_f32 v68, v68
    v_add_f32 v69, 0x44880000, v9
    v_mul_f32 v69, v69, v11
    v_fract_f32 v69, v69
    v_add_f32 v70, 0x44900000, v9
    v_mul_f32 v70, v70, v11
    v_fract_f32 v70, v70
    v_add_f32 v71, 0x44980000, v9
    v_mul_f32 v71, v71, v11
    v_fract_f32 v71, v71
    v_cos_f32 v48, v64
    v_sin_f32 v56, v64
    v_cos_f32 v49, v65
    v_sin_f32 v57, v65
    v_cos_f32 v50, v66
    v_sin_f32 v58, v66
    v_cos_f32 v51, v67
    v_sin_f32 v59, v67
    v_cos_f32 v52, v68
    v_sin_f32 v60, v68
    v_cos_f32 v53, v69
    v_sin_f32 v61, v69
    v_cos_f32 v54, v70
    v_sin_f32 v62, v70
    v_cos_f32 v55, v71
    v_sin_f32 v63, v71
    v_cvt_pk_bf16_f32 v100, v48, v49
    v_cvt_pk_bf16_f32 v108, v56, v57
    v_cvt_pk_bf16_f32 v101, v50, v51
    v_cvt_pk_bf16_f32 v109, v58, v59
    v_cvt_pk_bf16_f32 v102, v52, v53
    v_cvt_pk_bf16_f32 v110, v60, v61
    v_cvt_pk_bf16_f32 v103, v54, v55
    v_cvt_pk_bf16_f32 v111, v62, v63
    v_xor_b32 v112, 0x80008000, v104
    v_xor_b32 v113, 0x80008000, v105
    v_xor_b32 v114, 0x80008000, v106
    v_xor_b32 v115, 0x80008000, v107
    v_xor_b32 v116, 0x80008000, v108
    v_xor_b32 v117, 0x80008000, v109
    v_xor_b32 v118, 0x80008000, v110
    v_xor_b32 v119, 0x80008000, v111
    s_waitcnt vmcnt(3)
    v_max3_u32 v136, v16, v17, v18
    v_max3_u32 v137, v19, v20, v21
    v_max3_u32 v136, v136, v22, v23
    v_max3_u32 v137, v137, v24, v25
    v_max3_u32 v136, v136, v26, v27
    v_max3_u32 v137, v137, v28, v29
    v_max3_u32 v136, v136, v30, v31
    v_max3_u32 v137, v137, v32, v33
    v_max3_u32 v136, v136, v34, v35
    v_max3_u32 v137, v137, v36, v37
    v_max3_u32 v136, v136, v38, v39
    v_max3_u32 v137, v137, v40, v41
    v_max3_u32 v136, v136, v42, v43
    v_max3_u32 v137, v137, v44, v45
    v_max3_u32 v136, v136, v46, v47
    v_max3_u32 v137, v137, v146, v147
    v_max3_u32 v136, v136, v148, v149
    v_max3_u32 v136, v136, v137, v137
    v_cmp_eq_u32 vcc, -1, v136
    s_cbranch_vccnz L_vsp_43
L_vok_42:
    v_dot2_f32_bf16 v48, v16, s31, 0
    v_dot2_f32_bf16 v49, v16, s32, 0
    v_add_f32 v150, v147, v149
    v_dot2_f32_bf16 v50, v20, s31, 0
    v_dot2_f32_bf16 v51, v20, s32, 0
    v_add_f32 v146, v146, v148
    v_dot2_f32_bf16 v52, v24, s31, 0
    v_dot2_f32_bf16 v53, v24, s32, 0
    v_add_f32_dpp v146, v146, v146 row_ror:8 row_mask:0xf bank_mask:0xf
    v_dot2_f32_bf16 v54, v28, s31, 0
    v_dot2_f32_bf16 v55, v28, s32, 0
    v_add_f32_dpp v150, v150, v150 row_ror:8 row_mask:0xf bank_mask:0xf
    v_dot2_f32_bf16 v48, v32, s48, v48
    v_dot2_f32_bf16 v49, v32, s49, v49
    v_mov_b32 v147, v146
    v_dot2_f32_bf16 v50, v36, s48, v50
    v_dot2_f32_bf16 v51, v36, s49, v51
    v_mov_b32 v151, v150
    v_dot2_f32_bf16 v52, v40, s48, v52
    v_dot2_f32_bf16 v53, v40, s49, v53
    v_permlane16_swap_b32 v146, v147
    v_dot2_f32_bf16 v54, v44, s48, v54
    v_dot2_f32_bf16 v55, v44, s49, v55
    v_permlane16_swap_b32 v150, v151
    v_dot2_f32_bf16 v56, v17, s31, 0
    v_dot2_f32_bf16 v57, v17, s32, 0
    v_add_f32 v146, v146, v147
    v_dot2_f32_bf16 v58, v21, s31, 0
    v_dot2_f32_bf16 v59, v21, s32, 0
    v_add_f32 v150, v150, v151
    v_dot2_f32_bf16 v60, v25, s31, 0
    v_dot2_f32_bf16 v61, v25, s32, 0
    v_mov_b32 v147, v146
    v_dot2_f32_bf16 v62, v29, s31, 0
    v_dot2_f32_bf16 v63, v29, s32, 0
    v_mov_b32 v151, v150
    v_dot2_f32_bf16 v56, v33, s48, v56
    v_dot2_f32_bf16 v57, v33, s49, v57
    v_permlane32_swap_b32 v146, v147
    v_dot2_f32_bf16 v58, v37, s48, v58
    v_dot2_f32_bf16 v59, v37, s49, v59
    v_permlane32_swap_b32 v150, v151
    v_dot2_f32_bf16 v60, v41, s48, v60
    v_dot2_f32_bf16 v61, v41, s49, v61
    v_add_f32 v146, v146, v147
    v_dot2_f32_bf16 v62, v45, s48, v62
    v_dot2_f32_bf16 v63, v45, s49, v63
    v_add_f32 v150, v150, v151
    v_dot2_f32_bf16 v64, v18, s31, 0
    v_dot2_f32_bf16 v65, v18, s32, 0
    v_mul_f32 v146, 0x3b000000, v146
    v_dot2_f32_bf16 v66, v22, s31, 0
    v_dot2_f32_bf16 v67, v22, s32, 0
    v_mul_f32 v150, 0x3b000000, v150
    v_dot2_f32_bf16 v68, v26, s31, 0
    v_dot2_f32_bf16 v69, v26, s32, 0
    v_fma_f32 v150, -v146, v146, v150
    v_dot2_f32_bf16 v70, v30, s31, 0
    v_dot2_f32_bf16 v71, v30, s32, 0
    v_max_f32 v150, 0, v150
    v_dot2_f32_bf16 v64, v34, s48, v64
    v_dot2_f32_bf16 v65, v34, s49, v65
    v_add_f32 v150, 0x3727c5ac, v150
    v_dot2_f32_bf16 v66, v38, s48, v66
    v_dot2_f32_bf16 v67, v38, s49, v67
    v_rsq_f32 v150, v150
    v_dot2_f32_bf16 v68, v42, s48, v68
    v_dot2_f32_bf16 v69, v42, s49, v69
    v_mul_f32 v146, s50, v146
    v_dot2_f32_bf16 v70, v46, s48, v70
    v_dot2_f32_bf16 v71, v46, s49, v71
    v_mul_f32 v146, v146, v150
    v_dot2_f32_bf16 v72, v19, s31, 0
    v_dot2_f32_bf16 v73, v19, s32, 0
    v_mul_f32 v120, s40, v150
    v_dot2_f32_bf16 v74, v23, s31, 0
    v_dot2_f32_bf16 v75, v23, s32, 0
    v_mul_f32 v121, s40, v150
    v_dot2_f32_bf16 v76, v27, s31, 0
    v_dot2_f32_bf16 v77, v27, s32, 0
    v_mul_f32 v122, s41, v150
    v_dot2_f32_bf16 v78, v31, s31, 0
    v_dot2_f32_bf16 v79, v31, s32, 0
    v_mul_f32 v123, s41, v150
    v_dot2_f32_bf16 v72, v35, s48, v72
    v_dot2_f32_bf16 v73, v35, s49, v73
    v_mul_f32 v124, s42, v150
    v_dot2_f32_bf16 v74, v39, s48, v74
    v_dot2_f32_bf16 v75, v39, s49, v75
    v_mul_f32 v125, s42, v150
    v_dot2_f32_bf16 v76, v43, s48, v76
    v_dot2_f32_bf16 v77, v43, s49, v77
    v_mul_f32 v126, s43, v150
    v_dot2_f32_bf16 v78, v47, s48, v78
    v_mul_f32 v127, s43, v150
    v_dot2_f32_bf16 v79, v47, s49, v79
    v_mul_f32 v132, s44, v150
    v_mul_f32 v133, s44, v150
    v_mul_f32 v134, s45, v150
    v_mul_f32 v135, s45, v150
    v_mul_f32 v136, s46, v150
    v_mul_f32 v137, s46, v150
    v_mul_f32 v138, s47, v150
    v_mul_f32 v139, s47, v150
    v_mov_b32 v147, v146
    v_pk_fma_f32 v[16:17], v[48:49], v[120:121], v[146:147]
    v_pk_mul_f32 v[24:25], v[48:49], v[132:133]
    v_pk_fma_f32 v[18:19], v[56:57], v[120:121], v[146:147]
    v_pk_mul_f32 v[26:27], v[56:57], v[132:133]
    v_pk_fma_f32 v[20:21], v[64:65], v[120:121], v[146:147]
    v_pk_mul_f32 v[28:29], v[64:65], v[132:133]
    v_pk_fma_f32 v[22:23], v[72:73], v[120:121], v[146:147]
    v_pk_mul_f32 v[30:31], v[72:73], v[132:133]
    v_pk_fma_f32 v[16:17], v[50:51], v[122:123], v[16:17]
    v_pk_fma_f32 v[24:25], v[50:51], v[134:135], v[24:25]
    v_pk_fma_f32 v[18:19], v[58:59], v[122:123], v[18:19]
    v_pk_fma_f32 v[26:27], v[58:59], v[134:135], v[26:27]
    v_pk_fma_f32 v[20:21], v[66:67], v[122:123], v[20:21]
    v_pk_fma_f32 v[28:29], v[66:67], v[134:135], v[28:29]
    v_pk_fma_f32 v[22:23], v[74:75], v[122:123], v[22:23]
    v_pk_fma_f32 v[30:31], v[74:75], v[134:135], v[30:31]
    v_pk_fma_f32 v[16:17], v[52:53], v[124:125], v[16:17]
    v_pk_fma_f32 v[24:25], v[52:53], v[136:137], v[24:25]
    v_pk_fma_f32 v[18:19], v[60:61], v[124:125], v[18:19]
    v_pk_fma_f32 v[26:27], v[60:61], v[136:137], v[26:27]
    v_pk_fma_f32 v[20:21], v[68:69], v[124:125], v[20:21]
    v_pk_fma_f32 v[28:29], v[68:69], v[136:137], v[28:29]
    v_pk_fma_f32 v[22:23], v[76:77], v[124:125], v[22:23]
    v_pk_fma_f32 v[30:31], v[76:77], v[136:137], v[30:31]
    v_pk_fma_f32 v[16:17], v[54:55], v[126:127], v[16:17]
    v_pk_fma_f32 v[24:25], v[54:55], v[138:139], v[24:25]
    v_pk_fma_f32 v[18:19], v[62:63], v[126:127], v[18:19]
    v_pk_fma_f32 v[26:27], v[62:63], v[138:139], v[26:27]
    v_pk_fma_f32 v[20:21], v[70:71], v[126:127], v[20:21]
    v_pk_fma_f32 v[28:29], v[70:71], v[138:139], v[28:29]
    v_pk_fma_f32 v[22:23], v[78:79], v[126:127], v[22:23]
    v_pk_fma_f32 v[30:31], v[78:79], v[138:139], v[30:31]
    v_cvt_pk_bf16_f32 v32, v16, v17
    v_cvt_pk_bf16_f32 v36, v24, v25
    v_cvt_pk_bf16_f32 v33, v18, v19
    v_cvt_pk_bf16_f32 v37, v26, v27
    v_cvt_pk_bf16_f32 v34, v20, v21
    v_cvt_pk_bf16_f32 v38, v28, v29
    v_cvt_pk_bf16_f32 v35, v22, v23
    v_cvt_pk_bf16_f32 v39, v30, v31
    ds_write_b128 v8, v[32:35] offset:0
    ds_write_b128 v8, v[36:39] offset:4096
    v_xor_b32 v40, 0x80008000, v32
    v_xor_b32 v44, 0x80008000, v36
    v_xor_b32 v41, 0x80008000, v33
    v_xor_b32 v45, 0x80008000, v37
    v_xor_b32 v42, 0x80008000, v34
    v_xor_b32 v46, 0x80008000, v38
    v_xor_b32 v43, 0x80008000, v35
    v_xor_b32 v47, 0x80008000, v39
    ds_write_b128 v8, v[40:43] offset:8192
    ds_write_b128 v8, v[44:47] offset:12288
    s_waitcnt vmcnt(0) lgkmcnt(0)
    s_barrier
    ds_read_b128 v[48:51], v140 offset:0
    ds_read_b128 v[64:67], v142 offset:0
    ds_read_b128 v[16:19], v144 offset:0
    ds_read_b128 v[52:55], v141 offset:1024
    ds_read_b128 v[68:71], v143 offset:1024
    ds_read_b128 v[20:23], v145 offset:1024
    ds_read_b128 v[56:59], v140 offset:2048
    ds_read_b128 v[72:75], v142 offset:2048
    ds_read_b128 v[24:27], v144 offset:2048
    ds_read_b128 v[60:63], v141 offset:3072
    ds_read_b128 v[76:79], v143 offset:3072
    ds_read_b128 v[28:31], v145 offset:3072
    v_and_b32 v40, s37, v80
    v_and_b32 v146, s37, v88
    v_and_b32 v41, s37, v81
    v_and_b32 v147, s37, v89
    v_and_b32 v42, s37, v82
    v_and_b32 v148, s37, v90
    v_and_b32 v43, s37, v83
    v_and_b32 v149, s37, v91
    v_and_b32 v44, s37, v84
    v_and_b32 v150, s37, v92
    v_and_b32 v45, s37, v85
    v_and_b32 v151, s37, v93
    v_and_b32 v46, s37, v86
    v_and_b32 v152, s37, v94
    v_and_b32 v47, s37, v87
    v_and_b32 v153, s37, v95
    s_waitcnt lgkmcnt(9)
    v_mfma_f32_16x16x32_bf16 v[120:123], v[48:51], v[80:83], 0
    v_mfma_f32_16x16x32_bf16 v[132:135], v[64:67], v[40:43], 0
    v_mfma_f32_16x16x32_bf16 v[120:123], v[64:67], v[146:149], v[120:123]
    v_mfma_f32_16x16x32_bf16 v[132:135], v[16:19], v[88:91], v[132:135]
    s_waitcnt lgkmcnt(6)
    v_mfma_f32_16x16x32_bf16 v[120:123], v[52:55], v[84:87], v[120:123]
    v_mfma_f32_16x16x32_bf16 v[132:135], v[68:71], v[44:47], v[132:135]
    v_mfma_f32_16x16x32_bf16 v[120:123], v[68:71], v[150:153], v[120:123]
    v_mfma_f32_16x16x32_bf16 v[132:135], v[20:23], v[92:95], v[132:135]
    s_waitcnt lgkmcnt(3)
    v_mfma_f32_16x16x32_bf16 v[124:127], v[56:59], v[80:83], 0
    v_mfma_f32_16x16x32_bf16 v[136:139], v[72:75], v[40:43], 0
    v_mfma_f32_16x16x32_bf16 v[124:127], v[72:75], v[146:149], v[124:127]
    v_mfma_f32_16x16x32_bf16 v[136:139], v[24:27], v[88:91], v[136:139]
    s_waitcnt lgkmcnt(0)
    v_mfma_f32_16x16x32_bf16 v[124:127], v[60:63], v[84:87], v[124:127]
    v_mfma_f32_16x16x32_bf16 v[136:139], v[76:79], v[44:47], v[136:139]
    v_mfma_f32_16x16x32_bf16 v[124:127], v[76:79], v[150:153], v[124:127]
    v_mfma_f32_16x16x32_bf16 v[136:139], v[28:31], v[92:95], v[136:139]
    v_cvt_pk_bf16_f32 v32, v120, v121
    v_cvt_pk_bf16_f32 v36, v132, v133
    v_cvt_pk_bf16_f32 v33, v122, v123
    v_cvt_pk_bf16_f32 v37, v134, v135
    s_nop 2
    v_cvt_pk_bf16_f32 v34, v124, v125
    v_cvt_pk_bf16_f32 v38, v136, v137
    v_cvt_pk_bf16_f32 v35, v126, v127
    v_cvt_pk_bf16_f32 v39, v138, v139
    s_nop 1
    v_mfma_f32_16x16x32_bf16 v[48:51], v[96:99], v[32:35], 0
    v_mfma_f32_16x16x32_bf16 v[56:59], v[96:99], v[36:39], 0
    v_mfma_f32_16x16x32_bf16 v[52:55], v[100:103], v[32:35], 0
    v_mfma_f32_16x16x32_bf16 v[60:63], v[100:103], v[36:39], 0
    v_mfma_f32_16x16x32_bf16 v[48:51], v[104:107], v[36:39], v[48:51]
    v_mfma_f32_16x16x32_bf16 v[56:59], v[112:115], v[32:35], v[56:59]
    v_mfma_f32_16x16x32_bf16 v[52:55], v[108:111], v[36:39], v[52:55]
    v_mfma_f32_16x16x32_bf16 v[60:63], v[116:119], v[32:35], v[60:63]
    s_and_b32 s23, s33, 63
    s_lshl_b32 s23, s23, 10
    s_add_u32 s23, s23, 0xc60000
    s_nop 2
    v_cvt_pk_bf16_f32 v64, v48, v56
    s_add_u32 s24, s23, 0
    buffer_store_dword v64, v7, s[8:11], s24 offen sc1
    v_cvt_pk_bf16_f32 v65, v49, v57
    s_add_u32 s24, s23, 65536
    buffer_store_dword v65, v7, s[8:11], s24 offen sc1
    v_cvt_pk_bf16_f32 v66, v50, v58
    s_add_u32 s24, s23, 131072
    buffer_store_dword v66, v7, s[8:11], s24 offen sc1
    v_cvt_pk_bf16_f32 v67, v51, v59
    s_add_u32 s24, s23, 196608
    buffer_store_dword v67, v7, s[8:11], s24 offen sc1
    v_cvt_pk_bf16_f32 v68, v52, v60
    s_add_u32 s24, s23, 1048576
    buffer_store_dword v68, v7, s[8:11], s24 offen sc1
    v_cvt_pk_bf16_f32 v69, v53, v61
    s_add_u32 s24, s23, 1114112
    buffer_store_dword v69, v7, s[8:11], s24 offen sc1
    v_cvt_pk_bf16_f32 v70, v54, v62
    s_add_u32 s24, s23, 1179648
    buffer_store_dword v70, v7, s[8:11], s24 offen sc1
    v_cvt_pk_bf16_f32 v71, v55, v63
    s_add_u32 s24, s23, 1245184
    buffer_store_dword v71, v7, s[8:11], s24 offen sc1
    v_mul_f32 v72, v48, v128
    v_mul_f32 v73, v56, v128
    v_fmac_f32 v72, v56, v129
    v_fma_f32 v73, -v48, v129, v73
    v_cvt_pk_bf16_f32 v72, v72, v73
    s_add_u32 s24, s23, 2097152
    s_mov_b64 exec, 0xffff
    buffer_store_dword v72, v7, s[8:11], s24 offen sc1
    s_mov_b64 exec, -1
    s_and_b32 s27, s2, 7
    s_lshr_b32 s28, s2, 3
    s_and_b32 s23, s27, 1
    s_lshl_b32 s23, s23, 3
    s_and_b32 s29, s28, 7
    s_add_u32 s23, s23, s29
    s_lshr_b32 s20, s27, 1
    s_lshl_b32 s20, s20, 2
    s_lshr_b32 s29, s28, 3
    s_add_u32 s20, s20, s29
    s_lshr_b32 s21, s23, 3
    s_and_b32 s22, s23, 7
    s_mov_b32 s25, s20
    s_add_u32 s26, s20, 16
    s_lshl_b32 s24, s21, 4
    s_add_u32 s24, s24, s20
    v_and_b32 v1, 63, v0
    v_lshlrev_b32 v2, 4, v1
    s_mul_i32 s43, s23, 7
    s_lshl_b32 s44, s43, 15
    s_lshl_b32 s45, s88, 12
    s_add_u32 s59, s44, 0x27c00
    s_add_u32 s44, s44, s45
    s_lshl_b32 s47, s43, 7
    s_add_u32 s47, s47, 0x540000
    s_and_b32 s41, s88, 1
    s_lshr_b32 s39, s88, 1
    s_mul_i32 s48, s88, 28
    s_lshl_b32 s49, s22, 1
    s_add_u32 s58, s49, s41
    s_xor_b32 s49, s58, 1
    s_mul_i32 s53, s58, 112
    s_mul_i32 s49, s49, 112
    s_add_u32 s53, s53, s48
    s_add_u32 s49, s49, s48
    s_lshl_b32 s53, s53, 10
    s_lshl_b32 s49, s49, 10
    s_add_u32 s98, s53, 0x380000
    s_add_u32 s99, s49, 0x380000
    s_add_u32 m0, s45, 98304
    s_add_u32 s89, s44, 0
    buffer_load_dwordx4 v2, s[8:11], s89 offen offset:0 sc1 lds
    buffer_load_dwordx4 v2, s[8:11], s89 offen offset:1024 sc1 lds
    buffer_load_dwordx4 v2, s[8:11], s89 offen offset:2048 sc1 lds
    buffer_load_dwordx4 v2, s[8:11], s89 offen offset:3072 sc1 lds
    v_add_u32 v3, 0x10000, v2
    v_add_u32 v4, 0x20000, v2
    v_lshrrev_b32 v5, 5, v1
    v_lshlrev_b32 v5, 6, v5
    v_add_u32 v5, 0x27c00, v5
    s_cmp_lt_u32 s88, 2
    s_cselect_b32 s40, s25, s26
    s_lshl_b32 s40, s40, 1
    s_add_u32 s40, s40, s41
    s_lshl_b32 s42, s40, 15
    s_add_u32 s42, s42, 0xf00000
    s_mul_i32 s46, s40, 112
    s_lshr_b32 s53, s23, 2
    s_mul_i32 s53, s53, 28
    s_add_u32 s46, s46, s53
    s_and_b32 s53, s23, 3
    s_add_u32 s46, s46, s53
    s_lshl_b32 s46, s46, 10
    s_add_u32 s46, s46, 0x1900000
    s_lshl_b32 s49, s24, 1
    s_add_u32 s49, s49, s39
    s_xor_b32 s50, s49, 1
    s_mul_i32 s53, s49, 112
    s_mul_i32 s50, s50, 112
    s_add_u32 s53, s53, s48
    s_add_u32 s50, s50, s48
    s_lshl_b32 s53, s53, 10
    s_lshl_b32 s50, s50, 10
    s_mov_b32 s101, 0x1900000
    s_add_u32 s100, s53, s101
    s_add_u32 s101, s50, s101
    s_lshl_b32 s49, s49, 15
    s_lshl_b32 s50, s58, 11
    s_add_u32 s49, s49, s50
    s_add_u32 s49, s49, 0xa60000
    s_lshl_b32 s50, s40, 12
    s_add_u32 s50, s50, 0x1100000
    v_and_b32 v127, 31, v1
    v_lshlrev_b32 v127, 4, v127
    v_lshrrev_b32 v126, 5, v1
    v_lshl_add_u32 v127, v126, 11, v127
    s_lshl_b32 s51, s20, 13
    s_add_u32 s51, s51, 0x5c0000
    s_lshl_b32 s52, s23, 2
    s_add_u32 s52, s52, s88
    s_lshl_b32 s52, s52, 7
    s_add_u32 s52, s52, s51
    v_and_b32 v6, 3, v1
    v_bfe_u32 v13, v1, 2, 1
    v_lshl_add_u32 v6, v6, 2, v13
    s_lshl_b32 s53, s88, 4
    s_lshl_b32 s54, s21, 1
    s_add_u32 s53, s53, s54
    v_add_u32 v6, s53, v6
    v_lshlrev_b32 v6, 7, v6
    v_mov_b32 v7, 0x7f000000
    v_cmp_eq_u32 vcc, 0, v1
    s_nop 1
    v_cndmask_b32 v7, v7, v1, vcc
    v_and_b32 v201, 63, v0
    v_bfe_u32 v204, v201, 2, 3
    s_cmp_ge_u32 s22, 4
    s_cselect_b32 s36, 0x11, 0
    s_or_b32 s36, s36, 0xe0
    v_lshrrev_b32 v205, v204, s36
    v_and_b32 v205, 1, v205
    v_cmp_eq_u32 vcc, 1, v205
    v_sub_u32 v206, 8, v204
    v_and_b32 v206, 7, v206
    s_lshl_b32 s37, s22, 3
    s_sub_u32 s38, 56, s37
    s_and_b32 s37, s37, 0x30
    s_and_b32 s38, s38, 0x30
    v_mov_b32 v207, s37
    v_mov_b32 v208, s38
    v_cndmask_b32 v206, v204, v206, vcc
    v_cndmask_b32 v207, v207, v208, vcc
    s_sub_u32 s38, 32, s24
    v_mov_b32 v208, s24
    v_mov_b32 v209, s38
    v_cndmask_b32 v208, v208, v209, vcc
    v_and_b32 v209, 3, v206
    v_lshl_add_u32 v207, v209, 6, v207
    v_lshrrev_b32 v209, 2, v206
    v_lshl_add_u32 v207, v209, 5, v207
    v_mul_u32_u24 v209, 3, v205
    v_lshrrev_b32 v210, 1, v204
    v_xor_b32 v209, v209, v210
    v_xor_b32 v209, v209, v201
    v_and_b32 v209, 3, v209
    v_lshl_add_u32 v207, v209, 2, v207
    v_or_b32 v205, v205, v206
    v_cmp_eq_u32 vcc, 0, v205
    v_lshlrev_b32 v208, 14, v208
    v_add_u32 v207, v207, v208
    v_lshrrev_b32 v209, 5, v201
    v_lshl_add_u32 v207, v209, 8, v207
    v_subb_co_u32 v207, vcc, v207, 0, vcc
    v_add_u32 v207, 1, v207
    v_lshlrev_b32 v207, 2, v207
    s_lshl_b32 s4, s88, 14
    s_add_u32 s4, s4, 0xc5fffc
    s_lshl_b32 s5, s88, 13
    v_and_b32 v202, 31, v201
    v_lshrrev_b32 v203, 5, v201
    s_and_b32 s27, s88, 1
    s_lshr_b32 s34, s88, 1
    s_lshl_b32 s35, s22, 1
    s_add_u32 s35, s35, s27
    v_lshlrev_b32 v213, 4, v201
    s_lshl_b32 s37, s24, 1
    s_add_u32 s36, s37, s34
    v_accvgpr_read_b32 v96, a228
    v_accvgpr_read_b32 v97, a229
    v_accvgpr_read_b32 v98, a230
    v_accvgpr_read_b32 v99, a231
    v_accvgpr_read_b32 v100, a232
    v_accvgpr_read_b32 v101, a233
    v_accvgpr_read_b32 v102, a234
    v_accvgpr_read_b32 v103, a235
    s_lshl_b32 s37, s36, 15
    s_lshl_b32 s38, s35, 11
    s_add_u32 s37, s37, s38
    v_and_b32 v204, 3, v202
    v_bfe_u32 v205, v202, 3, 1
    v_lshl_add_u32 v204, v205, 2, v204
    v_bfe_u32 v205, v202, 4, 1
    v_bfe_u32 v206, v202, 2, 1
    v_lshl_add_u32 v205, v205, 1, v206
    s_lshl_b32 s38, s27, 2
    v_add_u32 v205, s38, v205
    s_cmp_ge_u32 s22, 4
    s_cselect_b32 s38, 0x11, 0
    s_or_b32 s38, s38, 0xe0
    v_lshrrev_b32 v206, v204, s38
    v_and_b32 v206, 1, v206
    v_lshlrev_b32 v214, 31, v206
    v_mul_u32_u24 v206, 3, v206
    v_xor_b32 v206, v206, v205
    s_and_b32 s38, s22, 1
    s_lshl_b32 s38, s38, 3
    v_xor_b32 v206, s38, v206
    v_lshrrev_b32 v208, 1, v204
    v_lshlrev_b32 v208, 2, v208
    v_xor_b32 v206, v206, v208
    v_lshl_add_u32 v206, v204, 4, v206
    v_lshl_add_u32 v206, v203, 9, v206
    v_lshlrev_b32 v208, 2, v206
    v_add_u32 v208, 0x10000, v208
    v_or_b32 v204, v204, v205
    v_or_b32 v204, s22, v204
    v_cmp_ne_u32 vcc, 0, v204
    s_nop 1
    v_cndmask_b32 v209, 0, -1, vcc
    v_lshl_add_u32 v211, v202, 1, s34
    v_cvt_f32_u32 v211, v211
    v_mul_f32 v211, 0x3c800000, v211
    v_lshlrev_b32 v210, 2, v203
    v_cvt_f32_u32 v210, v210
    v_mul_f32 v210, v210, v211
    v_mul_f32 v215, 0x40a00000, v211
    v_fract_f32 v104, v210
    v_add_f32 v210, v210, v211
    v_fract_f32 v105, v210
    v_add_f32 v210, v210, v211
    v_fract_f32 v106, v210
    v_add_f32 v210, v210, v211
    v_fract_f32 v107, v210
    v_cos_f32 v108, v104
    v_sin_f32 v112, v104
    v_cos_f32 v109, v105
    v_sin_f32 v113, v105
    v_cos_f32 v110, v106
    v_sin_f32 v114, v106
    v_cos_f32 v111, v107
    v_sin_f32 v115, v107
    v_cvt_pk_bf16_f32 v48, v108, v112
    v_cvt_pk_bf16_f32 v49, v109, v113
    v_cvt_pk_bf16_f32 v50, v110, v114
    v_cvt_pk_bf16_f32 v51, v111, v115
    v_add_f32 v210, v210, v215
    v_fract_f32 v104, v210
    v_add_f32 v210, v210, v211
    v_fract_f32 v105, v210
    v_add_f32 v210, v210, v211
    v_fract_f32 v106, v210
    v_add_f32 v210, v210, v211
    v_fract_f32 v107, v210
    v_cos_f32 v108, v104
    v_sin_f32 v112, v104
    v_cos_f32 v109, v105
    v_sin_f32 v113, v105
    v_cos_f32 v110, v106
    v_sin_f32 v114, v106
    v_cos_f32 v111, v107
    v_sin_f32 v115, v107
    v_cvt_pk_bf16_f32 v52, v108, v112
    v_cvt_pk_bf16_f32 v53, v109, v113
    v_cvt_pk_bf16_f32 v54, v110, v114
    v_cvt_pk_bf16_f32 v55, v111, v115
    s_lshl_b32 s38, s34, 15
    v_and_b32 v210, 1, v202
    v_sub_u32 v210, 0, v210
    v_and_b32 v210, 0x80008000, v210
    v_xor_b32 v210, s38, v210
    s_lshl_b32 s38, s34, 4
    s_mul_i32 s31, s34, 0x80008000
    v_alignbit_b32 v56, v48, v48, s38
    v_alignbit_b32 v57, v49, v49, s38
    v_alignbit_b32 v58, v50, v50, s38
    v_alignbit_b32 v59, v51, v51, s38
    v_alignbit_b32 v60, v52, v52, s38
    v_alignbit_b32 v61, v53, v53, s38
    v_alignbit_b32 v62, v54, v54, s38
    v_alignbit_b32 v63, v55, v55, s38
    v_xor_b32 v56, v210, v56
    v_xor_b32 v57, v210, v57
    v_xor_b32 v58, v210, v58
    v_xor_b32 v59, v210, v59
    v_xor_b32 v60, v210, v60
    v_xor_b32 v61, v210, v61
    v_xor_b32 v62, v210, v62
    v_xor_b32 v63, v210, v63
    v_xor_b32 v64, s31, v48
    v_xor_b32 v65, s31, v49
    v_xor_b32 v66, s31, v50
    v_xor_b32 v67, s31, v51
    v_xor_b32 v68, s31, v52
    v_xor_b32 v69, s31, v53
    v_xor_b32 v70, s31, v54
    v_xor_b32 v71, s31, v55
    v_xor_b32 v72, s31, v56
    v_xor_b32 v73, s31, v57
    v_xor_b32 v74, s31, v58
    v_xor_b32 v75, s31, v59
    v_xor_b32 v76, s31, v60
    v_xor_b32 v77, s31, v61
    v_xor_b32 v78, s31, v62
    v_xor_b32 v79, s31, v63
    s_mov_b32 s31, 0x3f803f80
    s_add_u32 s37, s37, 0xf00000
    s_lshl_b32 s36, s36, 12
    s_lshl_b32 s38, s22, 9
    s_add_u32 s36, s36, s38
    s_lshl_b32 s38, s27, 3
    s_add_u32 s36, s36, s38
    s_add_u32 s36, s36, 0x1100000
    v_lshlrev_b32 v212, 4, v202
    v_lshlrev_b32 v80, 16, v96
    v_and_b32 v81, 0xffff0000, v96
    v_lshlrev_b32 v82, 16, v97
    v_and_b32 v83, 0xffff0000, v97
    v_lshlrev_b32 v84, 16, v98
    v_and_b32 v85, 0xffff0000, v98
    v_lshlrev_b32 v86, 16, v99
    v_and_b32 v87, 0xffff0000, v99
    v_lshlrev_b32 v88, 16, v100
    v_and_b32 v89, 0xffff0000, v100
    v_lshlrev_b32 v90, 16, v101
    v_and_b32 v91, 0xffff0000, v101
    v_lshlrev_b32 v92, 16, v102
    v_and_b32 v93, 0xffff0000, v102
    v_lshlrev_b32 v94, 16, v103
    v_and_b32 v95, 0xffff0000, v103
    s_add_u32 m0, s5, 65536
    s_add_u32 s3, s4, 0
    buffer_load_dwordx4 v207, s[8:11], s3 offen sc1 lds
    s_add_u32 m0, s5, 66560
    s_add_u32 s3, s4, 2048
    buffer_load_dwordx4 v207, s[8:11], s3 offen sc1 lds
    s_add_u32 m0, s5, 67584
    s_add_u32 s3, s4, 4096
    buffer_load_dwordx4 v207, s[8:11], s3 offen sc1 lds
    s_add_u32 m0, s5, 68608
    s_add_u32 s3, s4, 6144
    buffer_load_dwordx4 v207, s[8:11], s3 offen sc1 lds
    s_add_u32 m0, s5, 69632
    s_add_u32 s3, s4, 8192
    buffer_load_dwordx4 v207, s[8:11], s3 offen sc1 lds
    s_add_u32 m0, s5, 70656
    s_add_u32 s3, s4, 10240
    buffer_load_dwordx4 v207, s[8:11], s3 offen sc1 lds
    s_add_u32 m0, s5, 71680
    s_add_u32 s3, s4, 12288
    buffer_load_dwordx4 v207, s[8:11], s3 offen sc1 lds
    s_add_u32 m0, s5, 72704
    s_add_u32 s3, s4, 14336
    buffer_load_dwordx4 v207, s[8:11], s3 offen sc1 lds
    s_add_u32 s3, s5, 65536
    v_add_u32 v210, s3, v213
    s_waitcnt vmcnt(0)
    ds_read_b128 v[16:19], v210 offset:0
    ds_read_b128 v[20:23], v210 offset:1024
    ds_read_b128 v[24:27], v210 offset:2048
    ds_read_b128 v[28:31], v210 offset:3072
    ds_read_b128 v[32:35], v210 offset:4096
    ds_read_b128 v[36:39], v210 offset:5120
    ds_read_b128 v[40:43], v210 offset:6144
    ds_read_b128 v[44:47], v210 offset:7168
    s_waitcnt lgkmcnt(0)
    v_max3_u32 v104, v16, v17, v18
    v_max3_u32 v105, v19, v20, v21
    v_max3_u32 v104, v104, v22, v23
    v_max3_u32 v105, v105, v24, v25
    v_max3_u32 v104, v104, v26, v27
    v_max3_u32 v105, v105, v28, v29
    v_max3_u32 v104, v104, v30, v31
    v_max3_u32 v105, v105, v32, v33
    v_max3_u32 v104, v104, v34, v35
    v_max3_u32 v105, v105, v36, v37
    v_max3_u32 v104, v104, v38, v39
    v_max3_u32 v105, v105, v40, v41
    v_max3_u32 v104, v104, v42, v43
    v_max3_u32 v105, v105, v44, v45
    v_max3_u32 v104, v104, v46, v47
    v_max3_u32 v104, v104, v105, v105
    v_cmp_eq_u32 vcc, -1, v104
    s_cbranch_vccnz L_vsp_45
L_vok_44:
    s_barrier
    ds_read2st64_b32 v[16:17], v208 offset0:0 offset1:2
    ds_read2st64_b32 v[18:19], v208 offset0:4 offset1:6
    ds_read2st64_b32 v[20:21], v208 offset0:16 offset1:18
    ds_read2st64_b32 v[22:23], v208 offset0:20 offset1:22
    ds_read2st64_b32 v[24:25], v208 offset0:32 offset1:34
    ds_read2st64_b32 v[26:27], v208 offset0:36 offset1:38
    ds_read2st64_b32 v[28:29], v208 offset0:48 offset1:50
    ds_read2st64_b32 v[30:31], v208 offset0:52 offset1:54
    ds_read2st64_b32 v[32:33], v208 offset0:64 offset1:66
    ds_read2st64_b32 v[34:35], v208 offset0:68 offset1:70
    ds_read2st64_b32 v[36:37], v208 offset0:80 offset1:82
    ds_read2st64_b32 v[38:39], v208 offset0:84 offset1:86
    ds_read2st64_b32 v[40:41], v208 offset0:96 offset1:98
    ds_read2st64_b32 v[42:43], v208 offset0:100 offset1:102
    ds_read2st64_b32 v[44:45], v208 offset0:112 offset1:114
    ds_read2st64_b32 v[46:47], v208 offset0:116 offset1:118
    s_waitcnt lgkmcnt(14)
    v_bitop3_b32 v16, v214, v16, v209 bitop3:0x28
    v_bitop3_b32 v17, v214, v17, v209 bitop3:0x28
    v_bitop3_b32 v18, v214, v18, v209 bitop3:0x28
    v_bitop3_b32 v19, v214, v19, v209 bitop3:0x28
    s_nop 2
    v_mfma_f32_32x32x16_bf16 v[80:95], v[16:19], v[48:51], v[80:95]
    s_waitcnt lgkmcnt(12)
    v_bitop3_b32 v20, v214, v20, v209 bitop3:0x28
    v_bitop3_b32 v21, v214, v21, v209 bitop3:0x28
    v_bitop3_b32 v22, v214, v22, v209 bitop3:0x28
    v_bitop3_b32 v23, v214, v23, v209 bitop3:0x28
    s_nop 2
    v_mfma_f32_32x32x16_bf16 v[80:95], v[20:23], v[52:55], v[80:95]
    s_waitcnt lgkmcnt(10)
    v_bitop3_b32 v24, v214, v24, v209 bitop3:0x28
    v_bitop3_b32 v25, v214, v25, v209 bitop3:0x28
    v_bitop3_b32 v26, v214, v26, v209 bitop3:0x28
    v_bitop3_b32 v27, v214, v27, v209 bitop3:0x28
    s_nop 2
    v_mfma_f32_32x32x16_bf16 v[80:95], v[24:27], v[56:59], v[80:95]
    s_waitcnt lgkmcnt(8)
    v_bitop3_b32 v28, v214, v28, v209 bitop3:0x28
    v_bitop3_b32 v29, v214, v29, v209 bitop3:0x28
    v_bitop3_b32 v30, v214, v30, v209 bitop3:0x28
    v_bitop3_b32 v31, v214, v31, v209 bitop3:0x28
    s_nop 2
    v_mfma_f32_32x32x16_bf16 v[80:95], v[28:31], v[60:63], v[80:95]
    s_waitcnt lgkmcnt(6)
    v_bitop3_b32 v32, v214, v32, v209 bitop3:0x28
    v_bitop3_b32 v33, v214, v33, v209 bitop3:0x28
    v_bitop3_b32 v34, v214, v34, v209 bitop3:0x28
    v_bitop3_b32 v35, v214, v35, v209 bitop3:0x28
    s_nop 2
    v_mfma_f32_32x32x16_bf16 v[80:95], v[32:35], v[64:67], v[80:95]
    s_waitcnt lgkmcnt(4)
    v_bitop3_b32 v36, v214, v36, v209 bitop3:0x28
    v_bitop3_b32 v37, v214, v37, v209 bitop3:0x28
    v_bitop3_b32 v38, v214, v38, v209 bitop3:0x28
    v_bitop3_b32 v39, v214, v39, v209 bitop3:0x28
    s_nop 2
    v_mfma_f32_32x32x16_bf16 v[80:95], v[36:39], v[68:71], v[80:95]
    s_waitcnt lgkmcnt(2)
    v_bitop3_b32 v40, v214, v40, v209 bitop3:0x28
    v_bitop3_b32 v41, v214, v41, v209 bitop3:0x28
    v_bitop3_b32 v42, v214, v42, v209 bitop3:0x28
    v_bitop3_b32 v43, v214, v43, v209 bitop3:0x28
    s_nop 2
    v_mfma_f32_32x32x16_bf16 v[80:95], v[40:43], v[72:75], v[80:95]
    s_waitcnt lgkmcnt(0)
    v_bitop3_b32 v44, v214, v44, v209 bitop3:0x28
    v_bitop3_b32 v45, v214, v45, v209 bitop3:0x28
    v_bitop3_b32 v46, v214, v46, v209 bitop3:0x28
    v_bitop3_b32 v47, v214, v47, v209 bitop3:0x28
    s_nop 2
    v_mfma_f32_32x32x16_bf16 v[80:95], v[44:47], v[76:79], v[80:95]
    s_nop 11
    v_cvt_pk_bf16_f32 v16, v80, v81
    v_cvt_pk_bf16_f32 v17, v82, v83
    v_cvt_pk_bf16_f32 v18, v84, v85
    v_cvt_pk_bf16_f32 v19, v86, v87
    v_cvt_pk_bf16_f32 v20, v88, v89
    v_cvt_pk_bf16_f32 v21, v90, v91
    v_cvt_pk_bf16_f32 v22, v92, v93
    v_cvt_pk_bf16_f32 v23, v94, v95
    buffer_store_dwordx4 v[16:19], v213, s[8:11], s37 offen sc1
    buffer_store_dwordx4 v[20:23], v213, s[8:11], s37 offen offset:1024 sc1
    v_dot2_f32_bf16 v104, v16, s31, 0
    v_dot2_f32_bf16 v105, v16, v16, 0
    v_dot2_f32_bf16 v106, v17, s31, 0
    v_dot2_f32_bf16 v107, v17, v17, 0
    v_dot2_f32_bf16 v104, v18, s31, v104
    v_dot2_f32_bf16 v105, v18, v18, v105
    v_dot2_f32_bf16 v106, v19, s31, v106
    v_dot2_f32_bf16 v107, v19, v19, v107
    v_dot2_f32_bf16 v104, v20, s31, v104
    v_dot2_f32_bf16 v105, v20, v20, v105
    v_dot2_f32_bf16 v106, v21, s31, v106
    v_dot2_f32_bf16 v107, v21, v21, v107
    v_dot2_f32_bf16 v104, v22, s31, v104
    v_dot2_f32_bf16 v105, v22, v22, v105
    v_dot2_f32_bf16 v106, v23, s31, v106
    v_dot2_f32_bf16 v107, v23, v23, v107
    v_accvgpr_write_b32 a228, v16
    v_accvgpr_write_b32 a229, v17
    v_accvgpr_write_b32 a230, v18
    v_pk_add_f32 v[104:105], v[104:105], v[106:107]
    v_accvgpr_write_b32 a231, v19
    v_mov_b32 v106, v104
    v_mov_b32 v107, v105
    v_accvgpr_write_b32 a232, v20
    v_accvgpr_write_b32 a233, v21
    v_permlane32_swap_b32 v104, v106
    v_permlane32_swap_b32 v105, v107
    v_pk_add_f32 v[104:105], v[104:105], v[106:107]
    buffer_store_dwordx2 v[104:105], v212, s[8:11], s36 offen sc1
    v_accvgpr_write_b32 a234, v22
    v_accvgpr_write_b32 a235, v23
    s_barrier
    s_add_u32 m0, s45, 114688
    s_add_u32 s89, s44, 16384
    buffer_load_dwordx4 v2, s[8:11], s89 offen offset:0 sc1 lds
    buffer_load_dwordx4 v2, s[8:11], s89 offen offset:1024 sc1 lds
    buffer_load_dwordx4 v2, s[8:11], s89 offen offset:2048 sc1 lds
    buffer_load_dwordx4 v2, s[8:11], s89 offen offset:3072 sc1 lds
    s_add_u32 m0, s45, 65536
    s_add_u32 s89, s44, 32768
    buffer_load_dwordx4 v2, s[8:11], s89 offen offset:0 sc1 lds
    buffer_load_dwordx4 v2, s[8:11], s89 offen offset:1024 sc1 lds
    buffer_load_dwordx4 v2, s[8:11], s89 offen offset:2048 sc1 lds
    buffer_load_dwordx4 v2, s[8:11], s89 offen offset:3072 sc1 lds
    s_add_u32 s56, s42, 0
    buffer_load_dwordx4 v[128:131], v2, s[8:11], s56 offen offset:0 sc1
    buffer_load_dwordx4 v[132:135], v2, s[8:11], s56 offen offset:1024 sc1
    buffer_load_dwordx4 v[136:139], v2, s[8:11], s56 offen offset:2048 sc1
    buffer_load_dwordx4 v[140:143], v2, s[8:11], s56 offen offset:3072 sc1
    s_add_u32 s56, s42, 4096
    buffer_load_dwordx4 v[144:147], v2, s[8:11], s56 offen offset:0 sc1
    buffer_load_dwordx4 v[148:151], v2, s[8:11], s56 offen offset:1024 sc1
    buffer_load_dwordx4 v[152:155], v2, s[8:11], s56 offen offset:2048 sc1
    buffer_load_dwordx4 v[156:159], v2, s[8:11], s56 offen offset:3072 sc1
    s_add_u32 s56, s42, 8192
    buffer_load_dwordx4 v[160:163], v2, s[8:11], s56 offen offset:0 sc1
    buffer_load_dwordx4 v[164:167], v2, s[8:11], s56 offen offset:1024 sc1
    buffer_load_dwordx4 v[168:171], v2, s[8:11], s56 offen offset:2048 sc1
    buffer_load_dwordx4 v[172:175], v2, s[8:11], s56 offen offset:3072 sc1
    s_add_u32 s56, s42, 12288
    buffer_load_dwordx4 v[176:179], v2, s[8:11], s56 offen offset:0 sc1
    buffer_load_dwordx4 v[180:183], v2, s[8:11], s56 offen offset:1024 sc1
    buffer_load_dwordx4 v[184:187], v2, s[8:11], s56 offen offset:2048 sc1
    buffer_load_dwordx4 v[188:191], v2, s[8:11], s56 offen offset:3072 sc1
    s_add_u32 s56, s42, 16384
    buffer_load_dwordx4 v[192:195], v2, s[8:11], s56 offen offset:0 sc1
    buffer_load_dwordx4 v[196:199], v2, s[8:11], s56 offen offset:1024 sc1
    buffer_load_dwordx4 v[200:203], v2, s[8:11], s56 offen offset:2048 sc1
    buffer_load_dwordx4 v[204:207], v2, s[8:11], s56 offen offset:3072 sc1
    s_waitcnt vmcnt(16) lgkmcnt(0)
    s_barrier
    ds_read_b128 v[64:67], v2 offset:0
    ds_read_b128 v[68:71], v2 offset:32768
    ds_read_b128 v[72:75], v2 offset:1024
    ds_read_b128 v[76:79], v2 offset:33792
    ds_read_b128 v[80:83], v2 offset:2048
    ds_read_b128 v[84:87], v2 offset:34816
    ds_read_b128 v[88:91], v2 offset:3072
    ds_read_b128 v[96:99], v5 offset:640
    ds_read_b128 v[100:103], v5 offset:656
    ds_read_b128 v[104:107], v5 offset:672
    ds_read_b128 v[108:111], v5 offset:688
    s_waitcnt vmcnt(16)
    v_max3_u32 v12, v128, v129, v130
    v_max3_u32 v13, v131, v132, v133
    v_max3_u32 v12, v12, v134, v135
    v_max3_u32 v13, v13, v136, v137
    v_max3_u32 v12, v12, v138, v139
    v_max3_u32 v13, v13, v140, v141
    v_max3_u32 v12, v12, v142, v143
    v_max3_u32 v12, v12, v13, v13
    v_cmp_eq_u32 vcc, -1, v12
    s_cbranch_vccnz L_vsp_47
L_vok_46:
    s_waitcnt lgkmcnt(7)
    v_mfma_f32_32x32x16_bf16 v[16:31], v[64:67], v[128:131], 0
    ds_read_b128 v[92:95], v2 offset:35840
    buffer_load_dwordx4 v[48:51], v127, s[8:11], s50 offen offset:0 sc1
    v_mfma_f32_32x32x16_bf16 v[32:47], v[68:71], v[128:131], 0
    ds_read_b128 v[64:67], v2 offset:4096
    v_mfma_f32_32x32x16_bf16 v[16:31], v[72:75], v[132:135], v[16:31]
    ds_read_b128 v[68:71], v2 offset:36864
    s_waitcnt vmcnt(13)
    v_max3_u32 v12, v144, v145, v146
    v_max3_u32 v13, v147, v148, v149
    v_mfma_f32_32x32x16_bf16 v[32:47], v[76:79], v[132:135], v[32:47]
    ds_read_b128 v[72:75], v2 offset:5120
    v_max3_u32 v12, v12, v150, v151
    v_max3_u32 v13, v13, v152, v153
    v_max3_u32 v12, v12, v154, v155
    buffer_load_dwordx4 v[52:55], v127, s[8:11], s50 offen offset:512 sc1
    s_waitcnt lgkmcnt(3)
    v_mfma_f32_32x32x16_bf16 v[16:31], v[80:83], v[136:139], v[16:31]
    ds_read_b128 v[76:79], v2 offset:37888
    v_max3_u32 v13, v13, v156, v157
    v_max3_u32 v12, v12, v158, v159
    v_max3_u32 v12, v12, v13, v13
    v_mfma_f32_32x32x16_bf16 v[32:47], v[84:87], v[136:139], v[32:47]
    ds_read_b128 v[80:83], v2 offset:6144
    v_cmp_eq_u32 vcc, -1, v12
    s_cbranch_vccnz L_vsp_49
L_vok_48:
    v_mfma_f32_32x32x16_bf16 v[16:31], v[88:91], v[140:143], v[16:31]
    ds_read_b128 v[84:87], v2 offset:38912
    buffer_load_dwordx4 v[56:59], v127, s[8:11], s50 offen offset:1024 sc1
    v_mfma_f32_32x32x16_bf16 v[32:47], v[92:95], v[140:143], v[32:47]
    ds_read_b128 v[88:91], v2 offset:7168
    s_waitcnt lgkmcnt(3)
    v_mfma_f32_32x32x16_bf16 v[16:31], v[64:67], v[144:147], v[16:31]
    ds_read_b128 v[92:95], v2 offset:39936
    v_mfma_f32_32x32x16_bf16 v[32:47], v[68:71], v[144:147], v[32:47]
    ds_read_b128 v[64:67], v2 offset:8192
    buffer_load_dwordx4 v[60:63], v127, s[8:11], s50 offen offset:1536 sc1
    v_mfma_f32_32x32x16_bf16 v[16:31], v[72:75], v[148:151], v[16:31]
    ds_read_b128 v[68:71], v2 offset:40960
    s_waitcnt vmcnt(12)
    v_max3_u32 v12, v160, v161, v162
    v_max3_u32 v13, v163, v164, v165
    v_mfma_f32_32x32x16_bf16 v[32:47], v[76:79], v[148:151], v[32:47]
    ds_read_b128 v[72:75], v2 offset:9216
    v_max3_u32 v12, v12, v166, v167
    v_max3_u32 v13, v13, v168, v169
    v_max3_u32 v12, v12, v170, v171
    s_waitcnt lgkmcnt(3)
    v_mfma_f32_32x32x16_bf16 v[16:31], v[80:83], v[152:155], v[16:31]
    ds_read_b128 v[76:79], v2 offset:41984
    v_max3_u32 v13, v13, v172, v173
    v_max3_u32 v12, v12, v174, v175
    v_max3_u32 v12, v12, v13, v13
    s_add_u32 s56, s42, 20480
    buffer_load_dwordx4 v[208:211], v2, s[8:11], s56 offen offset:0 sc1
    v_mfma_f32_32x32x16_bf16 v[32:47], v[84:87], v[152:155], v[32:47]
    ds_read_b128 v[80:83], v2 offset:10240
    v_cmp_eq_u32 vcc, -1, v12
    s_cbranch_vccnz L_vsp_51
L_vok_50:
    v_mfma_f32_32x32x16_bf16 v[16:31], v[88:91], v[156:159], v[16:31]
    ds_read_b128 v[84:87], v2 offset:43008
    buffer_load_dwordx4 v[212:215], v2, s[8:11], s56 offen offset:1024 sc1
    v_mfma_f32_32x32x16_bf16 v[32:47], v[92:95], v[156:159], v[32:47]
    ds_read_b128 v[88:91], v2 offset:11264
    s_waitcnt lgkmcnt(3)
    v_mfma_f32_32x32x16_bf16 v[16:31], v[64:67], v[160:163], v[16:31]
    ds_read_b128 v[92:95], v2 offset:44032
    v_mfma_f32_32x32x16_bf16 v[32:47], v[68:71], v[160:163], v[32:47]
    ds_read_b128 v[64:67], v2 offset:12288
    buffer_load_dwordx4 v[216:219], v2, s[8:11], s56 offen offset:2048 sc1
    v_mfma_f32_32x32x16_bf16 v[16:31], v[72:75], v[164:167], v[16:31]
    ds_read_b128 v[68:71], v2 offset:45056
    s_waitcnt vmcnt(11)
    v_max3_u32 v12, v176, v177, v178
    v_max3_u32 v13, v179, v180, v181
    v_mfma_f32_32x32x16_bf16 v[32:47], v[76:79], v[164:167], v[32:47]
    ds_read_b128 v[72:75], v2 offset:13312
    v_max3_u32 v12, v12, v182, v183
    v_max3_u32 v13, v13, v184, v185
    v_max3_u32 v12, v12, v186, v187
    s_waitcnt lgkmcnt(3)
    v_mfma_f32_32x32x16_bf16 v[16:31], v[80:83], v[168:171], v[16:31]
    ds_read_b128 v[76:79], v2 offset:46080
    v_max3_u32 v13, v13, v188, v189
    v_max3_u32 v12, v12, v190, v191
    v_max3_u32 v12, v12, v13, v13
    buffer_load_dwordx4 v[220:223], v2, s[8:11], s56 offen offset:3072 sc1
    v_mfma_f32_32x32x16_bf16 v[32:47], v[84:87], v[168:171], v[32:47]
    ds_read_b128 v[80:83], v2 offset:14336
    v_cmp_eq_u32 vcc, -1, v12
    s_cbranch_vccnz L_vsp_53
L_vok_52:
    v_mfma_f32_32x32x16_bf16 v[16:31], v[88:91], v[172:175], v[16:31]
    ds_read_b128 v[84:87], v2 offset:47104
    v_mfma_f32_32x32x16_bf16 v[32:47], v[92:95], v[172:175], v[32:47]
    ds_read_b128 v[88:91], v2 offset:15360
    s_add_u32 s56, s42, 24576
    buffer_load_dwordx4 v[224:227], v2, s[8:11], s56 offen offset:0 sc1
    s_waitcnt lgkmcnt(3)
    v_mfma_f32_32x32x16_bf16 v[16:31], v[64:67], v[176:179], v[16:31]
    ds_read_b128 v[92:95], v2 offset:48128
    v_mfma_f32_32x32x16_bf16 v[32:47], v[68:71], v[176:179], v[32:47]
    ds_read_b128 v[64:67], v2 offset:16384
    v_mfma_f32_32x32x16_bf16 v[16:31], v[72:75], v[180:183], v[16:31]
    ds_read_b128 v[68:71], v2 offset:49152
    s_waitcnt vmcnt(9)
    v_max3_u32 v12, v192, v193, v194
    v_max3_u32 v13, v195, v196, v197
    buffer_load_dwordx4 v[228:231], v2, s[8:11], s56 offen offset:1024 sc1
    v_mfma_f32_32x32x16_bf16 v[32:47], v[76:79], v[180:183], v[32:47]
    ds_read_b128 v[72:75], v2 offset:17408
    v_max3_u32 v12, v12, v198, v199
    v_max3_u32 v13, v13, v200, v201
    v_max3_u32 v12, v12, v202, v203
    s_waitcnt lgkmcnt(3)
    v_mfma_f32_32x32x16_bf16 v[16:31], v[80:83], v[184:187], v[16:31]
    ds_read_b128 v[76:79], v2 offset:50176
    v_max3_u32 v13, v13, v204, v205
    v_max3_u32 v12, v12, v206, v207
    v_max3_u32 v12, v12, v13, v13
    v_mfma_f32_32x32x16_bf16 v[32:47], v[84:87], v[184:187], v[32:47]
    ds_read_b128 v[80:83], v2 offset:18432
    v_cmp_eq_u32 vcc, -1, v12
    s_cbranch_vccnz L_vsp_55
L_vok_54:
    buffer_load_dwordx4 v[232:235], v2, s[8:11], s56 offen offset:2048 sc1
    v_mfma_f32_32x32x16_bf16 v[16:31], v[88:91], v[188:191], v[16:31]
    ds_read_b128 v[84:87], v2 offset:51200
    v_mfma_f32_32x32x16_bf16 v[32:47], v[92:95], v[188:191], v[32:47]
    ds_read_b128 v[88:91], v2 offset:19456
    buffer_load_dwordx4 v[236:239], v2, s[8:11], s56 offen offset:3072 sc1
    s_waitcnt vmcnt(8)
    v_max3_u32 v14, v48, v49, v50
    v_max3_u32 v15, v51, v52, v53
    v_max3_u32 v14, v14, v54, v55
    v_max3_u32 v15, v15, v56, v57
    v_max3_u32 v14, v14, v58, v59
    v_max3_u32 v15, v15, v60, v61
    v_max3_u32 v14, v14, v62, v63
    v_max3_u32 v14, v14, v15, v15
    v_cmp_eq_u32 vcc, -1, v14
    s_cbranch_vccnz L_vsp_57
L_vok_56:
    v_pk_add_f32 v[48:49], v[48:49], v[56:57]
    s_waitcnt lgkmcnt(3)
    v_mfma_f32_32x32x16_bf16 v[16:31], v[64:67], v[192:195], v[16:31]
    ds_read_b128 v[92:95], v2 offset:52224
    v_pk_add_f32 v[50:51], v[50:51], v[58:59]
    v_pk_add_f32 v[52:53], v[52:53], v[60:61]
    v_pk_add_f32 v[54:55], v[54:55], v[62:63]
    v_pk_add_f32 v[48:49], v[48:49], v[52:53]
    v_pk_add_f32 v[50:51], v[50:51], v[54:55]
    v_pk_add_f32 v[48:49], v[48:49], v[50:51]
    v_mfma_f32_32x32x16_bf16 v[32:47], v[68:71], v[192:195], v[32:47]
    ds_read_b128 v[64:67], v2 offset:20480
    v_mov_b32 v50, v48
    v_mov_b32 v51, v49
    s_nop 0
    s_nop 0
    v_permlane32_swap_b32 v48, v50
    v_permlane32_swap_b32 v49, v51
    v_mfma_f32_32x32x16_bf16 v[16:31], v[72:75], v[196:199], v[16:31]
    ds_read_b128 v[68:71], v2 offset:53248
    s_waitcnt vmcnt(4)
    v_max3_u32 v12, v208, v209, v210
    v_max3_u32 v13, v211, v212, v213
    s_add_u32 s56, s42, 28672
    buffer_load_dwordx4 v[240:243], v2, s[8:11], s56 offen offset:0 sc1
    v_mfma_f32_32x32x16_bf16 v[32:47], v[76:79], v[196:199], v[32:47]
    ds_read_b128 v[72:75], v2 offset:21504
    v_max3_u32 v12, v12, v214, v215
    v_max3_u32 v13, v13, v216, v217
    v_max3_u32 v12, v12, v218, v219
    v_add_f32 v48, v48, v50
    v_add_f32 v49, v49, v51
    v_mul_f32 v8, 0x3b000000, v48
    s_waitcnt lgkmcnt(3)
    v_mfma_f32_32x32x16_bf16 v[16:31], v[80:83], v[200:203], v[16:31]
    ds_read_b128 v[76:79], v2 offset:54272
    v_max3_u32 v13, v13, v220, v221
    v_max3_u32 v12, v12, v222, v223
    v_max3_u32 v12, v12, v13, v13
    v_mul_f32 v49, 0x3b000000, v49
    v_fma_f32 v49, -v8, v8, v49
    v_max_f32 v49, 0, v49
    v_mfma_f32_32x32x16_bf16 v[32:47], v[84:87], v[200:203], v[32:47]
    ds_read_b128 v[80:83], v2 offset:22528
    v_cmp_eq_u32 vcc, -1, v12
    s_cbranch_vccnz L_vsp_59
L_vok_58:
    buffer_load_dwordx4 v[244:247], v2, s[8:11], s56 offen offset:1024 sc1
    v_add_f32 v49, 0x3727c5ac, v49
    v_mfma_f32_32x32x16_bf16 v[16:31], v[88:91], v[204:207], v[16:31]
    ds_read_b128 v[84:87], v2 offset:55296
    v_rsq_f32 v10, v49
    s_nop 0
    v_mul_f32 v9, 0xbfb8aa3b, v10
    v_mfma_f32_32x32x16_bf16 v[32:47], v[92:95], v[204:207], v[32:47]
    ds_read_b128 v[88:91], v2 offset:23552
    s_waitcnt lgkmcnt(3)
    v_mfma_f32_32x32x16_bf16 v[16:31], v[64:67], v[208:211], v[16:31]
    ds_read_b128 v[92:95], v2 offset:56320
    buffer_load_dwordx4 v[248:251], v2, s[8:11], s56 offen offset:2048 sc1
    v_mfma_f32_32x32x16_bf16 v[32:47], v[68:71], v[208:211], v[32:47]
    ds_read_b128 v[64:67], v2 offset:24576
    v_mfma_f32_32x32x16_bf16 v[16:31], v[72:75], v[212:215], v[16:31]
    ds_read_b128 v[68:71], v2 offset:57344
    s_waitcnt vmcnt(3)
    v_max3_u32 v12, v224, v225, v226
    v_max3_u32 v13, v227, v228, v229
    buffer_load_dwordx4 v[252:255], v2, s[8:11], s56 offen offset:3072 sc1
    v_mfma_f32_32x32x16_bf16 v[32:47], v[76:79], v[212:215], v[32:47]
    ds_read_b128 v[72:75], v2 offset:25600
    v_max3_u32 v12, v12, v230, v231
    v_max3_u32 v13, v13, v232, v233
    v_max3_u32 v12, v12, v234, v235
    s_waitcnt lgkmcnt(3)
    v_mfma_f32_32x32x16_bf16 v[16:31], v[80:83], v[216:219], v[16:31]
    ds_read_b128 v[76:79], v2 offset:58368
    v_max3_u32 v13, v13, v236, v237
    v_max3_u32 v12, v12, v238, v239
    v_max3_u32 v12, v12, v13, v13
    v_mfma_f32_32x32x16_bf16 v[32:47], v[84:87], v[216:219], v[32:47]
    ds_read_b128 v[80:83], v2 offset:26624
    v_cmp_eq_u32 vcc, -1, v12
    s_cbranch_vccnz L_vsp_61
L_vok_60:
    s_add_u32 m0, s45, 81920
    s_add_u32 s89, s44, 49152
    buffer_load_dwordx4 v2, s[8:11], s89 offen offset:0 sc1 lds
    v_mfma_f32_32x32x16_bf16 v[16:31], v[88:91], v[220:223], v[16:31]
    ds_read_b128 v[84:87], v2 offset:59392
    v_mfma_f32_32x32x16_bf16 v[32:47], v[92:95], v[220:223], v[32:47]
    ds_read_b128 v[88:91], v2 offset:27648
    s_waitcnt lgkmcnt(3)
    v_mfma_f32_32x32x16_bf16 v[16:31], v[64:67], v[224:227], v[16:31]
    ds_read_b128 v[92:95], v2 offset:60416
    buffer_load_dwordx4 v2, s[8:11], s89 offen offset:1024 sc1 lds
    v_mfma_f32_32x32x16_bf16 v[32:47], v[68:71], v[224:227], v[32:47]
    ds_read_b128 v[64:67], v2 offset:28672
    v_mfma_f32_32x32x16_bf16 v[16:31], v[72:75], v[228:231], v[16:31]
    ds_read_b128 v[68:71], v2 offset:61440
    s_waitcnt vmcnt(2)
    v_max3_u32 v12, v240, v241, v242
    v_max3_u32 v13, v243, v244, v245
    v_mfma_f32_32x32x16_bf16 v[32:47], v[76:79], v[228:231], v[32:47]
    ds_read_b128 v[72:75], v2 offset:29696
    v_max3_u32 v12, v12, v246, v247
    v_max3_u32 v13, v13, v248, v249
    v_max3_u32 v12, v12, v250, v251
    buffer_load_dwordx4 v2, s[8:11], s89 offen offset:2048 sc1 lds
    s_waitcnt lgkmcnt(3)
    v_mfma_f32_32x32x16_bf16 v[16:31], v[80:83], v[232:235], v[16:31]
    ds_read_b128 v[76:79], v2 offset:62464
    v_max3_u32 v13, v13, v252, v253
    v_max3_u32 v12, v12, v254, v255
    v_max3_u32 v12, v12, v13, v13
    v_mfma_f32_32x32x16_bf16 v[32:47], v[84:87], v[232:235], v[32:47]
    ds_read_b128 v[80:83], v2 offset:30720
    v_cmp_eq_u32 vcc, -1, v12
    s_cbranch_vccnz L_vsp_63
L_vok_62:
    v_mfma_f32_32x32x16_bf16 v[16:31], v[88:91], v[236:239], v[16:31]
    ds_read_b128 v[84:87], v2 offset:63488
    buffer_load_dwordx4 v2, s[8:11], s89 offen offset:3072 sc1 lds
    v_mfma_f32_32x32x16_bf16 v[32:47], v[92:95], v[236:239], v[32:47]
    ds_read_b128 v[88:91], v2 offset:31744
    s_waitcnt lgkmcnt(3)
    v_mfma_f32_32x32x16_bf16 v[16:31], v[64:67], v[240:243], v[16:31]
    ds_read_b128 v[92:95], v2 offset:64512
    v_mov_b32 v120, -1
    v_mov_b32 v121, -1
    v_mov_b32 v122, -1
    v_mov_b32 v123, -1
    s_add_u32 s57, s46, 12288
    buffer_store_dwordx4 v[120:123], v2, s[8:11], s57 offen sc1
    v_mfma_f32_32x32x16_bf16 v[32:47], v[68:71], v[240:243], v[32:47]
    ds_read_b128 v[64:67], v4 offset:0
    v_mfma_f32_32x32x16_bf16 v[16:31], v[72:75], v[244:247], v[16:31]
    ds_read_b128 v[68:71], v4 offset:1024
    v_mfma_f32_32x32x16_bf16 v[32:47], v[76:79], v[244:247], v[32:47]
    ds_read_b128 v[72:75], v4 offset:2048
    s_add_u32 s57, s46, 16384
    buffer_store_dwordx4 v[120:123], v2, s[8:11], s57 offen sc1
    s_waitcnt lgkmcnt(3)
    v_mfma_f32_32x32x16_bf16 v[16:31], v[80:83], v[248:251], v[16:31]
    ds_read_b128 v[76:79], v4 offset:3072
    v_mfma_f32_32x32x16_bf16 v[32:47], v[84:87], v[248:251], v[32:47]
    ds_read_b128 v[80:83], v4 offset:4096
    v_mfma_f32_32x32x16_bf16 v[16:31], v[88:91], v[252:255], v[16:31]
    ds_read_b128 v[84:87], v4 offset:5120
    s_add_u32 s57, s46, 20480
    buffer_store_dwordx4 v[120:123], v2, s[8:11], s57 offen sc1
    v_mfma_f32_32x32x16_bf16 v[32:47], v[92:95], v[252:255], v[32:47]
    ds_read_b128 v[88:91], v4 offset:6144
    s_waitcnt lgkmcnt(3)
    v_mfma_f32_32x32x16_bf16 v[48:63], v[64:67], v[128:131], 0
    ds_read_b128 v[92:95], v4 offset:7168
    v_mfma_f32_32x32x16_bf16 v[48:63], v[68:71], v[132:135], v[48:63]
    ds_read_b128 v[64:67], v4 offset:8192
    s_add_u32 s57, s46, 24576
    buffer_store_dwordx4 v[120:123], v2, s[8:11], s57 offen sc1
    v_mfma_f32_32x32x16_bf16 v[48:63], v[72:75], v[136:139], v[48:63]
    ds_read_b128 v[68:71], v4 offset:9216
    s_waitcnt lgkmcnt(15)
    v_fma_f32 v16, -v8, v96, v16
    v_fma_f32 v17, -v8, v97, v17
    v_fma_f32 v18, -v8, v98, v18
    v_fma_f32 v19, -v8, v99, v19
    v_fma_f32 v20, -v8, v100, v20
    v_mfma_f32_32x32x16_bf16 v[48:63], v[76:79], v[140:143], v[48:63]
    ds_read_b128 v[72:75], v4 offset:10240
    v_fma_f32 v21, -v8, v101, v21
    v_fma_f32 v22, -v8, v102, v22
    v_fma_f32 v23, -v8, v103, v23
    v_fma_f32 v24, -v8, v104, v24
    v_fma_f32 v25, -v8, v105, v25
    v_fma_f32 v26, -v8, v106, v26
    s_waitcnt lgkmcnt(3)
    v_mfma_f32_32x32x16_bf16 v[48:63], v[80:83], v[144:147], v[48:63]
    ds_read_b128 v[76:79], v4 offset:11264
    v_fma_f32 v27, -v8, v107, v27
    v_fma_f32 v28, -v8, v108, v28
    v_fma_f32 v29, -v8, v109, v29
    v_fma_f32 v30, -v8, v110, v30
    v_fma_f32 v31, -v8, v111, v31
    v_mul_f32 v16, v16, v9
    v_mfma_f32_32x32x16_bf16 v[48:63], v[84:87], v[148:151], v[48:63]
    ds_read_b128 v[80:83], v4 offset:12288
    v_mul_f32 v17, v17, v9
    v_mul_f32 v18, v18, v9
    v_mul_f32 v19, v19, v9
    v_mul_f32 v20, v20, v9
    v_mul_f32 v21, v21, v9
    v_mul_f32 v22, v22, v9
    v_mfma_f32_32x32x16_bf16 v[48:63], v[88:91], v[152:155], v[48:63]
    ds_read_b128 v[84:87], v4 offset:13312
    v_mul_f32 v23, v23, v9
    ds_read_b128 v[96:99], v5 offset:768
    ds_read_b128 v[100:103], v5 offset:784
    ds_read_b128 v[104:107], v5 offset:800
    ds_read_b128 v[108:111], v5 offset:816
    v_mfma_f32_32x32x16_bf16 v[48:63], v[92:95], v[156:159], v[48:63]
    ds_read_b128 v[88:91], v4 offset:14336
    v_exp_f32 v16, v16
    v_mul_f32 v24, v24, v10
    v_exp_f32 v17, v17
    v_mul_f32 v25, v25, v10
    s_waitcnt lgkmcnt(7)
    v_mfma_f32_32x32x16_bf16 v[48:63], v[64:67], v[160:163], v[48:63]
    ds_read_b128 v[92:95], v4 offset:15360
    v_exp_f32 v18, v18
    v_mul_f32 v26, v26, v10
    v_exp_f32 v19, v19
    v_mul_f32 v27, v27, v10
    v_mfma_f32_32x32x16_bf16 v[48:63], v[68:71], v[164:167], v[48:63]
    ds_read_b128 v[64:67], v4 offset:16384
    v_exp_f32 v20, v20
    v_mul_f32 v28, v28, v10
    v_exp_f32 v21, v21
    v_mul_f32 v29, v29, v10
    v_mfma_f32_32x32x16_bf16 v[48:63], v[72:75], v[168:171], v[48:63]
    ds_read_b128 v[68:71], v4 offset:17408
    v_exp_f32 v22, v22
    v_mul_f32 v30, v30, v10
    v_exp_f32 v23, v23
    v_mul_f32 v31, v31, v10
    v_mfma_f32_32x32x16_bf16 v[48:63], v[76:79], v[172:175], v[48:63]
    ds_read_b128 v[72:75], v4 offset:18432
    v_add_f32 v16, 1.0, v16
    v_add_f32 v17, 1.0, v17
    v_add_f32 v18, 1.0, v18
    v_add_f32 v19, 1.0, v19
    v_add_f32 v20, 1.0, v20
    v_add_f32 v21, 1.0, v21
    s_waitcnt lgkmcnt(3)
    v_mfma_f32_32x32x16_bf16 v[48:63], v[80:83], v[176:179], v[48:63]
    ds_read_b128 v[76:79], v4 offset:19456
    v_add_f32 v22, 1.0, v22
    v_add_f32 v23, 1.0, v23
    v_rcp_f32 v16, v16
    v_rcp_f32 v17, v17
    v_mfma_f32_32x32x16_bf16 v[48:63], v[84:87], v[180:183], v[48:63]
    ds_read_b128 v[80:83], v4 offset:20480
    v_rcp_f32 v18, v18
    v_rcp_f32 v19, v19
    v_rcp_f32 v20, v20
    v_mfma_f32_32x32x16_bf16 v[48:63], v[88:91], v[184:187], v[48:63]
    ds_read_b128 v[84:87], v4 offset:21504
    v_rcp_f32 v21, v21
    v_rcp_f32 v22, v22
    v_rcp_f32 v23, v23
    v_mfma_f32_32x32x16_bf16 v[48:63], v[92:95], v[188:191], v[48:63]
    ds_read_b128 v[88:91], v4 offset:22528
    v_mul_f32 v16, v16, v24
    v_mul_f32 v17, v17, v25
    v_mul_f32 v18, v18, v26
    v_mul_f32 v19, v19, v27
    v_mul_f32 v20, v20, v28
    v_mul_f32 v21, v21, v29
    s_waitcnt lgkmcnt(3)
    v_mfma_f32_32x32x16_bf16 v[48:63], v[64:67], v[192:195], v[48:63]
    ds_read_b128 v[92:95], v4 offset:23552
    v_mul_f32 v22, v22, v30
    v_mul_f32 v23, v23, v31
    v_cvt_pk_bf16_f32 v112, v16, v17
    v_cvt_pk_bf16_f32 v113, v18, v19
    v_cvt_pk_bf16_f32 v114, v20, v21
    v_cvt_pk_bf16_f32 v115, v22, v23
    v_mfma_f32_32x32x16_bf16 v[48:63], v[68:71], v[196:199], v[48:63]
    ds_read_b128 v[64:67], v4 offset:24576
    s_add_u32 s57, s46, 0
    buffer_store_dwordx4 v[112:115], v2, s[8:11], s57 offen sc1
    s_waitcnt lgkmcnt(11)
    v_fma_f32 v32, -v8, v96, v32
    v_mfma_f32_32x32x16_bf16 v[48:63], v[72:75], v[200:203], v[48:63]
    ds_read_b128 v[68:71], v4 offset:25600
    v_fma_f32 v33, -v8, v97, v33
    v_fma_f32 v34, -v8, v98, v34
    v_fma_f32 v35, -v8, v99, v35
    v_fma_f32 v36, -v8, v100, v36
    v_fma_f32 v37, -v8, v101, v37
    v_fma_f32 v38, -v8, v102, v38
    v_mfma_f32_32x32x16_bf16 v[48:63], v[76:79], v[204:207], v[48:63]
    ds_read_b128 v[72:75], v4 offset:26624
    v_fma_f32 v39, -v8, v103, v39
    v_fma_f32 v40, -v8, v104, v40
    v_fma_f32 v41, -v8, v105, v41
    v_fma_f32 v42, -v8, v106, v42
    v_fma_f32 v43, -v8, v107, v43
    v_fma_f32 v44, -v8, v108, v44
    s_waitcnt lgkmcnt(3)
    v_mfma_f32_32x32x16_bf16 v[48:63], v[80:83], v[208:211], v[48:63]
    ds_read_b128 v[76:79], v4 offset:27648
    v_fma_f32 v45, -v8, v109, v45
    v_fma_f32 v46, -v8, v110, v46
    v_fma_f32 v47, -v8, v111, v47
    v_mul_f32 v32, v32, v9
    v_mul_f32 v33, v33, v9
    v_mul_f32 v34, v34, v9
    v_mfma_f32_32x32x16_bf16 v[48:63], v[84:87], v[212:215], v[48:63]
    ds_read_b128 v[80:83], v4 offset:28672
    v_mul_f32 v35, v35, v9
    v_mul_f32 v36, v36, v9
    v_mul_f32 v37, v37, v9
    v_mul_f32 v38, v38, v9
    v_mul_f32 v39, v39, v9
    ds_read_b128 v[96:99], v5 offset:512
    v_mfma_f32_32x32x16_bf16 v[48:63], v[88:91], v[216:219], v[48:63]
    ds_read_b128 v[84:87], v4 offset:29696
    ds_read_b128 v[100:103], v5 offset:528
    ds_read_b128 v[104:107], v5 offset:544
    ds_read_b128 v[108:111], v5 offset:560
    v_exp_f32 v32, v32
    v_mul_f32 v40, v40, v10
    v_mfma_f32_32x32x16_bf16 v[48:63], v[92:95], v[220:223], v[48:63]
    ds_read_b128 v[88:91], v4 offset:30720
    v_exp_f32 v33, v33
    v_mul_f32 v41, v41, v10
    v_exp_f32 v34, v34
    v_mul_f32 v42, v42, v10
    s_waitcnt lgkmcnt(7)
    v_mfma_f32_32x32x16_bf16 v[48:63], v[64:67], v[224:227], v[48:63]
    v_exp_f32 v35, v35
    v_mul_f32 v43, v43, v10
    v_exp_f32 v36, v36
    v_mul_f32 v44, v44, v10
    s_waitcnt vmcnt(49)
    s_barrier
    v_mfma_f32_32x32x16_bf16 v[48:63], v[68:71], v[228:231], v[48:63]
    ds_read_b128 v[64:67], v3 offset:32768
    s_add_u32 m0, s45, 0
    s_add_u32 s89, s44, 65536
    buffer_load_dwordx4 v2, s[8:11], s89 offen offset:0 sc1 lds
    v_exp_f32 v37, v37
    v_mfma_f32_32x32x16_bf16 v[48:63], v[72:75], v[232:235], v[48:63]
    ds_read_b128 v[68:71], v3 offset:33792
    v_mul_f32 v45, v45, v10
    v_exp_f32 v38, v38
    v_mul_f32 v46, v46, v10
    v_exp_f32 v39, v39
    v_mfma_f32_32x32x16_bf16 v[48:63], v[76:79], v[236:239], v[48:63]
    ds_read_b128 v[72:75], v3 offset:34816
    buffer_load_dwordx4 v2, s[8:11], s89 offen offset:1024 sc1 lds
    v_mul_f32 v47, v47, v10
    v_add_f32 v32, 1.0, v32
    s_waitcnt lgkmcnt(3)
    v_mfma_f32_32x32x16_bf16 v[48:63], v[80:83], v[240:243], v[48:63]
    ds_read_b128 v[76:79], v3 offset:35840
    v_add_f32 v33, 1.0, v33
    v_add_f32 v34, 1.0, v34
    v_add_f32 v35, 1.0, v35
    v_add_f32 v36, 1.0, v36
    v_add_f32 v37, 1.0, v37
    v_add_f32 v38, 1.0, v38
    v_mfma_f32_32x32x16_bf16 v[48:63], v[84:87], v[244:247], v[48:63]
    ds_read_b128 v[80:83], v3 offset:36864
    v_add_f32 v39, 1.0, v39
    v_rcp_f32 v32, v32
    v_rcp_f32 v33, v33
    v_mfma_f32_32x32x16_bf16 v[48:63], v[88:91], v[248:251], v[48:63]
    ds_read_b128 v[84:87], v3 offset:37888
    buffer_load_dwordx4 v2, s[8:11], s89 offen offset:2048 sc1 lds
    v_rcp_f32 v34, v34
    v_mfma_f32_32x32x16_bf16 v[48:63], a[224:227], v[252:255], v[48:63]
    ds_read_b128 v[88:91], v3 offset:38912
    v_rcp_f32 v35, v35
    v_rcp_f32 v36, v36
    v_rcp_f32 v37, v37
    s_waitcnt lgkmcnt(3)
    v_mfma_f32_32x32x16_bf16 v[16:31], v[64:67], v[128:131], 0
    ds_read_b128 v[92:95], v3 offset:39936
    v_rcp_f32 v38, v38
    v_rcp_f32 v39, v39
    v_mul_f32 v32, v32, v40
    v_mul_f32 v33, v33, v41
    v_mfma_f32_32x32x16_bf16 v[16:31], v[68:71], v[132:135], v[16:31]
    ds_read_b128 v[64:67], v3 offset:40960
    buffer_load_dwordx4 v2, s[8:11], s89 offen offset:3072 sc1 lds
    v_mul_f32 v34, v34, v42
    v_mul_f32 v35, v35, v43
    v_mfma_f32_32x32x16_bf16 v[16:31], v[72:75], v[136:139], v[16:31]
    ds_read_b128 v[68:71], v3 offset:41984
    v_mul_f32 v36, v36, v44
    v_mul_f32 v37, v37, v45
    v_mul_f32 v38, v38, v46
    v_mul_f32 v39, v39, v47
    v_cvt_pk_bf16_f32 v116, v32, v33
    v_cvt_pk_bf16_f32 v117, v34, v35
    v_mfma_f32_32x32x16_bf16 v[16:31], v[76:79], v[140:143], v[16:31]
    ds_read_b128 v[72:75], v3 offset:43008
    v_cvt_pk_bf16_f32 v118, v36, v37
    v_cvt_pk_bf16_f32 v119, v38, v39
    s_add_u32 s57, s46, 4096
    buffer_store_dwordx4 v[116:119], v2, s[8:11], s57 offen sc1
    s_waitcnt lgkmcnt(3)
    v_mfma_f32_32x32x16_bf16 v[16:31], v[80:83], v[144:147], v[16:31]
    ds_read_b128 v[76:79], v3 offset:44032
    s_waitcnt lgkmcnt(13)
    v_fma_f32 v48, -v8, v96, v48
    v_fma_f32 v49, -v8, v97, v49
    v_fma_f32 v50, -v8, v98, v50
    v_fma_f32 v51, -v8, v99, v51
    v_fma_f32 v52, -v8, v100, v52
    v_mfma_f32_32x32x16_bf16 v[16:31], v[84:87], v[148:151], v[16:31]
    ds_read_b128 v[80:83], v3 offset:45056
    v_fma_f32 v53, -v8, v101, v53
    v_fma_f32 v54, -v8, v102, v54
    v_fma_f32 v55, -v8, v103, v55
    v_fma_f32 v56, -v8, v104, v56
    v_fma_f32 v57, -v8, v105, v57
    v_fma_f32 v58, -v8, v106, v58
    v_mfma_f32_32x32x16_bf16 v[16:31], v[88:91], v[152:155], v[16:31]
    ds_read_b128 v[84:87], v3 offset:46080
    s_add_u32 m0, s45, 16384
    s_add_u32 s89, s44, 81920
    buffer_load_dwordx4 v2, s[8:11], s89 offen offset:0 sc1 lds
    v_fma_f32 v59, -v8, v107, v59
    v_fma_f32 v60, -v8, v108, v60
    v_mfma_f32_32x32x16_bf16 v[16:31], v[92:95], v[156:159], v[16:31]
    ds_read_b128 v[88:91], v3 offset:47104
    v_fma_f32 v61, -v8, v109, v61
    v_fma_f32 v62, -v8, v110, v62
    v_fma_f32 v63, -v8, v111, v63
    v_mul_f32 v48, v48, v9
    v_mul_f32 v49, v49, v9
    v_mul_f32 v50, v50, v9
    s_waitcnt lgkmcnt(3)
    v_mfma_f32_32x32x16_bf16 v[16:31], v[64:67], v[160:163], v[16:31]
    ds_read_b128 v[92:95], v3 offset:48128
    v_mul_f32 v51, v51, v9
    v_mul_f32 v52, v52, v9
    v_mul_f32 v53, v53, v9
    v_mul_f32 v54, v54, v9
    v_mul_f32 v55, v55, v9
    ds_read_b128 v[96:99], v5 offset:0
    v_mfma_f32_32x32x16_bf16 v[16:31], v[68:71], v[164:167], v[16:31]
    ds_read_b128 v[64:67], v3 offset:49152
    buffer_load_dwordx4 v2, s[8:11], s89 offen offset:1024 sc1 lds
    ds_read_b128 v[100:103], v5 offset:16
    ds_read_b128 v[104:107], v5 offset:32
    v_mfma_f32_32x32x16_bf16 v[16:31], v[72:75], v[168:171], v[16:31]
    ds_read_b128 v[68:71], v3 offset:50176
    ds_read_b128 v[108:111], v5 offset:48
    v_exp_f32 v48, v48
    v_mul_f32 v56, v56, v10
    v_exp_f32 v49, v49
    v_mfma_f32_32x32x16_bf16 v[16:31], v[76:79], v[172:175], v[16:31]
    ds_read_b128 v[72:75], v3 offset:51200
    v_mul_f32 v57, v57, v10
    v_exp_f32 v50, v50
    v_mul_f32 v58, v58, v10
    v_exp_f32 v51, v51
    s_waitcnt lgkmcnt(7)
    v_mfma_f32_32x32x16_bf16 v[16:31], v[80:83], v[176:179], v[16:31]
    ds_read_b128 v[76:79], v3 offset:52224
    buffer_load_dwordx4 v2, s[8:11], s89 offen offset:2048 sc1 lds
    v_mul_f32 v59, v59, v10
    v_mfma_f32_32x32x16_bf16 v[16:31], v[84:87], v[180:183], v[16:31]
    ds_read_b128 v[80:83], v3 offset:53248
    v_exp_f32 v52, v52
    v_mul_f32 v60, v60, v10
    v_exp_f32 v53, v53
    v_mul_f32 v61, v61, v10
    v_mfma_f32_32x32x16_bf16 v[16:31], v[88:91], v[184:187], v[16:31]
    ds_read_b128 v[84:87], v3 offset:54272
    v_exp_f32 v54, v54
    v_mul_f32 v62, v62, v10
    v_exp_f32 v55, v55
    v_mul_f32 v63, v63, v10
    v_mfma_f32_32x32x16_bf16 v[16:31], v[92:95], v[188:191], v[16:31]
    ds_read_b128 v[88:91], v3 offset:55296
    buffer_load_dwordx4 v2, s[8:11], s89 offen offset:3072 sc1 lds
    v_add_f32 v48, 1.0, v48
    v_add_f32 v49, 1.0, v49
    s_waitcnt lgkmcnt(3)
    v_mfma_f32_32x32x16_bf16 v[16:31], v[64:67], v[192:195], v[16:31]
    ds_read_b128 v[92:95], v3 offset:56320
    v_add_f32 v50, 1.0, v50
    v_add_f32 v51, 1.0, v51
    v_add_f32 v52, 1.0, v52
    v_add_f32 v53, 1.0, v53
    v_add_f32 v54, 1.0, v54
    v_add_f32 v55, 1.0, v55
    v_mfma_f32_32x32x16_bf16 v[16:31], v[68:71], v[196:199], v[16:31]
    ds_read_b128 v[64:67], v3 offset:57344
    v_rcp_f32 v48, v48
    v_rcp_f32 v49, v49
    v_rcp_f32 v50, v50
    v_mfma_f32_32x32x16_bf16 v[16:31], v[72:75], v[200:203], v[16:31]
    ds_read_b128 v[68:71], v3 offset:58368
    s_add_u32 m0, s45, 32768
    s_add_u32 s89, s44, 98304
    buffer_load_dwordx4 v2, s[8:11], s89 offen offset:0 sc1 lds
    v_rcp_f32 v51, v51
    v_mfma_f32_32x32x16_bf16 v[16:31], v[76:79], v[204:207], v[16:31]
    ds_read_b128 v[72:75], v3 offset:59392
    v_rcp_f32 v52, v52
    v_rcp_f32 v53, v53
    v_rcp_f32 v54, v54
    s_waitcnt lgkmcnt(3)
    v_mfma_f32_32x32x16_bf16 v[16:31], v[80:83], v[208:211], v[16:31]
    ds_read_b128 v[76:79], v3 offset:60416
    buffer_load_dwordx4 v2, s[8:11], s89 offen offset:1024 sc1 lds
    v_rcp_f32 v55, v55
    v_mfma_f32_32x32x16_bf16 v[16:31], v[84:87], v[212:215], v[16:31]
    ds_read_b128 v[80:83], v3 offset:61440
    v_mul_f32 v48, v48, v56
    v_mul_f32 v49, v49, v57
    v_mul_f32 v50, v50, v58
    v_mul_f32 v51, v51, v59
    v_mul_f32 v52, v52, v60
    v_mul_f32 v53, v53, v61
    v_mfma_f32_32x32x16_bf16 v[16:31], v[88:91], v[216:219], v[16:31]
    ds_read_b128 v[84:87], v3 offset:62464
    v_mul_f32 v54, v54, v62
    v_mul_f32 v55, v55, v63
    v_cvt_pk_bf16_f32 v112, v48, v49
    v_cvt_pk_bf16_f32 v113, v50, v51
    v_cvt_pk_bf16_f32 v114, v52, v53
    v_cvt_pk_bf16_f32 v115, v54, v55
    v_mfma_f32_32x32x16_bf16 v[16:31], v[92:95], v[220:223], v[16:31]
    ds_read_b128 v[88:91], v3 offset:63488
    buffer_load_dwordx4 v2, s[8:11], s89 offen offset:2048 sc1 lds
    s_waitcnt lgkmcnt(3)
    v_mfma_f32_32x32x16_bf16 v[16:31], v[64:67], v[224:227], v[16:31]
    ds_read_b128 v[92:95], v3 offset:64512
    s_add_u32 s57, s46, 8192
    buffer_store_dwordx4 v[112:115], v2, s[8:11], s57 offen sc1
    s_waitcnt vmcnt(18)
    s_barrier
    v_mfma_f32_32x32x16_bf16 v[16:31], v[68:71], v[228:231], v[16:31]
    ds_read_b128 v[64:67], v3 offset:0
    v_mfma_f32_32x32x16_bf16 v[16:31], v[72:75], v[232:235], v[16:31]
    ds_read_b128 v[68:71], v3 offset:1024
    v_mfma_f32_32x32x16_bf16 v[16:31], v[76:79], v[236:239], v[16:31]
    ds_read_b128 v[72:75], v3 offset:2048
    s_waitcnt lgkmcnt(3)
    v_mfma_f32_32x32x16_bf16 v[16:31], v[80:83], v[240:243], v[16:31]
    ds_read_b128 v[76:79], v3 offset:3072
    v_mfma_f32_32x32x16_bf16 v[16:31], v[84:87], v[244:247], v[16:31]
    ds_read_b128 v[80:83], v3 offset:4096
    buffer_load_dwordx4 v2, s[8:11], s89 offen offset:3072 sc1 lds
    v_mfma_f32_32x32x16_bf16 v[16:31], v[88:91], v[248:251], v[16:31]
    ds_read_b128 v[84:87], v3 offset:5120
    v_mfma_f32_32x32x16_bf16 v[16:31], v[92:95], v[252:255], v[16:31]
    ds_read_b128 v[88:91], v3 offset:6144
    s_waitcnt lgkmcnt(3)
    v_mfma_f32_32x32x16_bf16 v[32:47], v[64:67], v[128:131], 0
    ds_read_b128 v[92:95], v3 offset:7168
    s_add_u32 m0, s45, 49152
    s_add_u32 s89, s44, 114688
    buffer_load_dwordx4 v2, s[8:11], s89 offen offset:0 sc1 lds
    v_mfma_f32_32x32x16_bf16 v[32:47], v[68:71], v[132:135], v[32:47]
    ds_read_b128 v[64:67], v3 offset:8192
    v_mfma_f32_32x32x16_bf16 v[32:47], v[72:75], v[136:139], v[32:47]
    ds_read_b128 v[68:71], v3 offset:9216
    buffer_load_dwordx4 v2, s[8:11], s89 offen offset:1024 sc1 lds
    s_waitcnt lgkmcnt(15)
    v_mfma_f32_32x32x16_bf16 v[32:47], v[76:79], v[140:143], v[32:47]
    ds_read_b128 v[72:75], v3 offset:10240
    v_fma_f32 v16, -v8, v96, v16
    v_fma_f32 v17, -v8, v97, v17
    v_fma_f32 v18, -v8, v98, v18
    v_fma_f32 v19, -v8, v99, v19
    v_fma_f32 v20, -v8, v100, v20
    s_waitcnt lgkmcnt(3)
    v_mfma_f32_32x32x16_bf16 v[32:47], v[80:83], v[144:147], v[32:47]
    ds_read_b128 v[76:79], v3 offset:11264
    v_fma_f32 v21, -v8, v101, v21
    v_fma_f32 v22, -v8, v102, v22
    v_fma_f32 v23, -v8, v103, v23
    v_fma_f32 v24, -v8, v104, v24
    v_fma_f32 v25, -v8, v105, v25
    v_mfma_f32_32x32x16_bf16 v[32:47], v[84:87], v[148:151], v[32:47]
    ds_read_b128 v[80:83], v3 offset:12288
    buffer_load_dwordx4 v2, s[8:11], s89 offen offset:2048 sc1 lds
    v_fma_f32 v26, -v8, v106, v26
    v_mfma_f32_32x32x16_bf16 v[32:47], v[88:91], v[152:155], v[32:47]
    ds_read_b128 v[84:87], v3 offset:13312
    v_fma_f32 v27, -v8, v107, v27
    v_fma_f32 v28, -v8, v108, v28
    v_fma_f32 v29, -v8, v109, v29
    v_fma_f32 v30, -v8, v110, v30
    v_fma_f32 v31, -v8, v111, v31
    v_mfma_f32_32x32x16_bf16 v[32:47], v[92:95], v[156:159], v[32:47]
    ds_read_b128 v[88:91], v3 offset:14336
    v_mul_f32 v16, v16, v9
    v_mul_f32 v17, v17, v9
    v_mul_f32 v18, v18, v9
    v_mul_f32 v19, v19, v9
    v_mul_f32 v20, v20, v9
    s_waitcnt lgkmcnt(3)
    v_mfma_f32_32x32x16_bf16 v[32:47], v[64:67], v[160:163], v[32:47]
    ds_read_b128 v[92:95], v3 offset:15360
    buffer_load_dwordx4 v2, s[8:11], s89 offen offset:3072 sc1 lds
    v_mul_f32 v21, v21, v9
    v_mfma_f32_32x32x16_bf16 v[32:47], v[68:71], v[164:167], v[32:47]
    ds_read_b128 v[64:67], v3 offset:16384
    v_mul_f32 v22, v22, v9
    v_mul_f32 v23, v23, v9
    ds_read_b128 v[96:99], v5 offset:128
    ds_read_b128 v[100:103], v5 offset:144
    ds_read_b128 v[104:107], v5 offset:160
    v_mfma_f32_32x32x16_bf16 v[32:47], v[72:75], v[168:171], v[32:47]
    ds_read_b128 v[68:71], v3 offset:17408
    ds_read_b128 v[108:111], v5 offset:176
    v_exp_f32 v16, v16
    v_mul_f32 v24, v24, v10
    v_mfma_f32_32x32x16_bf16 v[32:47], v[76:79], v[172:175], v[32:47]
    ds_read_b128 v[72:75], v3 offset:18432
    v_exp_f32 v17, v17
    v_mul_f32 v25, v25, v10
    v_exp_f32 v18, v18
    s_waitcnt lgkmcnt(7)
    v_mfma_f32_32x32x16_bf16 v[32:47], v[80:83], v[176:179], v[32:47]
    ds_read_b128 v[76:79], v3 offset:19456
    v_mul_f32 v26, v26, v10
    v_exp_f32 v19, v19
    v_mul_f32 v27, v27, v10
    v_mfma_f32_32x32x16_bf16 v[32:47], v[84:87], v[180:183], v[32:47]
    ds_read_b128 v[80:83], v3 offset:20480
    v_exp_f32 v20, v20
    v_mul_f32 v28, v28, v10
    v_exp_f32 v21, v21
    v_mfma_f32_32x32x16_bf16 v[32:47], v[88:91], v[184:187], v[32:47]
    ds_read_b128 v[84:87], v3 offset:21504
    v_mul_f32 v29, v29, v10
    v_exp_f32 v22, v22
    v_mul_f32 v30, v30, v10
    v_mfma_f32_32x32x16_bf16 v[32:47], v[92:95], v[188:191], v[32:47]
    ds_read_b128 v[88:91], v3 offset:22528
    v_exp_f32 v23, v23
    v_mul_f32 v31, v31, v10
    v_add_f32 v16, 1.0, v16
    v_add_f32 v17, 1.0, v17
    s_waitcnt lgkmcnt(3)
    v_mfma_f32_32x32x16_bf16 v[32:47], v[64:67], v[192:195], v[32:47]
    ds_read_b128 v[92:95], v3 offset:23552
    v_add_f32 v18, 1.0, v18
    v_add_f32 v19, 1.0, v19
    v_add_f32 v20, 1.0, v20
    v_add_f32 v21, 1.0, v21
    v_add_f32 v22, 1.0, v22
    v_mfma_f32_32x32x16_bf16 v[32:47], v[68:71], v[196:199], v[32:47]
    ds_read_b128 v[64:67], v3 offset:24576
    v_add_f32 v23, 1.0, v23
    v_rcp_f32 v16, v16
    v_rcp_f32 v17, v17
    v_mfma_f32_32x32x16_bf16 v[32:47], v[72:75], v[200:203], v[32:47]
    ds_read_b128 v[68:71], v3 offset:25600
    v_rcp_f32 v18, v18
    v_rcp_f32 v19, v19
    v_mfma_f32_32x32x16_bf16 v[32:47], v[76:79], v[204:207], v[32:47]
    ds_read_b128 v[72:75], v3 offset:26624
    v_rcp_f32 v20, v20
    v_rcp_f32 v21, v21
    s_waitcnt lgkmcnt(3)
    v_mfma_f32_32x32x16_bf16 v[32:47], v[80:83], v[208:211], v[32:47]
    ds_read_b128 v[76:79], v3 offset:27648
    v_rcp_f32 v22, v22
    v_rcp_f32 v23, v23
    v_mul_f32 v16, v16, v24
    v_mfma_f32_32x32x16_bf16 v[32:47], v[84:87], v[212:215], v[32:47]
    ds_read_b128 v[80:83], v3 offset:28672
    v_mul_f32 v17, v17, v25
    v_mul_f32 v18, v18, v26
    v_mul_f32 v19, v19, v27
    v_mul_f32 v20, v20, v28
    v_mul_f32 v21, v21, v29
    v_mfma_f32_32x32x16_bf16 v[32:47], v[88:91], v[216:219], v[32:47]
    ds_read_b128 v[84:87], v3 offset:29696
    v_mul_f32 v22, v22, v30
    v_mul_f32 v23, v23, v31
    v_cvt_pk_bf16_f32 v116, v16, v17
    v_cvt_pk_bf16_f32 v117, v18, v19
    v_cvt_pk_bf16_f32 v118, v20, v21
    s_waitcnt vmcnt(5)
    v_mov_b32 v14, s18
    v_mov_b32 v15, s19
    buffer_store_dwordx2 v[14:15], v7, s[8:11], s52 offen sc1
    v_mfma_f32_32x32x16_bf16 v[32:47], v[92:95], v[220:223], v[32:47]
    ds_read_b128 v[88:91], v3 offset:30720
    v_cvt_pk_bf16_f32 v119, v22, v23
    s_add_u32 s57, s46, 12288
    buffer_store_dwordx4 v[116:119], v2, s[8:11], s57 offen sc1
    s_waitcnt lgkmcnt(3)
    v_mfma_f32_32x32x16_bf16 v[32:47], v[64:67], v[224:227], v[32:47]
    ds_read_b128 v[92:95], v3 offset:31744
    s_waitcnt vmcnt(11)
    s_barrier
    v_mfma_f32_32x32x16_bf16 v[32:47], v[68:71], v[228:231], v[32:47]
    ds_read_b128 v[64:67], v2 offset:0
    v_mfma_f32_32x32x16_bf16 v[32:47], v[72:75], v[232:235], v[32:47]
    ds_read_b128 v[68:71], v2 offset:1024
    v_mfma_f32_32x32x16_bf16 v[32:47], v[76:79], v[236:239], v[32:47]
    ds_read_b128 v[72:75], v2 offset:2048
    s_waitcnt lgkmcnt(3)
    v_mfma_f32_32x32x16_bf16 v[32:47], v[80:83], v[240:243], v[32:47]
    ds_read_b128 v[76:79], v2 offset:3072
    v_mfma_f32_32x32x16_bf16 v[32:47], v[84:87], v[244:247], v[32:47]
    ds_read_b128 v[80:83], v2 offset:4096
    v_mfma_f32_32x32x16_bf16 v[32:47], v[88:91], v[248:251], v[32:47]
    ds_read_b128 v[84:87], v2 offset:5120
    v_mfma_f32_32x32x16_bf16 v[32:47], v[92:95], v[252:255], v[32:47]
    ds_read_b128 v[88:91], v2 offset:6144
    s_waitcnt lgkmcnt(3)
    v_mfma_f32_32x32x16_bf16 v[48:63], v[64:67], v[128:131], 0
    ds_read_b128 v[92:95], v2 offset:7168
    v_mfma_f32_32x32x16_bf16 v[48:63], v[68:71], v[132:135], v[48:63]
    ds_read_b128 v[64:67], v2 offset:8192
    v_mfma_f32_32x32x16_bf16 v[48:63], v[72:75], v[136:139], v[48:63]
    ds_read_b128 v[68:71], v2 offset:9216
    s_waitcnt lgkmcnt(15)
    s_nop 2
    v_fma_f32 v32, -v8, v96, v32
    v_fma_f32 v33, -v8, v97, v33
    v_fma_f32 v34, -v8, v98, v34
    v_fma_f32 v35, -v8, v99, v35
    v_mfma_f32_32x32x16_bf16 v[48:63], v[76:79], v[140:143], v[48:63]
    ds_read_b128 v[72:75], v2 offset:10240
    v_fma_f32 v36, -v8, v100, v36
    v_fma_f32 v37, -v8, v101, v37
    v_fma_f32 v38, -v8, v102, v38
    v_fma_f32 v39, -v8, v103, v39
    v_fma_f32 v40, -v8, v104, v40
    buffer_load_dwordx2 v[124:125], v6, s[8:11], s51 offen sc1
    s_waitcnt lgkmcnt(3)
    v_mfma_f32_32x32x16_bf16 v[48:63], v[80:83], v[144:147], v[48:63]
    ds_read_b128 v[76:79], v2 offset:11264
    v_fma_f32 v41, -v8, v105, v41
    v_fma_f32 v42, -v8, v106, v42
    v_fma_f32 v43, -v8, v107, v43
    v_fma_f32 v44, -v8, v108, v44
    v_fma_f32 v45, -v8, v109, v45
    v_mfma_f32_32x32x16_bf16 v[48:63], v[84:87], v[148:151], v[48:63]
    ds_read_b128 v[80:83], v2 offset:12288
    v_fma_f32 v46, -v8, v110, v46
    v_fma_f32 v47, -v8, v111, v47
    v_mul_f32 v32, v32, v9
    v_mul_f32 v33, v33, v9
    v_mul_f32 v34, v34, v9
    v_mfma_f32_32x32x16_bf16 v[48:63], v[88:91], v[152:155], v[48:63]
    ds_read_b128 v[84:87], v2 offset:13312
    v_mul_f32 v35, v35, v9
    v_mul_f32 v36, v36, v9
    v_mul_f32 v37, v37, v9
    v_mul_f32 v38, v38, v9
    v_mul_f32 v39, v39, v9
    v_mfma_f32_32x32x16_bf16 v[48:63], v[92:95], v[156:159], v[48:63]
    ds_read_b128 v[88:91], v2 offset:14336
    ds_read_b128 v[96:99], v5 offset:256
    ds_read_b128 v[100:103], v5 offset:272
    ds_read_b128 v[104:107], v5 offset:288
    ds_read_b128 v[108:111], v5 offset:304
    s_waitcnt lgkmcnt(7)
    v_mfma_f32_32x32x16_bf16 v[48:63], v[64:67], v[160:163], v[48:63]
    ds_read_b128 v[92:95], v2 offset:15360
    v_exp_f32 v32, v32
    v_mul_f32 v40, v40, v10
    v_exp_f32 v33, v33
    v_mfma_f32_32x32x16_bf16 v[48:63], v[68:71], v[164:167], v[48:63]
    ds_read_b128 v[64:67], v2 offset:16384
    v_mul_f32 v41, v41, v10
    v_exp_f32 v34, v34
    v_mul_f32 v42, v42, v10
    v_mfma_f32_32x32x16_bf16 v[48:63], v[72:75], v[168:171], v[48:63]
    ds_read_b128 v[68:71], v2 offset:17408
    v_exp_f32 v35, v35
    v_mul_f32 v43, v43, v10
    v_exp_f32 v36, v36
    v_mfma_f32_32x32x16_bf16 v[48:63], v[76:79], v[172:175], v[48:63]
    ds_read_b128 v[72:75], v2 offset:18432
    v_mul_f32 v44, v44, v10
    v_exp_f32 v37, v37
    v_mul_f32 v45, v45, v10
    s_waitcnt lgkmcnt(3)
    v_mfma_f32_32x32x16_bf16 v[48:63], v[80:83], v[176:179], v[48:63]
    ds_read_b128 v[76:79], v2 offset:19456
    v_exp_f32 v38, v38
    v_mul_f32 v46, v46, v10
    v_exp_f32 v39, v39
    v_mfma_f32_32x32x16_bf16 v[48:63], v[84:87], v[180:183], v[48:63]
    ds_read_b128 v[80:83], v2 offset:20480
    v_mul_f32 v47, v47, v10
    v_add_f32 v32, 1.0, v32
    v_add_f32 v33, 1.0, v33
    v_add_f32 v34, 1.0, v34
    v_add_f32 v35, 1.0, v35
    v_mfma_f32_32x32x16_bf16 v[48:63], v[88:91], v[184:187], v[48:63]
    ds_read_b128 v[84:87], v2 offset:21504
    v_add_f32 v36, 1.0, v36
    v_add_f32 v37, 1.0, v37
    v_add_f32 v38, 1.0, v38
    v_add_f32 v39, 1.0, v39
    v_mfma_f32_32x32x16_bf16 v[48:63], v[92:95], v[188:191], v[48:63]
    ds_read_b128 v[88:91], v2 offset:22528
    v_rcp_f32 v32, v32
    v_rcp_f32 v33, v33
    s_waitcnt lgkmcnt(3)
    v_mfma_f32_32x32x16_bf16 v[48:63], v[64:67], v[192:195], v[48:63]
    ds_read_b128 v[92:95], v2 offset:23552
    v_rcp_f32 v34, v34
    v_rcp_f32 v35, v35
    v_mfma_f32_32x32x16_bf16 v[48:63], v[68:71], v[196:199], v[48:63]
    ds_read_b128 v[64:67], v2 offset:24576
    v_rcp_f32 v36, v36
    v_rcp_f32 v37, v37
    v_mfma_f32_32x32x16_bf16 v[48:63], v[72:75], v[200:203], v[48:63]
    ds_read_b128 v[68:71], v2 offset:25600
    v_rcp_f32 v38, v38
    v_rcp_f32 v39, v39
    v_mul_f32 v32, v32, v40
    v_mfma_f32_32x32x16_bf16 v[48:63], v[76:79], v[204:207], v[48:63]
    ds_read_b128 v[72:75], v2 offset:26624
    v_mul_f32 v33, v33, v41
    v_mul_f32 v34, v34, v42
    v_mul_f32 v35, v35, v43
    v_mul_f32 v36, v36, v44
    v_mul_f32 v37, v37, v45
    s_waitcnt lgkmcnt(3)
    v_mfma_f32_32x32x16_bf16 v[48:63], v[80:83], v[208:211], v[48:63]
    ds_read_b128 v[76:79], v2 offset:27648
    v_mul_f32 v38, v38, v46
    v_mul_f32 v39, v39, v47
    v_cvt_pk_bf16_f32 v112, v32, v33
    v_cvt_pk_bf16_f32 v113, v34, v35
    v_cvt_pk_bf16_f32 v114, v36, v37
    v_mfma_f32_32x32x16_bf16 v[48:63], v[84:87], v[212:215], v[48:63]
    ds_read_b128 v[80:83], v2 offset:28672
    v_cvt_pk_bf16_f32 v115, v38, v39
    s_add_u32 s57, s46, 16384
    buffer_store_dwordx4 v[112:115], v2, s[8:11], s57 offen sc1
    v_mfma_f32_32x32x16_bf16 v[48:63], v[88:91], v[216:219], v[48:63]
    ds_read_b128 v[84:87], v2 offset:29696
    v_mfma_f32_32x32x16_bf16 v[48:63], v[92:95], v[220:223], v[48:63]
    ds_read_b128 v[88:91], v2 offset:30720
    s_waitcnt lgkmcnt(3)
    v_mfma_f32_32x32x16_bf16 v[48:63], v[64:67], v[224:227], v[48:63]
    ds_read_b128 v[92:95], v2 offset:31744
    s_waitcnt vmcnt(4)
    s_barrier
    v_mfma_f32_32x32x16_bf16 v[48:63], v[68:71], v[228:231], v[48:63]
    ds_read_b128 v[64:67], v2 offset:32768
    v_mfma_f32_32x32x16_bf16 v[48:63], v[72:75], v[232:235], v[48:63]
    ds_read_b128 v[68:71], v2 offset:33792
    v_mfma_f32_32x32x16_bf16 v[48:63], v[76:79], v[236:239], v[48:63]
    ds_read_b128 v[72:75], v2 offset:34816
    s_waitcnt lgkmcnt(3)
    v_mfma_f32_32x32x16_bf16 v[48:63], v[80:83], v[240:243], v[48:63]
    ds_read_b128 v[76:79], v2 offset:35840
    v_mfma_f32_32x32x16_bf16 v[48:63], v[84:87], v[244:247], v[48:63]
    ds_read_b128 v[80:83], v2 offset:36864
    v_mfma_f32_32x32x16_bf16 v[48:63], v[88:91], v[248:251], v[48:63]
    ds_read_b128 v[84:87], v2 offset:37888
    v_mfma_f32_32x32x16_bf16 v[48:63], v[92:95], v[252:255], v[48:63]
    ds_read_b128 v[88:91], v2 offset:38912
    s_waitcnt lgkmcnt(3)
    v_mfma_f32_32x32x16_bf16 v[16:31], v[64:67], v[128:131], 0
    ds_read_b128 v[92:95], v2 offset:39936
    v_mfma_f32_32x32x16_bf16 v[16:31], v[68:71], v[132:135], v[16:31]
    ds_read_b128 v[64:67], v2 offset:40960
    s_waitcnt vmcnt(1)
    v_cmp_eq_u64 vcc, s[18:19], v[124:125]
    s_cmp_eq_u64 vcc, -1
    s_cbranch_scc0 L_spin_65
L_ok_64:
    v_mfma_f32_32x32x16_bf16 v[16:31], v[72:75], v[136:139], v[16:31]
    ds_read_b128 v[68:71], v2 offset:41984
    s_add_u32 s54, s100, 0
    buffer_load_dwordx4 v[128:131], v2, s[8:11], s54 offen offset:0 sc1
    s_waitcnt lgkmcnt(15)
    v_fma_f32 v48, -v8, v96, v48
    v_mfma_f32_32x32x16_bf16 v[16:31], v[76:79], v[140:143], v[16:31]
    ds_read_b128 v[72:75], v2 offset:43008
    s_add_u32 s55, s101, 0
    buffer_load_dwordx4 v[132:135], v2, s[8:11], s55 offen offset:0 sc1
    v_fma_f32 v49, -v8, v97, v49
    v_fma_f32 v50, -v8, v98, v50
    s_waitcnt lgkmcnt(3)
    v_mfma_f32_32x32x16_bf16 v[16:31], v[80:83], v[144:147], v[16:31]
    ds_read_b128 v[76:79], v2 offset:44032
    v_fma_f32 v51, -v8, v99, v51
    v_fma_f32 v52, -v8, v100, v52
    v_fma_f32 v53, -v8, v101, v53
    v_fma_f32 v54, -v8, v102, v54
    v_fma_f32 v55, -v8, v103, v55
    v_fma_f32 v56, -v8, v104, v56
    v_mfma_f32_32x32x16_bf16 v[16:31], v[84:87], v[148:151], v[16:31]
    ds_read_b128 v[80:83], v2 offset:45056
    buffer_load_dwordx4 v[136:139], v2, s[8:11], s54 offen offset:1024 sc1
    v_fma_f32 v57, -v8, v105, v57
    v_fma_f32 v58, -v8, v106, v58
    v_mfma_f32_32x32x16_bf16 v[16:31], v[88:91], v[152:155], v[16:31]
    ds_read_b128 v[84:87], v2 offset:46080
    buffer_load_dwordx4 v[140:143], v2, s[8:11], s55 offen offset:1024 sc1
    v_fma_f32 v59, -v8, v107, v59
    v_fma_f32 v60, -v8, v108, v60
    v_mfma_f32_32x32x16_bf16 v[16:31], v[92:95], v[156:159], v[16:31]
    ds_read_b128 v[88:91], v2 offset:47104
    v_fma_f32 v61, -v8, v109, v61
    v_fma_f32 v62, -v8, v110, v62
    v_fma_f32 v63, -v8, v111, v63
    v_mul_f32 v48, v48, v9
    v_mul_f32 v49, v49, v9
    v_mul_f32 v50, v50, v9
    s_waitcnt lgkmcnt(3)
    v_mfma_f32_32x32x16_bf16 v[16:31], v[64:67], v[160:163], v[16:31]
    ds_read_b128 v[92:95], v2 offset:48128
    buffer_load_dwordx4 v[144:147], v2, s[8:11], s54 offen offset:2048 sc1
    v_mul_f32 v51, v51, v9
    v_mul_f32 v52, v52, v9
    v_mfma_f32_32x32x16_bf16 v[16:31], v[68:71], v[164:167], v[16:31]
    ds_read_b128 v[64:67], v2 offset:49152
    buffer_load_dwordx4 v[148:151], v2, s[8:11], s55 offen offset:2048 sc1
    v_mul_f32 v53, v53, v9
    v_mul_f32 v54, v54, v9
    v_mfma_f32_32x32x16_bf16 v[16:31], v[72:75], v[168:171], v[16:31]
    ds_read_b128 v[68:71], v2 offset:50176
    v_mul_f32 v55, v55, v9
    ds_read_b128 v[96:99], v5 offset:384
    ds_read_b128 v[100:103], v5 offset:400
    ds_read_b128 v[104:107], v5 offset:416
    ds_read_b128 v[108:111], v5 offset:432
    v_mfma_f32_32x32x16_bf16 v[16:31], v[76:79], v[172:175], v[16:31]
    ds_read_b128 v[72:75], v2 offset:51200
    buffer_load_dwordx4 v[152:155], v2, s[8:11], s54 offen offset:3072 sc1
    v_exp_f32 v48, v48
    s_waitcnt lgkmcnt(7)
    v_mfma_f32_32x32x16_bf16 v[16:31], v[80:83], v[176:179], v[16:31]
    ds_read_b128 v[76:79], v2 offset:52224
    v_mul_f32 v56, v56, v10
    v_exp_f32 v49, v49
    v_mul_f32 v57, v57, v10
    v_exp_f32 v50, v50
    v_mfma_f32_32x32x16_bf16 v[16:31], v[84:87], v[180:183], v[16:31]
    ds_read_b128 v[80:83], v2 offset:53248
    buffer_load_dwordx4 v[156:159], v2, s[8:11], s55 offen offset:3072 sc1
    v_mul_f32 v58, v58, v10
    v_mfma_f32_32x32x16_bf16 v[16:31], v[88:91], v[184:187], v[16:31]
    ds_read_b128 v[84:87], v2 offset:54272
    s_add_u32 s54, s100, 4096
    buffer_load_dwordx4 v[160:163], v2, s[8:11], s54 offen offset:0 sc1
    v_exp_f32 v51, v51
    v_mfma_f32_32x32x16_bf16 v[16:31], v[92:95], v[188:191], v[16:31]
    ds_read_b128 v[88:91], v2 offset:55296
    v_mul_f32 v59, v59, v10
    v_exp_f32 v52, v52
    v_mul_f32 v60, v60, v10
    v_exp_f32 v53, v53
    s_waitcnt lgkmcnt(3)
    v_mfma_f32_32x32x16_bf16 v[16:31], v[64:67], v[192:195], v[16:31]
    ds_read_b128 v[92:95], v2 offset:56320
    s_add_u32 s55, s101, 4096
    buffer_load_dwordx4 v[164:167], v2, s[8:11], s55 offen offset:0 sc1
    v_mul_f32 v61, v61, v10
    v_mfma_f32_32x32x16_bf16 v[16:31], v[68:71], v[196:199], v[16:31]
    ds_read_b128 v[64:67], v2 offset:57344
    buffer_load_dwordx4 v[168:171], v2, s[8:11], s54 offen offset:1024 sc1
    v_exp_f32 v54, v54
    v_mfma_f32_32x32x16_bf16 v[16:31], v[72:75], v[200:203], v[16:31]
    ds_read_b128 v[68:71], v2 offset:58368
    v_mul_f32 v62, v62, v10
    v_exp_f32 v55, v55
    v_mul_f32 v63, v63, v10
    v_add_f32 v48, 1.0, v48
    v_add_f32 v49, 1.0, v49
    v_mfma_f32_32x32x16_bf16 v[16:31], v[76:79], v[204:207], v[16:31]
    ds_read_b128 v[72:75], v2 offset:59392
    buffer_load_dwordx4 v[172:175], v2, s[8:11], s55 offen offset:1024 sc1
    v_add_f32 v50, 1.0, v50
    v_add_f32 v51, 1.0, v51
    s_waitcnt lgkmcnt(3)
    v_mfma_f32_32x32x16_bf16 v[16:31], v[80:83], v[208:211], v[16:31]
    ds_read_b128 v[76:79], v2 offset:60416
    v_add_f32 v52, 1.0, v52
    v_add_f32 v53, 1.0, v53
    v_add_f32 v54, 1.0, v54
    v_add_f32 v55, 1.0, v55
    v_rcp_f32 v48, v48
    v_mfma_f32_32x32x16_bf16 v[16:31], v[84:87], v[212:215], v[16:31]
    ds_read_b128 v[80:83], v2 offset:61440
    buffer_load_dwordx4 v[176:179], v2, s[8:11], s54 offen offset:2048 sc1
    v_mfma_f32_32x32x16_bf16 v[16:31], v[88:91], v[216:219], v[16:31]
    ds_read_b128 v[84:87], v2 offset:62464
    buffer_load_dwordx4 v[180:183], v2, s[8:11], s55 offen offset:2048 sc1
    v_rcp_f32 v49, v49
    v_mfma_f32_32x32x16_bf16 v[16:31], v[92:95], v[220:223], v[16:31]
    ds_read_b128 v[88:91], v2 offset:63488
    v_rcp_f32 v50, v50
    v_rcp_f32 v51, v51
    v_rcp_f32 v52, v52
    s_waitcnt lgkmcnt(3)
    v_mfma_f32_32x32x16_bf16 v[16:31], v[64:67], v[224:227], v[16:31]
    ds_read_b128 v[92:95], v2 offset:64512
    buffer_load_dwordx4 v[184:187], v2, s[8:11], s54 offen offset:3072 sc1
    v_mfma_f32_32x32x16_bf16 v[16:31], v[68:71], v[228:231], v[16:31]
    buffer_load_dwordx4 v[188:191], v2, s[8:11], s55 offen offset:3072 sc1
    v_rcp_f32 v53, v53
    v_mfma_f32_32x32x16_bf16 v[16:31], v[72:75], v[232:235], v[16:31]
    v_rcp_f32 v54, v54
    v_rcp_f32 v55, v55
    v_mul_f32 v48, v48, v56
    v_mul_f32 v49, v49, v57
    v_mfma_f32_32x32x16_bf16 v[16:31], v[76:79], v[236:239], v[16:31]
    s_add_u32 s54, s100, 8192
    buffer_load_dwordx4 v[192:195], v2, s[8:11], s54 offen offset:0 sc1
    v_mul_f32 v50, v50, v58
    v_mul_f32 v51, v51, v59
    s_waitcnt lgkmcnt(0)
    v_mfma_f32_32x32x16_bf16 v[16:31], v[80:83], v[240:243], v[16:31]
    v_mul_f32 v52, v52, v60
    v_mul_f32 v53, v53, v61
    v_mul_f32 v54, v54, v62
    v_mul_f32 v55, v55, v63
    v_cvt_pk_bf16_f32 v116, v48, v49
    v_cvt_pk_bf16_f32 v117, v50, v51
    v_mfma_f32_32x32x16_bf16 v[16:31], v[84:87], v[244:247], v[16:31]
    s_add_u32 s55, s101, 8192
    buffer_load_dwordx4 v[196:199], v2, s[8:11], s55 offen offset:0 sc1
    v_cvt_pk_bf16_f32 v118, v52, v53
    v_mfma_f32_32x32x16_bf16 v[16:31], v[88:91], v[248:251], v[16:31]
    buffer_load_dwordx4 v[200:203], v2, s[8:11], s54 offen offset:1024 sc1
    v_cvt_pk_bf16_f32 v119, v54, v55
    v_mfma_f32_32x32x16_bf16 v[16:31], v[92:95], v[252:255], v[16:31]
    s_add_u32 s57, s46, 20480
    buffer_store_dwordx4 v[116:119], v2, s[8:11], s57 offen sc1
    buffer_load_dwordx4 v[204:207], v2, s[8:11], s55 offen offset:1024 sc1
    s_waitcnt vmcnt(19)
    v_mfma_f32_32x32x16_bf16 v[32:47], a[160:163], v[128:131], 0
    s_waitcnt lgkmcnt(14)
    s_nop 5
    v_fma_f32 v16, -v8, v96, v16
    v_fma_f32 v17, -v8, v97, v17
    v_fma_f32 v18, -v8, v98, v18
    v_fma_f32 v19, -v8, v99, v19
    v_fma_f32 v20, -v8, v100, v20
    v_fma_f32 v21, -v8, v101, v21
    v_fma_f32 v22, -v8, v102, v22
    v_fma_f32 v23, -v8, v103, v23
    v_fma_f32 v24, -v8, v104, v24
    v_fma_f32 v25, -v8, v105, v25
    v_fma_f32 v26, -v8, v106, v26
    v_mfma_f32_32x32x16_bf16 v[48:63], a[164:167], v[128:131], 0
    buffer_load_dwordx4 v[208:211], v2, s[8:11], s54 offen offset:2048 sc1
    v_fma_f32 v27, -v8, v107, v27
    v_fma_f32 v28, -v8, v108, v28
    v_fma_f32 v29, -v8, v109, v29
    v_fma_f32 v30, -v8, v110, v30
    v_fma_f32 v31, -v8, v111, v31
    v_mul_f32 v16, v16, v9
    v_mul_f32 v17, v17, v9
    v_mul_f32 v18, v18, v9
    v_mfma_f32_32x32x16_bf16 v[64:79], a[160:163], v[132:135], 0
    v_mul_f32 v19, v19, v9
    v_mul_f32 v20, v20, v9
    v_mul_f32 v21, v21, v9
    v_mul_f32 v22, v22, v9
    v_mul_f32 v23, v23, v9
    v_exp_f32 v16, v16
    v_mul_f32 v24, v24, v10
    v_exp_f32 v17, v17
    v_mul_f32 v25, v25, v10
    v_mfma_f32_32x32x16_bf16 v[80:95], a[164:167], v[132:135], 0
    buffer_load_dwordx4 v[212:215], v2, s[8:11], s55 offen offset:2048 sc1
    v_exp_f32 v18, v18
    v_mul_f32 v26, v26, v10
    v_exp_f32 v19, v19
    v_mul_f32 v27, v27, v10
    v_exp_f32 v20, v20
    s_waitcnt vmcnt(19)
    v_mfma_f32_32x32x16_bf16 v[32:47], a[168:171], v[136:139], v[32:47]
    v_mul_f32 v28, v28, v10
    v_exp_f32 v21, v21
    v_mul_f32 v29, v29, v10
    v_exp_f32 v22, v22
    v_mul_f32 v30, v30, v10
    v_exp_f32 v23, v23
    v_mul_f32 v31, v31, v10
    v_add_f32 v16, 1.0, v16
    v_add_f32 v17, 1.0, v17
    v_mfma_f32_32x32x16_bf16 v[48:63], a[172:175], v[136:139], v[48:63]
    buffer_load_dwordx4 v[216:219], v2, s[8:11], s54 offen offset:3072 sc1
    v_add_f32 v18, 1.0, v18
    v_add_f32 v19, 1.0, v19
    v_add_f32 v20, 1.0, v20
    v_add_f32 v21, 1.0, v21
    v_add_f32 v22, 1.0, v22
    v_add_f32 v23, 1.0, v23
    v_rcp_f32 v16, v16
    v_mfma_f32_32x32x16_bf16 v[64:79], a[168:171], v[140:143], v[64:79]
    v_rcp_f32 v17, v17
    v_rcp_f32 v18, v18
    v_rcp_f32 v19, v19
    v_rcp_f32 v20, v20
    v_rcp_f32 v21, v21
    v_rcp_f32 v22, v22
    v_mfma_f32_32x32x16_bf16 v[80:95], a[172:175], v[140:143], v[80:95]
    buffer_load_dwordx4 v[220:223], v2, s[8:11], s55 offen offset:3072 sc1
    v_rcp_f32 v23, v23
    v_mul_f32 v16, v16, v24
    v_mul_f32 v17, v17, v25
    v_mul_f32 v18, v18, v26
    v_mul_f32 v19, v19, v27
    v_mul_f32 v20, v20, v28
    v_mul_f32 v21, v21, v29
    s_waitcnt vmcnt(19)
    v_mfma_f32_32x32x16_bf16 v[32:47], a[176:179], v[144:147], v[32:47]
    v_mul_f32 v22, v22, v30
    v_mul_f32 v23, v23, v31
    v_cvt_pk_bf16_f32 v112, v16, v17
    v_cvt_pk_bf16_f32 v113, v18, v19
    v_cvt_pk_bf16_f32 v114, v20, v21
    v_cvt_pk_bf16_f32 v115, v22, v23
    s_add_u32 s57, s46, 24576
    buffer_store_dwordx4 v[112:115], v2, s[8:11], s57 offen sc1
    v_accvgpr_read_b32 v96, a228
    v_accvgpr_read_b32 v97, a229
    v_mfma_f32_32x32x16_bf16 v[48:63], a[180:183], v[144:147], v[48:63]
    v_accvgpr_read_b32 v98, a230
    v_accvgpr_read_b32 v99, a231
    v_accvgpr_read_b32 v100, a232
    v_accvgpr_read_b32 v101, a233
    v_accvgpr_read_b32 v102, a234
    v_accvgpr_read_b32 v103, a235
    v_mfma_f32_32x32x16_bf16 v[64:79], a[176:179], v[148:151], v[64:79]
    v_mfma_f32_32x32x16_bf16 v[80:95], a[180:183], v[148:151], v[80:95]
    s_add_u32 s54, s100, 12288
    buffer_load_dwordx4 v[224:227], v2, s[8:11], s54 offen offset:0 sc1
    s_waitcnt vmcnt(19)
    v_mfma_f32_32x32x16_bf16 v[32:47], a[184:187], v[152:155], v[32:47]
    v_mfma_f32_32x32x16_bf16 v[48:63], a[188:191], v[152:155], v[48:63]
    s_add_u32 s55, s101, 12288
    buffer_load_dwordx4 v[228:231], v2, s[8:11], s55 offen offset:0 sc1
    v_mfma_f32_32x32x16_bf16 v[64:79], a[184:187], v[156:159], v[64:79]
    v_mfma_f32_32x32x16_bf16 v[80:95], a[188:191], v[156:159], v[80:95]
    buffer_load_dwordx4 v[232:235], v2, s[8:11], s54 offen offset:1024 sc1
    s_waitcnt vmcnt(19)
    v_mfma_f32_32x32x16_bf16 v[32:47], a[192:195], v[160:163], v[32:47]
    v_mfma_f32_32x32x16_bf16 v[48:63], a[196:199], v[160:163], v[48:63]
    buffer_load_dwordx4 v[236:239], v2, s[8:11], s55 offen offset:1024 sc1
    v_mfma_f32_32x32x16_bf16 v[64:79], a[192:195], v[164:167], v[64:79]
    v_mfma_f32_32x32x16_bf16 v[80:95], a[196:199], v[164:167], v[80:95]
    buffer_load_dwordx4 v[240:243], v2, s[8:11], s54 offen offset:2048 sc1
    s_waitcnt vmcnt(19)
    v_mfma_f32_32x32x16_bf16 v[32:47], a[200:203], v[168:171], v[32:47]
    v_mfma_f32_32x32x16_bf16 v[48:63], a[204:207], v[168:171], v[48:63]
    buffer_load_dwordx4 v[244:247], v2, s[8:11], s55 offen offset:2048 sc1
    v_mfma_f32_32x32x16_bf16 v[64:79], a[200:203], v[172:175], v[64:79]
    v_mfma_f32_32x32x16_bf16 v[80:95], a[204:207], v[172:175], v[80:95]
    buffer_load_dwordx4 v[248:251], v2, s[8:11], s54 offen offset:3072 sc1
    s_waitcnt vmcnt(19)
    v_mfma_f32_32x32x16_bf16 v[32:47], a[208:211], v[176:179], v[32:47]
    v_mfma_f32_32x32x16_bf16 v[48:63], a[212:215], v[176:179], v[48:63]
    buffer_load_dwordx4 v[252:255], v2, s[8:11], s55 offen offset:3072 sc1
    v_mfma_f32_32x32x16_bf16 v[64:79], a[208:211], v[180:183], v[64:79]
    v_mfma_f32_32x32x16_bf16 v[80:95], a[212:215], v[180:183], v[80:95]
    s_add_u32 s54, s100, 16384
    buffer_load_dwordx4 v[128:131], v2, s[8:11], s54 offen offset:0 sc1
    s_waitcnt vmcnt(19)
    v_mfma_f32_32x32x16_bf16 v[32:47], a[216:219], v[184:187], v[32:47]
    v_mfma_f32_32x32x16_bf16 v[48:63], a[220:223], v[184:187], v[48:63]
    s_add_u32 s55, s101, 16384
    buffer_load_dwordx4 v[132:135], v2, s[8:11], s55 offen offset:0 sc1
    v_mfma_f32_32x32x16_bf16 v[64:79], a[216:219], v[188:191], v[64:79]
    v_mfma_f32_32x32x16_bf16 v[80:95], a[220:223], v[188:191], v[80:95]
    buffer_load_dwordx4 v[136:139], v2, s[8:11], s54 offen offset:1024 sc1
    s_waitcnt vmcnt(19)
    v_mfma_f32_32x32x16_bf16 v[32:47], a[128:131], v[192:195], v[32:47]
    v_mfma_f32_32x32x16_bf16 v[48:63], a[132:135], v[192:195], v[48:63]
    buffer_load_dwordx4 v[140:143], v2, s[8:11], s55 offen offset:1024 sc1
    v_mfma_f32_32x32x16_bf16 v[64:79], a[128:131], v[196:199], v[64:79]
    v_mfma_f32_32x32x16_bf16 v[80:95], a[132:135], v[196:199], v[80:95]
    buffer_load_dwordx4 v[144:147], v2, s[8:11], s54 offen offset:2048 sc1
    s_waitcnt vmcnt(18)
    v_mfma_f32_32x32x16_bf16 v[32:47], a[136:139], v[200:203], v[32:47]
    v_mfma_f32_32x32x16_bf16 v[48:63], a[140:143], v[200:203], v[48:63]
    buffer_load_dwordx4 v[148:151], v2, s[8:11], s55 offen offset:2048 sc1
    v_mfma_f32_32x32x16_bf16 v[64:79], a[136:139], v[204:207], v[64:79]
    v_mfma_f32_32x32x16_bf16 v[80:95], a[140:143], v[204:207], v[80:95]
    buffer_load_dwordx4 v[152:155], v2, s[8:11], s54 offen offset:3072 sc1
    s_waitcnt vmcnt(18)
    v_mfma_f32_32x32x16_bf16 v[32:47], a[144:147], v[208:211], v[32:47]
    s_waitcnt vmcnt(7)
    v_max3_u32 v12, v224, v225, v226
    v_max3_u32 v13, v227, v228, v229
    v_mfma_f32_32x32x16_bf16 v[48:63], a[148:151], v[208:211], v[48:63]
    v_max3_u32 v12, v12, v230, v231
    v_max3_u32 v13, v13, v232, v233
    v_max3_u32 v12, v12, v234, v235
    buffer_load_dwordx4 v[156:159], v2, s[8:11], s55 offen offset:3072 sc1
    v_mfma_f32_32x32x16_bf16 v[64:79], a[144:147], v[212:215], v[64:79]
    v_max3_u32 v13, v13, v236, v237
    v_max3_u32 v12, v12, v238, v239
    v_max3_u32 v13, v13, v240, v241
    v_mfma_f32_32x32x16_bf16 v[80:95], a[148:151], v[212:215], v[80:95]
    v_max3_u32 v12, v12, v242, v243
    v_max3_u32 v13, v13, v244, v245
    v_max3_u32 v12, v12, v246, v247
    s_add_u32 s54, s100, 20480
    buffer_load_dwordx4 v[160:163], v2, s[8:11], s54 offen offset:0 sc1
    s_waitcnt vmcnt(18)
    v_mfma_f32_32x32x16_bf16 v[32:47], a[152:155], v[216:219], v[32:47]
    v_max3_u32 v13, v13, v248, v249
    v_max3_u32 v12, v12, v250, v251
    v_max3_u32 v13, v13, v252, v253
    v_mfma_f32_32x32x16_bf16 v[48:63], a[156:159], v[216:219], v[48:63]
    v_max3_u32 v12, v12, v254, v255
    v_max3_u32 v12, v12, v13, v13
    v_cmp_eq_u32 vcc, -1, v12
    s_cbranch_vccnz L_vsp_67
L_vok_66:
    s_add_u32 s55, s101, 20480
    buffer_load_dwordx4 v[164:167], v2, s[8:11], s55 offen offset:0 sc1
    v_mfma_f32_32x32x16_bf16 v[64:79], a[152:155], v[220:223], v[64:79]
    v_mfma_f32_32x32x16_bf16 v[80:95], a[156:159], v[220:223], v[80:95]
    buffer_load_dwordx4 v[168:171], v2, s[8:11], s54 offen offset:1024 sc1
    s_waitcnt vmcnt(17)
    v_mfma_f32_32x32x16_bf16 v[32:47], a[0:3], v[224:227], v[32:47]
    v_mfma_f32_32x32x16_bf16 v[48:63], a[4:7], v[224:227], v[48:63]
    buffer_load_dwordx4 v[172:175], v2, s[8:11], s55 offen offset:1024 sc1
    v_mfma_f32_32x32x16_bf16 v[64:79], a[0:3], v[228:231], v[64:79]
    v_mfma_f32_32x32x16_bf16 v[80:95], a[4:7], v[228:231], v[80:95]
    buffer_load_dwordx4 v[176:179], v2, s[8:11], s54 offen offset:2048 sc1
    s_waitcnt vmcnt(17)
    v_mfma_f32_32x32x16_bf16 v[32:47], a[8:11], v[232:235], v[32:47]
    v_mfma_f32_32x32x16_bf16 v[48:63], a[12:15], v[232:235], v[48:63]
    buffer_load_dwordx4 v[180:183], v2, s[8:11], s55 offen offset:2048 sc1
    v_mfma_f32_32x32x16_bf16 v[64:79], a[8:11], v[236:239], v[64:79]
    v_mfma_f32_32x32x16_bf16 v[80:95], a[12:15], v[236:239], v[80:95]
    buffer_load_dwordx4 v[184:187], v2, s[8:11], s54 offen offset:3072 sc1
    s_waitcnt vmcnt(17)
    v_mfma_f32_32x32x16_bf16 v[32:47], a[16:19], v[240:243], v[32:47]
    s_waitcnt vmcnt(7)
    v_max3_u32 v12, v128, v129, v130
    v_max3_u32 v13, v131, v132, v133
    v_mfma_f32_32x32x16_bf16 v[48:63], a[20:23], v[240:243], v[48:63]
    v_max3_u32 v12, v12, v134, v135
    v_max3_u32 v13, v13, v136, v137
    v_max3_u32 v12, v12, v138, v139
    buffer_load_dwordx4 v[188:191], v2, s[8:11], s55 offen offset:3072 sc1
    v_mfma_f32_32x32x16_bf16 v[64:79], a[16:19], v[244:247], v[64:79]
    v_max3_u32 v13, v13, v140, v141
    v_max3_u32 v12, v12, v142, v143
    v_max3_u32 v13, v13, v144, v145
    v_mfma_f32_32x32x16_bf16 v[80:95], a[20:23], v[244:247], v[80:95]
    v_max3_u32 v12, v12, v146, v147
    v_max3_u32 v13, v13, v148, v149
    v_max3_u32 v12, v12, v150, v151
    s_add_u32 s54, s100, 24576
    buffer_load_dwordx4 v[192:195], v2, s[8:11], s54 offen offset:0 sc1
    s_waitcnt vmcnt(17)
    v_mfma_f32_32x32x16_bf16 v[32:47], a[24:27], v[248:251], v[32:47]
    v_max3_u32 v13, v13, v152, v153
    v_max3_u32 v12, v12, v154, v155
    v_max3_u32 v13, v13, v156, v157
    v_mfma_f32_32x32x16_bf16 v[48:63], a[28:31], v[248:251], v[48:63]
    v_max3_u32 v12, v12, v158, v159
    v_max3_u32 v12, v12, v13, v13
    v_cmp_eq_u32 vcc, -1, v12
    s_cbranch_vccnz L_vsp_69
L_vok_68:
    s_add_u32 s55, s101, 24576
    buffer_load_dwordx4 v[196:199], v2, s[8:11], s55 offen offset:0 sc1
    v_mfma_f32_32x32x16_bf16 v[64:79], a[24:27], v[252:255], v[64:79]
    v_mfma_f32_32x32x16_bf16 v[80:95], a[28:31], v[252:255], v[80:95]
    buffer_load_dwordx4 v[200:203], v2, s[8:11], s54 offen offset:1024 sc1
    s_waitcnt vmcnt(17)
    v_mfma_f32_32x32x16_bf16 v[32:47], a[32:35], v[128:131], v[32:47]
    v_mfma_f32_32x32x16_bf16 v[48:63], a[36:39], v[128:131], v[48:63]
    buffer_load_dwordx4 v[204:207], v2, s[8:11], s55 offen offset:1024 sc1
    v_mfma_f32_32x32x16_bf16 v[64:79], a[32:35], v[132:135], v[64:79]
    v_mfma_f32_32x32x16_bf16 v[80:95], a[36:39], v[132:135], v[80:95]
    buffer_load_dwordx4 v[208:211], v2, s[8:11], s54 offen offset:2048 sc1
    s_waitcnt vmcnt(17)
    v_mfma_f32_32x32x16_bf16 v[32:47], a[40:43], v[136:139], v[32:47]
    v_mfma_f32_32x32x16_bf16 v[48:63], a[44:47], v[136:139], v[48:63]
    buffer_load_dwordx4 v[212:215], v2, s[8:11], s55 offen offset:2048 sc1
    v_mfma_f32_32x32x16_bf16 v[64:79], a[40:43], v[140:143], v[64:79]
    v_mfma_f32_32x32x16_bf16 v[80:95], a[44:47], v[140:143], v[80:95]
    buffer_load_dwordx4 v[216:219], v2, s[8:11], s54 offen offset:3072 sc1
    s_waitcnt vmcnt(17)
    v_mfma_f32_32x32x16_bf16 v[32:47], a[48:51], v[144:147], v[32:47]
    s_waitcnt vmcnt(7)
    v_max3_u32 v12, v160, v161, v162
    v_max3_u32 v13, v163, v164, v165
    v_mfma_f32_32x32x16_bf16 v[48:63], a[52:55], v[144:147], v[48:63]
    v_max3_u32 v12, v12, v166, v167
    v_max3_u32 v13, v13, v168, v169
    v_max3_u32 v12, v12, v170, v171
    buffer_load_dwordx4 v[220:223], v2, s[8:11], s55 offen offset:3072 sc1
    v_mfma_f32_32x32x16_bf16 v[64:79], a[48:51], v[148:151], v[64:79]
    v_max3_u32 v13, v13, v172, v173
    v_max3_u32 v12, v12, v174, v175
    v_max3_u32 v13, v13, v176, v177
    v_mfma_f32_32x32x16_bf16 v[80:95], a[52:55], v[148:151], v[80:95]
    v_max3_u32 v12, v12, v178, v179
    v_max3_u32 v13, v13, v180, v181
    v_max3_u32 v12, v12, v182, v183
    s_waitcnt vmcnt(16)
    v_mfma_f32_32x32x16_bf16 v[32:47], a[56:59], v[152:155], v[32:47]
    v_max3_u32 v13, v13, v184, v185
    v_max3_u32 v12, v12, v186, v187
    v_max3_u32 v13, v13, v188, v189
    v_mfma_f32_32x32x16_bf16 v[48:63], a[60:63], v[152:155], v[48:63]
    v_max3_u32 v12, v12, v190, v191
    v_max3_u32 v12, v12, v13, v13
    v_cmp_eq_u32 vcc, -1, v12
    s_cbranch_vccnz L_vsp_71
L_vok_70:
    v_mfma_f32_32x32x16_bf16 v[64:79], a[56:59], v[156:159], v[64:79]
    v_mfma_f32_32x32x16_bf16 v[80:95], a[60:63], v[156:159], v[80:95]
    s_waitcnt vmcnt(14)
    v_mfma_f32_32x32x16_bf16 v[32:47], a[64:67], v[160:163], v[32:47]
    v_mfma_f32_32x32x16_bf16 v[48:63], a[68:71], v[160:163], v[48:63]
    v_mfma_f32_32x32x16_bf16 v[64:79], a[64:67], v[164:167], v[64:79]
    v_mfma_f32_32x32x16_bf16 v[80:95], a[68:71], v[164:167], v[80:95]
    s_waitcnt vmcnt(12)
    v_mfma_f32_32x32x16_bf16 v[32:47], a[72:75], v[168:171], v[32:47]
    v_mfma_f32_32x32x16_bf16 v[48:63], a[76:79], v[168:171], v[48:63]
    v_mfma_f32_32x32x16_bf16 v[64:79], a[72:75], v[172:175], v[64:79]
    v_mfma_f32_32x32x16_bf16 v[80:95], a[76:79], v[172:175], v[80:95]
    s_waitcnt vmcnt(10)
    v_mfma_f32_32x32x16_bf16 v[32:47], a[80:83], v[176:179], v[32:47]
    s_waitcnt vmcnt(0)
    v_max3_u32 v12, v192, v193, v194
    v_max3_u32 v13, v195, v196, v197
    v_mfma_f32_32x32x16_bf16 v[48:63], a[84:87], v[176:179], v[48:63]
    v_max3_u32 v12, v12, v198, v199
    v_max3_u32 v13, v13, v200, v201
    v_max3_u32 v12, v12, v202, v203
    v_mfma_f32_32x32x16_bf16 v[64:79], a[80:83], v[180:183], v[64:79]
    v_max3_u32 v13, v13, v204, v205
    v_max3_u32 v12, v12, v206, v207
    v_max3_u32 v13, v13, v208, v209
    v_mfma_f32_32x32x16_bf16 v[80:95], a[84:87], v[180:183], v[80:95]
    v_max3_u32 v12, v12, v210, v211
    v_max3_u32 v13, v13, v212, v213
    v_max3_u32 v12, v12, v214, v215
    s_waitcnt vmcnt(8)
    v_mfma_f32_32x32x16_bf16 v[32:47], a[88:91], v[184:187], v[32:47]
    v_max3_u32 v13, v13, v216, v217
    v_max3_u32 v12, v12, v218, v219
    v_max3_u32 v13, v13, v220, v221
    v_mfma_f32_32x32x16_bf16 v[48:63], a[92:95], v[184:187], v[48:63]
    v_max3_u32 v12, v12, v222, v223
    v_max3_u32 v12, v12, v13, v13
    v_cmp_eq_u32 vcc, -1, v12
    s_cbranch_vccnz L_vsp_73
L_vok_72:
    v_mfma_f32_32x32x16_bf16 v[64:79], a[88:91], v[188:191], v[64:79]
    v_mfma_f32_32x32x16_bf16 v[80:95], a[92:95], v[188:191], v[80:95]
    s_waitcnt vmcnt(6)
    s_waitcnt vmcnt(4)
    s_waitcnt vmcnt(2)
    s_waitcnt vmcnt(0)
    s_xor_b32 s57, s88, 1
    s_mul_i32 s57, s57, 12288
    v_add_u32 v9, s57, v3
    s_xor_b32 s57, s88, 2
    s_mul_i32 s57, s57, 12288
    v_add_u32 v10, s57, v3
    s_xor_b32 s57, s88, 3
    s_mul_i32 s57, s57, 12288
    v_add_u32 v11, s57, v3
    v_mfma_f32_32x32x16_bf16 v[80:95], a[100:103], v[196:199], v[80:95]
    v_mfma_f32_32x32x16_bf16 v[80:95], a[108:111], v[204:207], v[80:95]
    v_mfma_f32_32x32x16_bf16 v[80:95], a[116:119], v[212:215], v[80:95]
    v_mfma_f32_32x32x16_bf16 v[80:95], a[124:127], v[220:223], v[80:95]
    v_mfma_f32_32x32x16_bf16 v[64:79], a[96:99], v[196:199], v[64:79]
    v_mfma_f32_32x32x16_bf16 v[64:79], a[104:107], v[204:207], v[64:79]
    v_mfma_f32_32x32x16_bf16 v[64:79], a[112:115], v[212:215], v[64:79]
    s_nop 8
    ds_write_b128 v11, v[80:83] offset:8192
    ds_write_b128 v11, v[84:87] offset:9216
    v_mfma_f32_32x32x16_bf16 v[64:79], a[120:123], v[220:223], v[64:79]
    ds_write_b128 v11, v[88:91] offset:10240
    ds_write_b128 v11, v[92:95] offset:11264
    v_mfma_f32_32x32x16_bf16 v[48:63], a[100:103], v[192:195], v[48:63]
    s_nop 8
    ds_write_b128 v10, v[64:67] offset:4096
    ds_write_b128 v10, v[68:71] offset:5120
    v_mfma_f32_32x32x16_bf16 v[48:63], a[108:111], v[200:203], v[48:63]
    ds_write_b128 v10, v[72:75] offset:6144
    ds_write_b128 v10, v[76:79] offset:7168
    v_mfma_f32_32x32x16_bf16 v[48:63], a[116:119], v[208:211], v[48:63]
    v_mfma_f32_32x32x16_bf16 v[48:63], a[124:127], v[216:219], v[48:63]
    v_mfma_f32_32x32x16_bf16 v[32:47], a[96:99], v[192:195], v[32:47]
    s_nop 10
    ds_write_b128 v9, v[48:51] offset:0
    v_mfma_f32_32x32x16_bf16 v[32:47], a[104:107], v[200:203], v[32:47]
    ds_write_b128 v9, v[52:55] offset:1024
    v_mfma_f32_32x32x16_bf16 v[32:47], a[112:115], v[208:211], v[32:47]
    ds_write_b128 v9, v[56:59] offset:2048
    v_mfma_f32_32x32x16_bf16 v[32:47], a[120:123], v[216:219], v[32:47]
    ds_write_b128 v9, v[60:63] offset:3072
    s_mul_i32 s57, s88, 12288
    v_add_u32 v8, s57, v3
    v_lshlrev_b32 v176, 16, v96
    v_and_b32 v177, 0xffff0000, v96
    v_lshlrev_b32 v178, 16, v97
    v_and_b32 v179, 0xffff0000, v97
    v_lshlrev_b32 v180, 16, v98
    v_and_b32 v181, 0xffff0000, v98
    v_lshlrev_b32 v182, 16, v99
    v_and_b32 v183, 0xffff0000, v99
    v_lshlrev_b32 v184, 16, v100
    v_and_b32 v185, 0xffff0000, v100
    v_lshlrev_b32 v186, 16, v101
    v_and_b32 v187, 0xffff0000, v101
    v_lshlrev_b32 v188, 16, v102
    v_and_b32 v189, 0xffff0000, v102
    v_lshlrev_b32 v190, 16, v103
    v_and_b32 v191, 0xffff0000, v103
    s_waitcnt lgkmcnt(0)
    s_barrier
    ds_read_b128 v[128:131], v8 offset:0
    ds_read_b128 v[132:135], v8 offset:1024
    ds_read_b128 v[136:139], v8 offset:2048
    ds_read_b128 v[140:143], v8 offset:3072
    ds_read_b128 v[144:147], v8 offset:4096
    ds_read_b128 v[148:151], v8 offset:5120
    ds_read_b128 v[152:155], v8 offset:6144
    ds_read_b128 v[156:159], v8 offset:7168
    ds_read_b128 v[160:163], v8 offset:8192
    ds_read_b128 v[164:167], v8 offset:9216
    ds_read_b128 v[168:171], v8 offset:10240
    ds_read_b128 v[172:175], v8 offset:11264
    v_pk_add_f32 v[32:33], v[32:33], v[176:177]
    v_pk_add_f32 v[34:35], v[34:35], v[178:179]
    v_pk_add_f32 v[36:37], v[36:37], v[180:181]
    v_pk_add_f32 v[38:39], v[38:39], v[182:183]
    v_pk_add_f32 v[40:41], v[40:41], v[184:185]
    v_pk_add_f32 v[42:43], v[42:43], v[186:187]
    v_pk_add_f32 v[44:45], v[44:45], v[188:189]
    v_pk_add_f32 v[46:47], v[46:47], v[190:191]
    s_waitcnt lgkmcnt(8)
    v_pk_add_f32 v[32:33], v[32:33], v[128:129]
    v_pk_add_f32 v[34:35], v[34:35], v[130:131]
    v_pk_add_f32 v[36:37], v[36:37], v[132:133]
    v_pk_add_f32 v[38:39], v[38:39], v[134:135]
    v_pk_add_f32 v[40:41], v[40:41], v[136:137]
    v_pk_add_f32 v[42:43], v[42:43], v[138:139]
    v_pk_add_f32 v[44:45], v[44:45], v[140:141]
    v_pk_add_f32 v[46:47], v[46:47], v[142:143]
    s_waitcnt lgkmcnt(4)
    v_pk_add_f32 v[32:33], v[32:33], v[144:145]
    v_pk_add_f32 v[34:35], v[34:35], v[146:147]
    v_pk_add_f32 v[36:37], v[36:37], v[148:149]
    v_pk_add_f32 v[38:39], v[38:39], v[150:151]
    v_pk_add_f32 v[40:41], v[40:41], v[152:153]
    v_pk_add_f32 v[42:43], v[42:43], v[154:155]
    v_pk_add_f32 v[44:45], v[44:45], v[156:157]
    v_pk_add_f32 v[46:47], v[46:47], v[158:159]
    s_waitcnt lgkmcnt(0)
    v_pk_add_f32 v[32:33], v[32:33], v[160:161]
    v_pk_add_f32 v[34:35], v[34:35], v[162:163]
    v_pk_add_f32 v[36:37], v[36:37], v[164:165]
    v_pk_add_f32 v[38:39], v[38:39], v[166:167]
    v_pk_add_f32 v[40:41], v[40:41], v[168:169]
    v_pk_add_f32 v[42:43], v[42:43], v[170:171]
    v_pk_add_f32 v[44:45], v[44:45], v[172:173]
    v_pk_add_f32 v[46:47], v[46:47], v[174:175]
    v_cvt_pk_bf16_f32 v128, v32, v33
    v_cvt_pk_bf16_f32 v129, v34, v35
    v_cvt_pk_bf16_f32 v130, v36, v37
    v_cvt_pk_bf16_f32 v131, v38, v39
    v_cvt_pk_bf16_f32 v132, v40, v41
    v_cvt_pk_bf16_f32 v133, v42, v43
    v_cvt_pk_bf16_f32 v134, v44, v45
    v_cvt_pk_bf16_f32 v135, v46, v47
    v_and_b32 v9, 31, v1
    s_lshl_b32 s57, s39, 5
    v_add_u32 v9, s57, v9
    v_mul_u32_u24 v9, 144, v9
    v_lshrrev_b32 v10, 5, v1
    v_lshl_add_u32 v9, v10, 4, v9
    s_lshl_b32 s57, s41, 6
    v_add_u32 v9, s57, v9
    ds_write_b128 v9, v[128:131]
    ds_write_b128 v9, v[132:135] offset:32
    v_lshrrev_b32 v10, 3, v1
    s_lshl_b32 s57, s88, 4
    v_add_u32 v10, s57, v10
    v_and_b32 v11, 7, v1
    v_mul_u32_u24 v9, 144, v10
    v_lshl_add_u32 v9, v11, 4, v9
    v_and_b32 v10, 31, v10
    v_lshlrev_b32 v10, 6, v10
    s_lshl_b32 s57, s39, 5
    s_add_u32 s57, s57, s24
    s_add_u32 s57, s57, 2032
    v_add_u32 v10, s57, v10
    v_add_u32 v12, 512, v10
    v_and_b32 v10, 2047, v10
    v_and_b32 v12, 2047, v12
    v_lshlrev_b32 v10, 10, v10
    v_lshlrev_b32 v12, 10, v12
    v_lshl_add_u32 v10, v11, 4, v10
    v_lshl_add_u32 v12, v11, 4, v12
    s_lshl_b32 s58, s22, 7
    s_mov_b32 s18, 0x200000
    s_mov_b32 s19, 0x20000
    s_waitcnt lgkmcnt(0)
    s_barrier
    ds_read_b128 v[128:131], v9
    ds_read_b128 v[132:135], v9 offset:1152
    s_waitcnt lgkmcnt(1)
    buffer_store_dwordx4 v[128:131], v10, s[16:19], s58 offen nt
    s_waitcnt lgkmcnt(0)
    buffer_store_dwordx4 v[132:135], v12, s[16:19], s58 offen nt
    s_endpgm
L_tagsp_7:
    s_mov_b32 s6, 0x10000
    v_mov_b32 v160, 0
L_tagsp_7_l:
    global_load_dwordx2 v[220:221], v160, s[4:5] sc1
    s_waitcnt vmcnt(0)
    v_readfirstlane_b32 s18, v220
    v_readfirstlane_b32 s19, v221
    s_sub_u32 s6, s6, 1
    s_cmp_eq_u32 s6, 0
    s_cbranch_scc1 L_tag_6
    s_cmp_eq_u32 s18, 0
    s_cbranch_scc1 L_tagsp_7_l
    s_branch L_tag_6
L_spin_9:
    s_mov_b32 s6, 0x10000
L_spin_9_l:
    buffer_load_dwordx2 v[216:217], v210, s[8:11], s3 offen sc1
    s_sub_u32 s6, s6, 1
    s_cmp_eq_u32 s6, 0
    s_cbranch_scc1 L_ok_8
    s_waitcnt vmcnt(0)
    v_cmp_eq_u64 vcc, s[18:19], v[216:217]
    s_cmp_eq_u64 vcc, -1
    s_cbranch_scc0 L_spin_9_l
    s_branch L_ok_8
L_vsp_11:
    s_mov_b32 s6, 0x8000
L_vsp_11_l:
    s_add_u32 m0, s5, 131072
    s_add_u32 s3, s4, 0
    buffer_load_dwordx4 v207, s[8:11], s3 offen sc1 lds
    s_add_u32 m0, s5, 132096
    s_add_u32 s3, s4, 2048
    buffer_load_dwordx4 v207, s[8:11], s3 offen sc1 lds
    s_add_u32 m0, s5, 133120
    s_add_u32 s3, s4, 4096
    buffer_load_dwordx4 v207, s[8:11], s3 offen sc1 lds
    s_add_u32 m0, s5, 134144
    s_add_u32 s3, s4, 6144
    buffer_load_dwordx4 v207, s[8:11], s3 offen sc1 lds
    s_add_u32 m0, s5, 135168
    s_add_u32 s3, s4, 8192
    buffer_load_dwordx4 v207, s[8:11], s3 offen sc1 lds
    s_add_u32 m0, s5, 136192
    s_add_u32 s3, s4, 10240
    buffer_load_dwordx4 v207, s[8:11], s3 offen sc1 lds
    s_add_u32 m0, s5, 137216
    s_add_u32 s3, s4, 12288
    buffer_load_dwordx4 v207, s[8:11], s3 offen sc1 lds
    s_add_u32 m0, s5, 138240
    s_add_u32 s3, s4, 14336
    buffer_load_dwordx4 v207, s[8:11], s3 offen sc1 lds
    s_waitcnt vmcnt(0)
    ds_read_b128 v[16:19], v210 offset:0
    ds_read_b128 v[20:23], v210 offset:1024
    ds_read_b128 v[24:27], v210 offset:2048
    ds_read_b128 v[28:31], v210 offset:3072
    ds_read_b128 v[32:35], v210 offset:4096
    ds_read_b128 v[36:39], v210 offset:5120
    ds_read_b128 v[40:43], v210 offset:6144
    ds_read_b128 v[44:47], v210 offset:7168
    s_waitcnt lgkmcnt(0)
    s_sub_u32 s6, s6, 1
    s_cmp_eq_u32 s6, 0
    s_cbranch_scc1 L_vok_10
    v_max3_u32 v104, v16, v17, v18
    v_max3_u32 v105, v19, v20, v21
    v_max3_u32 v104, v104, v22, v23
    v_max3_u32 v105, v105, v24, v25
    v_max3_u32 v104, v104, v26, v27
    v_max3_u32 v105, v105, v28, v29
    v_max3_u32 v104, v104, v30, v31
    v_max3_u32 v105, v105, v32, v33
    v_max3_u32 v104, v104, v34, v35
    v_max3_u32 v105, v105, v36, v37
    v_max3_u32 v104, v104, v38, v39
    v_max3_u32 v105, v105, v40, v41
    v_max3_u32 v104, v104, v42, v43
    v_max3_u32 v105, v105, v44, v45
    v_max3_u32 v104, v104, v46, v47
    v_max3_u32 v104, v104, v105, v105
    v_cmp_eq_u32 vcc, -1, v104
    s_cbranch_vccnz L_vsp_11_l
    s_branch L_vok_10
L_vsp_13:
    s_mov_b32 s6, 0x8000
L_vsp_13_l:
    s_add_u32 s53, s42, 0
    buffer_load_dwordx4 v[128:131], v2, s[8:11], s53 offen offset:0 sc1
    buffer_load_dwordx4 v[132:135], v2, s[8:11], s53 offen offset:1024 sc1
    buffer_load_dwordx4 v[136:139], v2, s[8:11], s53 offen offset:2048 sc1
    buffer_load_dwordx4 v[140:143], v2, s[8:11], s53 offen offset:3072 sc1
    s_waitcnt vmcnt(0)
    s_sub_u32 s6, s6, 1
    s_cmp_eq_u32 s6, 0
    s_cbranch_scc1 L_vok_12
    v_max3_u32 v12, v128, v129, v130
    v_max3_u32 v13, v131, v132, v133
    v_max3_u32 v12, v12, v134, v135
    v_max3_u32 v13, v13, v136, v137
    v_max3_u32 v12, v12, v138, v139
    v_max3_u32 v13, v13, v140, v141
    v_max3_u32 v12, v12, v142, v143
    v_max3_u32 v12, v12, v13, v13
    v_cmp_eq_u32 vcc, -1, v12
    s_cbranch_vccnz L_vsp_13_l
    s_branch L_vok_12
L_vsp_15:
    s_mov_b32 s6, 0x8000
L_vsp_15_l:
    s_add_u32 s53, s42, 4096
    buffer_load_dwordx4 v[144:147], v2, s[8:11], s53 offen offset:0 sc1
    buffer_load_dwordx4 v[148:151], v2, s[8:11], s53 offen offset:1024 sc1
    buffer_load_dwordx4 v[152:155], v2, s[8:11], s53 offen offset:2048 sc1
    buffer_load_dwordx4 v[156:159], v2, s[8:11], s53 offen offset:3072 sc1
    s_waitcnt vmcnt(0)
    s_sub_u32 s6, s6, 1
    s_cmp_eq_u32 s6, 0
    s_cbranch_scc1 L_vok_14
    v_max3_u32 v12, v144, v145, v146
    v_max3_u32 v13, v147, v148, v149
    v_max3_u32 v12, v12, v150, v151
    v_max3_u32 v13, v13, v152, v153
    v_max3_u32 v12, v12, v154, v155
    v_max3_u32 v13, v13, v156, v157
    v_max3_u32 v12, v12, v158, v159
    v_max3_u32 v12, v12, v13, v13
    v_cmp_eq_u32 vcc, -1, v12
    s_cbranch_vccnz L_vsp_15_l
    s_branch L_vok_14
L_vsp_17:
    s_mov_b32 s6, 0x8000
L_vsp_17_l:
    s_add_u32 s53, s42, 8192
    buffer_load_dwordx4 v[160:163], v2, s[8:11], s53 offen offset:0 sc1
    buffer_load_dwordx4 v[164:167], v2, s[8:11], s53 offen offset:1024 sc1
    buffer_load_dwordx4 v[168:171], v2, s[8:11], s53 offen offset:2048 sc1
    buffer_load_dwordx4 v[172:175], v2, s[8:11], s53 offen offset:3072 sc1
    s_waitcnt vmcnt(0)
    s_sub_u32 s6, s6, 1
    s_cmp_eq_u32 s6, 0
    s_cbranch_scc1 L_vok_16
    v_max3_u32 v12, v160, v161, v162
    v_max3_u32 v13, v163, v164, v165
    v_max3_u32 v12, v12, v166, v167
    v_max3_u32 v13, v13, v168, v169
    v_max3_u32 v12, v12, v170, v171
    v_max3_u32 v13, v13, v172, v173
    v_max3_u32 v12, v12, v174, v175
    v_max3_u32 v12, v12, v13, v13
    v_cmp_eq_u32 vcc, -1, v12
    s_cbranch_vccnz L_vsp_17_l
    s_branch L_vok_16
L_vsp_19:
    s_mov_b32 s6, 0x8000
L_vsp_19_l:
    s_add_u32 s53, s42, 12288
    buffer_load_dwordx4 v[176:179], v2, s[8:11], s53 offen offset:0 sc1
    buffer_load_dwordx4 v[180:183], v2, s[8:11], s53 offen offset:1024 sc1
    buffer_load_dwordx4 v[184:187], v2, s[8:11], s53 offen offset:2048 sc1
    buffer_load_dwordx4 v[188:191], v2, s[8:11], s53 offen offset:3072 sc1
    s_waitcnt vmcnt(0)
    s_sub_u32 s6, s6, 1
    s_cmp_eq_u32 s6, 0
    s_cbranch_scc1 L_vok_18
    v_max3_u32 v12, v176, v177, v178
    v_max3_u32 v13, v179, v180, v181
    v_max3_u32 v12, v12, v182, v183
    v_max3_u32 v13, v13, v184, v185
    v_max3_u32 v12, v12, v186, v187
    v_max3_u32 v13, v13, v188, v189
    v_max3_u32 v12, v12, v190, v191
    v_max3_u32 v12, v12, v13, v13
    v_cmp_eq_u32 vcc, -1, v12
    s_cbranch_vccnz L_vsp_19_l
    s_branch L_vok_18
L_vsp_21:
    s_mov_b32 s6, 0x8000
L_vsp_21_l:
    s_add_u32 s53, s42, 16384
    buffer_load_dwordx4 v[192:195], v2, s[8:11], s53 offen offset:0 sc1
    buffer_load_dwordx4 v[196:199], v2, s[8:11], s53 offen offset:1024 sc1
    buffer_load_dwordx4 v[200:203], v2, s[8:11], s53 offen offset:2048 sc1
    buffer_load_dwordx4 v[204:207], v2, s[8:11], s53 offen offset:3072 sc1
    s_waitcnt vmcnt(0)
    s_sub_u32 s6, s6, 1
    s_cmp_eq_u32 s6, 0
    s_cbranch_scc1 L_vok_20
    v_max3_u32 v12, v192, v193, v194
    v_max3_u32 v13, v195, v196, v197
    v_max3_u32 v12, v12, v198, v199
    v_max3_u32 v13, v13, v200, v201
    v_max3_u32 v12, v12, v202, v203
    v_max3_u32 v13, v13, v204, v205
    v_max3_u32 v12, v12, v206, v207
    v_max3_u32 v12, v12, v13, v13
    v_cmp_eq_u32 vcc, -1, v12
    s_cbranch_vccnz L_vsp_21_l
    s_branch L_vok_20
L_vsp_23:
    s_mov_b32 s6, 0x8000
L_vsp_23_l:
    buffer_load_dwordx4 v[48:51], v127, s[8:11], s50 offen offset:0 sc1
    buffer_load_dwordx4 v[52:55], v127, s[8:11], s50 offen offset:512 sc1
    buffer_load_dwordx4 v[56:59], v127, s[8:11], s50 offen offset:1024 sc1
    buffer_load_dwordx4 v[60:63], v127, s[8:11], s50 offen offset:1536 sc1
    s_waitcnt vmcnt(0)
    s_sub_u32 s6, s6, 1
    s_cmp_eq_u32 s6, 0
    s_cbranch_scc1 L_vok_22
    v_max3_u32 v14, v48, v49, v50
    v_max3_u32 v15, v51, v52, v53
    v_max3_u32 v14, v14, v54, v55
    v_max3_u32 v15, v15, v56, v57
    v_max3_u32 v14, v14, v58, v59
    v_max3_u32 v15, v15, v60, v61
    v_max3_u32 v14, v14, v62, v63
    v_max3_u32 v14, v14, v15, v15
    v_cmp_eq_u32 vcc, -1, v14
    s_cbranch_vccnz L_vsp_23_l
    s_branch L_vok_22
L_vsp_25:
    s_mov_b32 s6, 0x8000
L_vsp_25_l:
    s_add_u32 s53, s42, 20480
    buffer_load_dwordx4 v[208:211], v2, s[8:11], s53 offen offset:0 sc1
    buffer_load_dwordx4 v[212:215], v2, s[8:11], s53 offen offset:1024 sc1
    buffer_load_dwordx4 v[216:219], v2, s[8:11], s53 offen offset:2048 sc1
    buffer_load_dwordx4 v[220:223], v2, s[8:11], s53 offen offset:3072 sc1
    s_waitcnt vmcnt(0)
    s_sub_u32 s6, s6, 1
    s_cmp_eq_u32 s6, 0
    s_cbranch_scc1 L_vok_24
    v_max3_u32 v12, v208, v209, v210
    v_max3_u32 v13, v211, v212, v213
    v_max3_u32 v12, v12, v214, v215
    v_max3_u32 v13, v13, v216, v217
    v_max3_u32 v12, v12, v218, v219
    v_max3_u32 v13, v13, v220, v221
    v_max3_u32 v12, v12, v222, v223
    v_max3_u32 v12, v12, v13, v13
    v_cmp_eq_u32 vcc, -1, v12
    s_cbranch_vccnz L_vsp_25_l
    s_branch L_vok_24
L_vsp_27:
    s_mov_b32 s6, 0x8000
L_vsp_27_l:
    s_add_u32 s53, s42, 24576
    buffer_load_dwordx4 v[224:227], v2, s[8:11], s53 offen offset:0 sc1
    buffer_load_dwordx4 v[228:231], v2, s[8:11], s53 offen offset:1024 sc1
    buffer_load_dwordx4 v[232:235], v2, s[8:11], s53 offen offset:2048 sc1
    buffer_load_dwordx4 v[236:239], v2, s[8:11], s53 offen offset:3072 sc1
    s_waitcnt vmcnt(0)
    s_sub_u32 s6, s6, 1
    s_cmp_eq_u32 s6, 0
    s_cbranch_scc1 L_vok_26
    v_max3_u32 v12, v224, v225, v226
    v_max3_u32 v13, v227, v228, v229
    v_max3_u32 v12, v12, v230, v231
    v_max3_u32 v13, v13, v232, v233
    v_max3_u32 v12, v12, v234, v235
    v_max3_u32 v13, v13, v236, v237
    v_max3_u32 v12, v12, v238, v239
    v_max3_u32 v12, v12, v13, v13
    v_cmp_eq_u32 vcc, -1, v12
    s_cbranch_vccnz L_vsp_27_l
    s_branch L_vok_26
L_vsp_29:
    s_mov_b32 s6, 0x8000
L_vsp_29_l:
    s_add_u32 s53, s42, 28672
    buffer_load_dwordx4 v[240:243], v2, s[8:11], s53 offen offset:0 sc1
    buffer_load_dwordx4 v[244:247], v2, s[8:11], s53 offen offset:1024 sc1
    buffer_load_dwordx4 v[248:251], v2, s[8:11], s53 offen offset:2048 sc1
    buffer_load_dwordx4 v[252:255], v2, s[8:11], s53 offen offset:3072 sc1
    s_waitcnt vmcnt(0)
    s_sub_u32 s6, s6, 1
    s_cmp_eq_u32 s6, 0
    s_cbranch_scc1 L_vok_28
    v_max3_u32 v12, v240, v241, v242
    v_max3_u32 v13, v243, v244, v245
    v_max3_u32 v12, v12, v246, v247
    v_max3_u32 v13, v13, v248, v249
    v_max3_u32 v12, v12, v250, v251
    v_max3_u32 v13, v13, v252, v253
    v_max3_u32 v12, v12, v254, v255
    v_max3_u32 v12, v12, v13, v13
    v_cmp_eq_u32 vcc, -1, v12
    s_cbranch_vccnz L_vsp_29_l
    s_branch L_vok_28
L_spin_31:
    s_mov_b32 s6, 0x10000
L_spin_31_l:
    buffer_load_dwordx2 v[124:125], v6, s[8:11], s51 offen sc1
    s_sub_u32 s6, s6, 1
    s_cmp_eq_u32 s6, 0
    s_cbranch_scc1 L_ok_30
    s_waitcnt vmcnt(0)
    v_cmp_eq_u64 vcc, s[18:19], v[124:125]
    s_cmp_eq_u64 vcc, -1
    s_cbranch_scc0 L_spin_31_l
    s_branch L_ok_30
L_vsp_33:
    s_mov_b32 s6, 0x8000
L_vsp_33_l:
    s_add_u32 s53, s100, 12288
    buffer_load_dwordx4 v[224:227], v2, s[8:11], s53 offen sc1
    s_add_u32 s53, s101, 12288
    buffer_load_dwordx4 v[228:231], v2, s[8:11], s53 offen sc1
    s_add_u32 s53, s100, 13312
    buffer_load_dwordx4 v[232:235], v2, s[8:11], s53 offen sc1
    s_add_u32 s53, s101, 13312
    buffer_load_dwordx4 v[236:239], v2, s[8:11], s53 offen sc1
    s_add_u32 s53, s100, 14336
    buffer_load_dwordx4 v[240:243], v2, s[8:11], s53 offen sc1
    s_add_u32 s53, s101, 14336
    buffer_load_dwordx4 v[244:247], v2, s[8:11], s53 offen sc1
    s_add_u32 s53, s100, 15360
    buffer_load_dwordx4 v[248:251], v2, s[8:11], s53 offen sc1
    s_add_u32 s53, s101, 15360
    buffer_load_dwordx4 v[252:255], v2, s[8:11], s53 offen sc1
    s_waitcnt vmcnt(0)
    s_sub_u32 s6, s6, 1
    s_cmp_eq_u32 s6, 0
    s_cbranch_scc1 L_vok_32
    v_max3_u32 v12, v224, v225, v226
    v_max3_u32 v13, v227, v228, v229
    v_max3_u32 v12, v12, v230, v231
    v_max3_u32 v13, v13, v232, v233
    v_max3_u32 v12, v12, v234, v235
    v_max3_u32 v13, v13, v236, v237
    v_max3_u32 v12, v12, v238, v239
    v_max3_u32 v13, v13, v240, v241
    v_max3_u32 v12, v12, v242, v243
    v_max3_u32 v13, v13, v244, v245
    v_max3_u32 v12, v12, v246, v247
    v_max3_u32 v13, v13, v248, v249
    v_max3_u32 v12, v12, v250, v251
    v_max3_u32 v13, v13, v252, v253
    v_max3_u32 v12, v12, v254, v255
    v_max3_u32 v12, v12, v13, v13
    v_cmp_eq_u32 vcc, -1, v12
    s_cbranch_vccnz L_vsp_33_l
    s_branch L_vok_32
L_vsp_35:
    s_mov_b32 s6, 0x8000
L_vsp_35_l:
    s_add_u32 s53, s100, 16384
    buffer_load_dwordx4 v[128:131], v2, s[8:11], s53 offen sc1
    s_add_u32 s53, s101, 16384
    buffer_load_dwordx4 v[132:135], v2, s[8:11], s53 offen sc1
    s_add_u32 s53, s100, 17408
    buffer_load_dwordx4 v[136:139], v2, s[8:11], s53 offen sc1
    s_add_u32 s53, s101, 17408
    buffer_load_dwordx4 v[140:143], v2, s[8:11], s53 offen sc1
    s_add_u32 s53, s100, 18432
    buffer_load_dwordx4 v[144:147], v2, s[8:11], s53 offen sc1
    s_add_u32 s53, s101, 18432
    buffer_load_dwordx4 v[148:151], v2, s[8:11], s53 offen sc1
    s_add_u32 s53, s100, 19456
    buffer_load_dwordx4 v[152:155], v2, s[8:11], s53 offen sc1
    s_add_u32 s53, s101, 19456
    buffer_load_dwordx4 v[156:159], v2, s[8:11], s53 offen sc1
    s_waitcnt vmcnt(0)
    s_sub_u32 s6, s6, 1
    s_cmp_eq_u32 s6, 0
    s_cbranch_scc1 L_vok_34
    v_max3_u32 v12, v128, v129, v130
    v_max3_u32 v13, v131, v132, v133
    v_max3_u32 v12, v12, v134, v135
    v_max3_u32 v13, v13, v136, v137
    v_max3_u32 v12, v12, v138, v139
    v_max3_u32 v13, v13, v140, v141
    v_max3_u32 v12, v12, v142, v143
    v_max3_u32 v13, v13, v144, v145
    v_max3_u32 v12, v12, v146, v147
    v_max3_u32 v13, v13, v148, v149
    v_max3_u32 v12, v12, v150, v151
    v_max3_u32 v13, v13, v152, v153
    v_max3_u32 v12, v12, v154, v155
    v_max3_u32 v13, v13, v156, v157
    v_max3_u32 v12, v12, v158, v159
    v_max3_u32 v12, v12, v13, v13
    v_cmp_eq_u32 vcc, -1, v12
    s_cbranch_vccnz L_vsp_35_l
    s_branch L_vok_34
L_vsp_37:
    s_mov_b32 s6, 0x8000
L_vsp_37_l:
    s_add_u32 s53, s100, 20480
    buffer_load_dwordx4 v[160:163], v2, s[8:11], s53 offen sc1
    s_add_u32 s53, s101, 20480
    buffer_load_dwordx4 v[164:167], v2, s[8:11], s53 offen sc1
    s_add_u32 s53, s100, 21504
    buffer_load_dwordx4 v[168:171], v2, s[8:11], s53 offen sc1
    s_add_u32 s53, s101, 21504
    buffer_load_dwordx4 v[172:175], v2, s[8:11], s53 offen sc1
    s_add_u32 s53, s100, 22528
    buffer_load_dwordx4 v[176:179], v2, s[8:11], s53 offen sc1
    s_add_u32 s53, s101, 22528
    buffer_load_dwordx4 v[180:183], v2, s[8:11], s53 offen sc1
    s_add_u32 s53, s100, 23552
    buffer_load_dwordx4 v[184:187], v2, s[8:11], s53 offen sc1
    s_add_u32 s53, s101, 23552
    buffer_load_dwordx4 v[188:191], v2, s[8:11], s53 offen sc1
    s_waitcnt vmcnt(0)
    s_sub_u32 s6, s6, 1
    s_cmp_eq_u32 s6, 0
    s_cbranch_scc1 L_vok_36
    v_max3_u32 v12, v160, v161, v162
    v_max3_u32 v13, v163, v164, v165
    v_max3_u32 v12, v12, v166, v167
    v_max3_u32 v13, v13, v168, v169
    v_max3_u32 v12, v12, v170, v171
    v_max3_u32 v13, v13, v172, v173
    v_max3_u32 v12, v12, v174, v175
    v_max3_u32 v13, v13, v176, v177
    v_max3_u32 v12, v12, v178, v179
    v_max3_u32 v13, v13, v180, v181
    v_max3_u32 v12, v12, v182, v183
    v_max3_u32 v13, v13, v184, v185
    v_max3_u32 v12, v12, v186, v187
    v_max3_u32 v13, v13, v188, v189
    v_max3_u32 v12, v12, v190, v191
    v_max3_u32 v12, v12, v13, v13
    v_cmp_eq_u32 vcc, -1, v12
    s_cbranch_vccnz L_vsp_37_l
    s_branch L_vok_36
L_spin_39:
    s_mov_b32 s6, 0x10000
L_spin_39_l:
    buffer_load_dwordx2 v[124:125], v11, s[8:11], s3 offen sc1
    s_sub_u32 s6, s6, 1
    s_cmp_eq_u32 s6, 0
    s_cbranch_scc1 L_ok_38
    s_waitcnt vmcnt(0)
    v_cmp_eq_u64 vcc, s[18:19], v[124:125]
    s_cmp_eq_u64 vcc, -1
    s_cbranch_scc0 L_spin_39_l
    s_branch L_ok_38
L_vsp_41:
    s_mov_b32 s6, 0x8000
L_vsp_41_l:
    s_add_u32 s53, s100, 24576
    buffer_load_dwordx4 v[192:195], v2, s[8:11], s53 offen sc1
    s_add_u32 s53, s101, 24576
    buffer_load_dwordx4 v[196:199], v2, s[8:11], s53 offen sc1
    s_add_u32 s53, s100, 25600
    buffer_load_dwordx4 v[200:203], v2, s[8:11], s53 offen sc1
    s_add_u32 s53, s101, 25600
    buffer_load_dwordx4 v[204:207], v2, s[8:11], s53 offen sc1
    s_add_u32 s53, s100, 26624
    buffer_load_dwordx4 v[208:211], v2, s[8:11], s53 offen sc1
    s_add_u32 s53, s101, 26624
    buffer_load_dwordx4 v[212:215], v2, s[8:11], s53 offen sc1
    s_add_u32 s53, s100, 27648
    buffer_load_dwordx4 v[216:219], v2, s[8:11], s53 offen sc1
    s_add_u32 s53, s101, 27648
    buffer_load_dwordx4 v[220:223], v2, s[8:11], s53 offen sc1
    s_waitcnt vmcnt(0)
    s_sub_u32 s6, s6, 1
    s_cmp_eq_u32 s6, 0
    s_cbranch_scc1 L_vok_40
    v_max3_u32 v12, v192, v193, v194
    v_max3_u32 v13, v195, v196, v197
    v_max3_u32 v12, v12, v198, v199
    v_max3_u32 v13, v13, v200, v201
    v_max3_u32 v12, v12, v202, v203
    v_max3_u32 v13, v13, v204, v205
    v_max3_u32 v12, v12, v206, v207
    v_max3_u32 v13, v13, v208, v209
    v_max3_u32 v12, v12, v210, v211
    v_max3_u32 v13, v13, v212, v213
    v_max3_u32 v12, v12, v214, v215
    v_max3_u32 v13, v13, v216, v217
    v_max3_u32 v12, v12, v218, v219
    v_max3_u32 v13, v13, v220, v221
    v_max3_u32 v12, v12, v222, v223
    v_max3_u32 v12, v12, v13, v13
    v_cmp_eq_u32 vcc, -1, v12
    s_cbranch_vccnz L_vsp_41_l
    s_branch L_vok_40
L_vsp_43:
    s_mov_b32 s6, 0x8000
L_vsp_43_l:
    s_lshl_b32 s24, s20, 12
    s_add_u32 s24, s24, 0xe70000
    buffer_load_dwordx4 v[146:149], v5, s[8:11], s24 offen sc1
    s_add_u32 s24, s23, 0
    buffer_load_dwordx4 v[16:19], v5, s[8:11], s24 offen sc1
    s_add_u32 s24, s23, 4096
    buffer_load_dwordx4 v[20:23], v5, s[8:11], s24 offen sc1
    s_add_u32 s24, s23, 8192
    buffer_load_dwordx4 v[24:27], v5, s[8:11], s24 offen sc1
    s_add_u32 s24, s23, 12288
    buffer_load_dwordx4 v[28:31], v5, s[8:11], s24 offen sc1
    s_add_u32 s24, s23, 16384
    buffer_load_dwordx4 v[32:35], v5, s[8:11], s24 offen sc1
    s_add_u32 s24, s23, 20480
    buffer_load_dwordx4 v[36:39], v5, s[8:11], s24 offen sc1
    s_add_u32 s24, s23, 24576
    buffer_load_dwordx4 v[40:43], v5, s[8:11], s24 offen sc1
    s_add_u32 s24, s23, 28672
    buffer_load_dwordx4 v[44:47], v5, s[8:11], s24 offen sc1
    s_waitcnt vmcnt(0)
    s_sub_u32 s6, s6, 1
    s_cmp_eq_u32 s6, 0
    s_cbranch_scc1 L_vok_42
    v_max3_u32 v136, v16, v17, v18
    v_max3_u32 v137, v19, v20, v21
    v_max3_u32 v136, v136, v22, v23
    v_max3_u32 v137, v137, v24, v25
    v_max3_u32 v136, v136, v26, v27
    v_max3_u32 v137, v137, v28, v29
    v_max3_u32 v136, v136, v30, v31
    v_max3_u32 v137, v137, v32, v33
    v_max3_u32 v136, v136, v34, v35
    v_max3_u32 v137, v137, v36, v37
    v_max3_u32 v136, v136, v38, v39
    v_max3_u32 v137, v137, v40, v41
    v_max3_u32 v136, v136, v42, v43
    v_max3_u32 v137, v137, v44, v45
    v_max3_u32 v136, v136, v46, v47
    v_max3_u32 v137, v137, v146, v147
    v_max3_u32 v136, v136, v148, v149
    v_max3_u32 v136, v136, v137, v137
    v_cmp_eq_u32 vcc, -1, v136
    s_cbranch_vccnz L_vsp_43_l
    s_branch L_vok_42
L_vsp_45:
    s_mov_b32 s6, 0x8000
L_vsp_45_l:
    s_add_u32 m0, s5, 65536
    s_add_u32 s3, s4, 0
    buffer_load_dwordx4 v207, s[8:11], s3 offen sc1 lds
    s_add_u32 m0, s5, 66560
    s_add_u32 s3, s4, 2048
    buffer_load_dwordx4 v207, s[8:11], s3 offen sc1 lds
    s_add_u32 m0, s5, 67584
    s_add_u32 s3, s4, 4096
    buffer_load_dwordx4 v207, s[8:11], s3 offen sc1 lds
    s_add_u32 m0, s5, 68608
    s_add_u32 s3, s4, 6144
    buffer_load_dwordx4 v207, s[8:11], s3 offen sc1 lds
    s_add_u32 m0, s5, 69632
    s_add_u32 s3, s4, 8192
    buffer_load_dwordx4 v207, s[8:11], s3 offen sc1 lds
    s_add_u32 m0, s5, 70656
    s_add_u32 s3, s4, 10240
    buffer_load_dwordx4 v207, s[8:11], s3 offen sc1 lds
    s_add_u32 m0, s5, 71680
    s_add_u32 s3, s4, 12288
    buffer_load_dwordx4 v207, s[8:11], s3 offen sc1 lds
    s_add_u32 m0, s5, 72704
    s_add_u32 s3, s4, 14336
    buffer_load_dwordx4 v207, s[8:11], s3 offen sc1 lds
    s_waitcnt vmcnt(0)
    ds_read_b128 v[16:19], v210 offset:0
    ds_read_b128 v[20:23], v210 offset:1024
    ds_read_b128 v[24:27], v210 offset:2048
    ds_read_b128 v[28:31], v210 offset:3072
    ds_read_b128 v[32:35], v210 offset:4096
    ds_read_b128 v[36:39], v210 offset:5120
    ds_read_b128 v[40:43], v210 offset:6144
    ds_read_b128 v[44:47], v210 offset:7168
    s_waitcnt lgkmcnt(0)
    s_sub_u32 s6, s6, 1
    s_cmp_eq_u32 s6, 0
    s_cbranch_scc1 L_vok_44
    v_max3_u32 v104, v16, v17, v18
    v_max3_u32 v105, v19, v20, v21
    v_max3_u32 v104, v104, v22, v23
    v_max3_u32 v105, v105, v24, v25
    v_max3_u32 v104, v104, v26, v27
    v_max3_u32 v105, v105, v28, v29
    v_max3_u32 v104, v104, v30, v31
    v_max3_u32 v105, v105, v32, v33
    v_max3_u32 v104, v104, v34, v35
    v_max3_u32 v105, v105, v36, v37
    v_max3_u32 v104, v104, v38, v39
    v_max3_u32 v105, v105, v40, v41
    v_max3_u32 v104, v104, v42, v43
    v_max3_u32 v105, v105, v44, v45
    v_max3_u32 v104, v104, v46, v47
    v_max3_u32 v104, v104, v105, v105
    v_cmp_eq_u32 vcc, -1, v104
    s_cbranch_vccnz L_vsp_45_l
    s_branch L_vok_44
L_vsp_47:
    s_mov_b32 s6, 0x8000
L_vsp_47_l:
    s_add_u32 s53, s42, 0
    buffer_load_dwordx4 v[128:131], v2, s[8:11], s53 offen offset:0 sc1
    buffer_load_dwordx4 v[132:135], v2, s[8:11], s53 offen offset:1024 sc1
    buffer_load_dwordx4 v[136:139], v2, s[8:11], s53 offen offset:2048 sc1
    buffer_load_dwordx4 v[140:143], v2, s[8:11], s53 offen offset:3072 sc1
    s_waitcnt vmcnt(0)
    s_sub_u32 s6, s6, 1
    s_cmp_eq_u32 s6, 0
    s_cbranch_scc1 L_vok_46
    v_max3_u32 v12, v128, v129, v130
    v_max3_u32 v13, v131, v132, v133
    v_max3_u32 v12, v12, v134, v135
    v_max3_u32 v13, v13, v136, v137
    v_max3_u32 v12, v12, v138, v139
    v_max3_u32 v13, v13, v140, v141
    v_max3_u32 v12, v12, v142, v143
    v_max3_u32 v12, v12, v13, v13
    v_cmp_eq_u32 vcc, -1, v12
    s_cbranch_vccnz L_vsp_47_l
    s_branch L_vok_46
L_vsp_49:
    s_mov_b32 s6, 0x8000
L_vsp_49_l:
    s_add_u32 s53, s42, 4096
    buffer_load_dwordx4 v[144:147], v2, s[8:11], s53 offen offset:0 sc1
    buffer_load_dwordx4 v[148:151], v2, s[8:11], s53 offen offset:1024 sc1
    buffer_load_dwordx4 v[152:155], v2, s[8:11], s53 offen offset:2048 sc1
    buffer_load_dwordx4 v[156:159], v2, s[8:11], s53 offen offset:3072 sc1
    s_waitcnt vmcnt(0)
    s_sub_u32 s6, s6, 1
    s_cmp_eq_u32 s6, 0
    s_cbranch_scc1 L_vok_48
    v_max3_u32 v12, v144, v145, v146
    v_max3_u32 v13, v147, v148, v149
    v_max3_u32 v12, v12, v150, v151
    v_max3_u32 v13, v13, v152, v153
    v_max3_u32 v12, v12, v154, v155
    v_max3_u32 v13, v13, v156, v157
    v_max3_u32 v12, v12, v158, v159
    v_max3_u32 v12, v12, v13, v13
    v_cmp_eq_u32 vcc, -1, v12
    s_cbranch_vccnz L_vsp_49_l
    s_branch L_vok_48
L_vsp_51:
    s_mov_b32 s6, 0x8000
L_vsp_51_l:
    s_add_u32 s53, s42, 8192
    buffer_load_dwordx4 v[160:163], v2, s[8:11], s53 offen offset:0 sc1
    buffer_load_dwordx4 v[164:167], v2, s[8:11], s53 offen offset:1024 sc1
    buffer_load_dwordx4 v[168:171], v2, s[8:11], s53 offen offset:2048 sc1
    buffer_load_dwordx4 v[172:175], v2, s[8:11], s53 offen offset:3072 sc1
    s_waitcnt vmcnt(0)
    s_sub_u32 s6, s6, 1
    s_cmp_eq_u32 s6, 0
    s_cbranch_scc1 L_vok_50
    v_max3_u32 v12, v160, v161, v162
    v_max3_u32 v13, v163, v164, v165
    v_max3_u32 v12, v12, v166, v167
    v_max3_u32 v13, v13, v168, v169
    v_max3_u32 v12, v12, v170, v171
    v_max3_u32 v13, v13, v172, v173
    v_max3_u32 v12, v12, v174, v175
    v_max3_u32 v12, v12, v13, v13
    v_cmp_eq_u32 vcc, -1, v12
    s_cbranch_vccnz L_vsp_51_l
    s_branch L_vok_50
L_vsp_53:
    s_mov_b32 s6, 0x8000
L_vsp_53_l:
    s_add_u32 s53, s42, 12288
    buffer_load_dwordx4 v[176:179], v2, s[8:11], s53 offen offset:0 sc1
    buffer_load_dwordx4 v[180:183], v2, s[8:11], s53 offen offset:1024 sc1
    buffer_load_dwordx4 v[184:187], v2, s[8:11], s53 offen offset:2048 sc1
    buffer_load_dwordx4 v[188:191], v2, s[8:11], s53 offen offset:3072 sc1
    s_waitcnt vmcnt(0)
    s_sub_u32 s6, s6, 1
    s_cmp_eq_u32 s6, 0
    s_cbranch_scc1 L_vok_52
    v_max3_u32 v12, v176, v177, v178
    v_max3_u32 v13, v179, v180, v181
    v_max3_u32 v12, v12, v182, v183
    v_max3_u32 v13, v13, v184, v185
    v_max3_u32 v12, v12, v186, v187
    v_max3_u32 v13, v13, v188, v189
    v_max3_u32 v12, v12, v190, v191
    v_max3_u32 v12, v12, v13, v13
    v_cmp_eq_u32 vcc, -1, v12
    s_cbranch_vccnz L_vsp_53_l
    s_branch L_vok_52
L_vsp_55:
    s_mov_b32 s6, 0x8000
L_vsp_55_l:
    s_add_u32 s53, s42, 16384
    buffer_load_dwordx4 v[192:195], v2, s[8:11], s53 offen offset:0 sc1
    buffer_load_dwordx4 v[196:199], v2, s[8:11], s53 offen offset:1024 sc1
    buffer_load_dwordx4 v[200:203], v2, s[8:11], s53 offen offset:2048 sc1
    buffer_load_dwordx4 v[204:207], v2, s[8:11], s53 offen offset:3072 sc1
    s_waitcnt vmcnt(0)
    s_sub_u32 s6, s6, 1
    s_cmp_eq_u32 s6, 0
    s_cbranch_scc1 L_vok_54
    v_max3_u32 v12, v192, v193, v194
    v_max3_u32 v13, v195, v196, v197
    v_max3_u32 v12, v12, v198, v199
    v_max3_u32 v13, v13, v200, v201
    v_max3_u32 v12, v12, v202, v203
    v_max3_u32 v13, v13, v204, v205
    v_max3_u32 v12, v12, v206, v207
    v_max3_u32 v12, v12, v13, v13
    v_cmp_eq_u32 vcc, -1, v12
    s_cbranch_vccnz L_vsp_55_l
    s_branch L_vok_54
L_vsp_57:
    s_mov_b32 s6, 0x8000
L_vsp_57_l:
    buffer_load_dwordx4 v[48:51], v127, s[8:11], s50 offen offset:0 sc1
    buffer_load_dwordx4 v[52:55], v127, s[8:11], s50 offen offset:512 sc1
    buffer_load_dwordx4 v[56:59], v127, s[8:11], s50 offen offset:1024 sc1
    buffer_load_dwordx4 v[60:63], v127, s[8:11], s50 offen offset:1536 sc1
    s_waitcnt vmcnt(0)
    s_sub_u32 s6, s6, 1
    s_cmp_eq_u32 s6, 0
    s_cbranch_scc1 L_vok_56
    v_max3_u32 v14, v48, v49, v50
    v_max3_u32 v15, v51, v52, v53
    v_max3_u32 v14, v14, v54, v55
    v_max3_u32 v15, v15, v56, v57
    v_max3_u32 v14, v14, v58, v59
    v_max3_u32 v15, v15, v60, v61
    v_max3_u32 v14, v14, v62, v63
    v_max3_u32 v14, v14, v15, v15
    v_cmp_eq_u32 vcc, -1, v14
    s_cbranch_vccnz L_vsp_57_l
    s_branch L_vok_56
L_vsp_59:
    s_mov_b32 s6, 0x8000
L_vsp_59_l:
    s_add_u32 s53, s42, 20480
    buffer_load_dwordx4 v[208:211], v2, s[8:11], s53 offen offset:0 sc1
    buffer_load_dwordx4 v[212:215], v2, s[8:11], s53 offen offset:1024 sc1
    buffer_load_dwordx4 v[216:219], v2, s[8:11], s53 offen offset:2048 sc1
    buffer_load_dwordx4 v[220:223], v2, s[8:11], s53 offen offset:3072 sc1
    s_waitcnt vmcnt(0)
    s_sub_u32 s6, s6, 1
    s_cmp_eq_u32 s6, 0
    s_cbranch_scc1 L_vok_58
    v_max3_u32 v12, v208, v209, v210
    v_max3_u32 v13, v211, v212, v213
    v_max3_u32 v12, v12, v214, v215
    v_max3_u32 v13, v13, v216, v217
    v_max3_u32 v12, v12, v218, v219
    v_max3_u32 v13, v13, v220, v221
    v_max3_u32 v12, v12, v222, v223
    v_max3_u32 v12, v12, v13, v13
    v_cmp_eq_u32 vcc, -1, v12
    s_cbranch_vccnz L_vsp_59_l
    s_branch L_vok_58
L_vsp_61:
    s_mov_b32 s6, 0x8000
L_vsp_61_l:
    s_add_u32 s53, s42, 24576
    buffer_load_dwordx4 v[224:227], v2, s[8:11], s53 offen offset:0 sc1
    buffer_load_dwordx4 v[228:231], v2, s[8:11], s53 offen offset:1024 sc1
    buffer_load_dwordx4 v[232:235], v2, s[8:11], s53 offen offset:2048 sc1
    buffer_load_dwordx4 v[236:239], v2, s[8:11], s53 offen offset:3072 sc1
    s_waitcnt vmcnt(0)
    s_sub_u32 s6, s6, 1
    s_cmp_eq_u32 s6, 0
    s_cbranch_scc1 L_vok_60
    v_max3_u32 v12, v224, v225, v226
    v_max3_u32 v13, v227, v228, v229
    v_max3_u32 v12, v12, v230, v231
    v_max3_u32 v13, v13, v232, v233
    v_max3_u32 v12, v12, v234, v235
    v_max3_u32 v13, v13, v236, v237
    v_max3_u32 v12, v12, v238, v239
    v_max3_u32 v12, v12, v13, v13
    v_cmp_eq_u32 vcc, -1, v12
    s_cbranch_vccnz L_vsp_61_l
    s_branch L_vok_60
L_vsp_63:
    s_mov_b32 s6, 0x8000
L_vsp_63_l:
    s_add_u32 s53, s42, 28672
    buffer_load_dwordx4 v[240:243], v2, s[8:11], s53 offen offset:0 sc1
    buffer_load_dwordx4 v[244:247], v2, s[8:11], s53 offen offset:1024 sc1
    buffer_load_dwordx4 v[248:251], v2, s[8:11], s53 offen offset:2048 sc1
    buffer_load_dwordx4 v[252:255], v2, s[8:11], s53 offen offset:3072 sc1
    s_waitcnt vmcnt(0)
    s_sub_u32 s6, s6, 1
    s_cmp_eq_u32 s6, 0
    s_cbranch_scc1 L_vok_62
    v_max3_u32 v12, v240, v241, v242
    v_max3_u32 v13, v243, v244, v245
    v_max3_u32 v12, v12, v246, v247
    v_max3_u32 v13, v13, v248, v249
    v_max3_u32 v12, v12, v250, v251
    v_max3_u32 v13, v13, v252, v253
    v_max3_u32 v12, v12, v254, v255
    v_max3_u32 v12, v12, v13, v13
    v_cmp_eq_u32 vcc, -1, v12
    s_cbranch_vccnz L_vsp_63_l
    s_branch L_vok_62
L_spin_65:
    s_mov_b32 s6, 0x10000
L_spin_65_l:
    buffer_load_dwordx2 v[124:125], v6, s[8:11], s51 offen sc1
    s_sub_u32 s6, s6, 1
    s_cmp_eq_u32 s6, 0
    s_cbranch_scc1 L_ok_64
    s_waitcnt vmcnt(0)
    v_cmp_eq_u64 vcc, s[18:19], v[124:125]
    s_cmp_eq_u64 vcc, -1
    s_cbranch_scc0 L_spin_65_l
    s_branch L_ok_64
L_vsp_67:
    s_mov_b32 s6, 0x8000
L_vsp_67_l:
    s_add_u32 s53, s100, 12288
    buffer_load_dwordx4 v[224:227], v2, s[8:11], s53 offen sc1
    s_add_u32 s53, s101, 12288
    buffer_load_dwordx4 v[228:231], v2, s[8:11], s53 offen sc1
    s_add_u32 s53, s100, 13312
    buffer_load_dwordx4 v[232:235], v2, s[8:11], s53 offen sc1
    s_add_u32 s53, s101, 13312
    buffer_load_dwordx4 v[236:239], v2, s[8:11], s53 offen sc1
    s_add_u32 s53, s100, 14336
    buffer_load_dwordx4 v[240:243], v2, s[8:11], s53 offen sc1
    s_add_u32 s53, s101, 14336
    buffer_load_dwordx4 v[244:247], v2, s[8:11], s53 offen sc1
    s_add_u32 s53, s100, 15360
    buffer_load_dwordx4 v[248:251], v2, s[8:11], s53 offen sc1
    s_add_u32 s53, s101, 15360
    buffer_load_dwordx4 v[252:255], v2, s[8:11], s53 offen sc1
    s_waitcnt vmcnt(0)
    s_sub_u32 s6, s6, 1
    s_cmp_eq_u32 s6, 0
    s_cbranch_scc1 L_vok_66
    v_max3_u32 v12, v224, v225, v226
    v_max3_u32 v13, v227, v228, v229
    v_max3_u32 v12, v12, v230, v231
    v_max3_u32 v13, v13, v232, v233
    v_max3_u32 v12, v12, v234, v235
    v_max3_u32 v13, v13, v236, v237
    v_max3_u32 v12, v12, v238, v239
    v_max3_u32 v13, v13, v240, v241
    v_max3_u32 v12, v12, v242, v243
    v_max3_u32 v13, v13, v244, v245
    v_max3_u32 v12, v12, v246, v247
    v_max3_u32 v13, v13, v248, v249
    v_max3_u32 v12, v12, v250, v251
    v_max3_u32 v13, v13, v252, v253
    v_max3_u32 v12, v12, v254, v255
    v_max3_u32 v12, v12, v13, v13
    v_cmp_eq_u32 vcc, -1, v12
    s_cbranch_vccnz L_vsp_67_l
    s_branch L_vok_66
L_vsp_69:
    s_mov_b32 s6, 0x8000
L_vsp_69_l:
    s_add_u32 s53, s100, 16384
    buffer_load_dwordx4 v[128:131], v2, s[8:11], s53 offen sc1
    s_add_u32 s53, s101, 16384
    buffer_load_dwordx4 v[132:135], v2, s[8:11], s53 offen sc1
    s_add_u32 s53, s100, 17408
    buffer_load_dwordx4 v[136:139], v2, s[8:11], s53 offen sc1
    s_add_u32 s53, s101, 17408
    buffer_load_dwordx4 v[140:143], v2, s[8:11], s53 offen sc1
    s_add_u32 s53, s100, 18432
    buffer_load_dwordx4 v[144:147], v2, s[8:11], s53 offen sc1
    s_add_u32 s53, s101, 18432
    buffer_load_dwordx4 v[148:151], v2, s[8:11], s53 offen sc1
    s_add_u32 s53, s100, 19456
    buffer_load_dwordx4 v[152:155], v2, s[8:11], s53 offen sc1
    s_add_u32 s53, s101, 19456
    buffer_load_dwordx4 v[156:159], v2, s[8:11], s53 offen sc1
    s_waitcnt vmcnt(0)
    s_sub_u32 s6, s6, 1
    s_cmp_eq_u32 s6, 0
    s_cbranch_scc1 L_vok_68
    v_max3_u32 v12, v128, v129, v130
    v_max3_u32 v13, v131, v132, v133
    v_max3_u32 v12, v12, v134, v135
    v_max3_u32 v13, v13, v136, v137
    v_max3_u32 v12, v12, v138, v139
    v_max3_u32 v13, v13, v140, v141
    v_max3_u32 v12, v12, v142, v143
    v_max3_u32 v13, v13, v144, v145
    v_max3_u32 v12, v12, v146, v147
    v_max3_u32 v13, v13, v148, v149
    v_max3_u32 v12, v12, v150, v151
    v_max3_u32 v13, v13, v152, v153
    v_max3_u32 v12, v12, v154, v155
    v_max3_u32 v13, v13, v156, v157
    v_max3_u32 v12, v12, v158, v159
    v_max3_u32 v12, v12, v13, v13
    v_cmp_eq_u32 vcc, -1, v12
    s_cbranch_vccnz L_vsp_69_l
    s_branch L_vok_68
L_vsp_71:
    s_mov_b32 s6, 0x8000
L_vsp_71_l:
    s_add_u32 s53, s100, 20480
    buffer_load_dwordx4 v[160:163], v2, s[8:11], s53 offen sc1
    s_add_u32 s53, s101, 20480
    buffer_load_dwordx4 v[164:167], v2, s[8:11], s53 offen sc1
    s_add_u32 s53, s100, 21504
    buffer_load_dwordx4 v[168:171], v2, s[8:11], s53 offen sc1
    s_add_u32 s53, s101, 21504
    buffer_load_dwordx4 v[172:175], v2, s[8:11], s53 offen sc1
    s_add_u32 s53, s100, 22528
    buffer_load_dwordx4 v[176:179], v2, s[8:11], s53 offen sc1
    s_add_u32 s53, s101, 22528
    buffer_load_dwordx4 v[180:183], v2, s[8:11], s53 offen sc1
    s_add_u32 s53, s100, 23552
    buffer_load_dwordx4 v[184:187], v2, s[8:11], s53 offen sc1
    s_add_u32 s53, s101, 23552
    buffer_load_dwordx4 v[188:191], v2, s[8:11], s53 offen sc1
    s_waitcnt vmcnt(0)
    s_sub_u32 s6, s6, 1
    s_cmp_eq_u32 s6, 0
    s_cbranch_scc1 L_vok_70
    v_max3_u32 v12, v160, v161, v162
    v_max3_u32 v13, v163, v164, v165
    v_max3_u32 v12, v12, v166, v167
    v_max3_u32 v13, v13, v168, v169
    v_max3_u32 v12, v12, v170, v171
    v_max3_u32 v13, v13, v172, v173
    v_max3_u32 v12, v12, v174, v175
    v_max3_u32 v13, v13, v176, v177
    v_max3_u32 v12, v12, v178, v179
    v_max3_u32 v13, v13, v180, v181
    v_max3_u32 v12, v12, v182, v183
    v_max3_u32 v13, v13, v184, v185
    v_max3_u32 v12, v12, v186, v187
    v_max3_u32 v13, v13, v188, v189
    v_max3_u32 v12, v12, v190, v191
    v_max3_u32 v12, v12, v13, v13
    v_cmp_eq_u32 vcc, -1, v12
    s_cbranch_vccnz L_vsp_71_l
    s_branch L_vok_70
L_vsp_73:
    s_mov_b32 s6, 0x8000
L_vsp_73_l:
    s_add_u32 s53, s100, 24576
    buffer_load_dwordx4 v[192:195], v2, s[8:11], s53 offen sc1
    s_add_u32 s53, s101, 24576
    buffer_load_dwordx4 v[196:199], v2, s[8:11], s53 offen sc1
    s_add_u32 s53, s100, 25600
    buffer_load_dwordx4 v[200:203], v2, s[8:11], s53 offen sc1
    s_add_u32 s53, s101, 25600
    buffer_load_dwordx4 v[204:207], v2, s[8:11], s53 offen sc1
    s_add_u32 s53, s100, 26624
    buffer_load_dwordx4 v[208:211], v2, s[8:11], s53 offen sc1
    s_add_u32 s53, s101, 26624
    buffer_load_dwordx4 v[212:215], v2, s[8:11], s53 offen sc1
    s_add_u32 s53, s100, 27648
    buffer_load_dwordx4 v[216:219], v2, s[8:11], s53 offen sc1
    s_add_u32 s53, s101, 27648
    buffer_load_dwordx4 v[220:223], v2, s[8:11], s53 offen sc1
    s_waitcnt vmcnt(0)
    s_sub_u32 s6, s6, 1
    s_cmp_eq_u32 s6, 0
    s_cbranch_scc1 L_vok_72
    v_max3_u32 v12, v192, v193, v194
    v_max3_u32 v13, v195, v196, v197
    v_max3_u32 v12, v12, v198, v199
    v_max3_u32 v13, v13, v200, v201
    v_max3_u32 v12, v12, v202, v203
    v_max3_u32 v13, v13, v204, v205
    v_max3_u32 v12, v12, v206, v207
    v_max3_u32 v13, v13, v208, v209
    v_max3_u32 v12, v12, v210, v211
    v_max3_u32 v13, v13, v212, v213
    v_max3_u32 v12, v12, v214, v215
    v_max3_u32 v13, v13, v216, v217
    v_max3_u32 v12, v12, v218, v219
    v_max3_u32 v13, v13, v220, v221
    v_max3_u32 v12, v12, v222, v223
    v_max3_u32 v12, v12, v13, v13
    v_cmp_eq_u32 vcc, -1, v12
    s_cbranch_vccnz L_vsp_73_l
    s_branch L_vok_72
L_exit_1:
L_main_end:
    s_endpgm
.section .rodata,"a"
.p2align 6
.amdhsa_kernel interleave_layers__spectral_fnet__glu_gated_glu__prompt_kernel
  .amdhsa_next_free_vgpr 512
  .amdhsa_next_free_sgpr 102
  .amdhsa_accum_offset 256
  .amdhsa_group_segment_fixed_size 0
  .amdhsa_kernarg_size 96
  .amdhsa_user_sgpr_count 2
  .amdhsa_user_sgpr_kernarg_segment_ptr 1
  .amdhsa_system_sgpr_workgroup_id_x 1
.end_amdhsa_kernel
```
